```python
import torch

def _softmax(x, axis=-1):
    return torch.softmax(x, dim=axis)
def _gelu(x):
    return torch.nn.functional.gelu(x, approximate="tanh")
def _silu(x):
    return torch.nn.functional.silu(x)
def _sigmoid(x):
    return torch.sigmoid(x)
def _layernorm(x, axis=-1, eps=1e-5):
    m = x.mean(dim=axis, keepdim=True)
    v = x.var(dim=axis, keepdim=True, unbiased=False)
    return (x - m) / torch.sqrt(v + eps)
def _scatter_add(tgt, idx, src, axis=0):
    return tgt.clone().index_add_(axis, idx, src)
def _segment_sum(src, seg, n):
    out = torch.zeros((n,) + src.shape[1:], dtype=src.dtype)
    return out.index_add_(0, seg, src)
def _pad(x, pw):
    flat = tuple(v for pair in reversed(pw) for v in pair)
    return torch.nn.functional.pad(x, flat)

kernel_name = 'standalone__kv_cache_quant_int4_int2_kv_with_per_channel_or_per_token_scales__prompt'

def setup_inputs():

    _w = (lambda a: (lambda t: t.to(torch.bfloat16) if t.is_floating_point() else t)(torch.as_tensor(a)))
    B = 1
    Sq = 2048
    Skv = 2048
    Hq = 32
    Hkv = 32
    Dh = 192
    bits = 3
    G = 32
    if G <= 0 or G >= Skv:
        G = max(1, Skv // 2)
    Skv = (Skv // G) * G
    ngk = Skv // G
    qmax = (1 << bits) - 1
    return {
        "q": _w((lambda *s: torch.randn(*s, dtype=torch.bfloat16) * 1.6)(B, Hq, Sq, Dh)),
        "qk": _w(torch.randint(0, qmax + 1, (B, Hkv, Skv, Dh)).to(torch.int32)),
        "qv": _w(torch.randint(0, qmax + 1, (B, Hkv, Skv, Dh)).to(torch.int32)),
        "k_scales": _w(torch.abs((lambda *s: torch.randn(*s, dtype=torch.bfloat16) * 1.6)(B, Hkv, ngk, Dh)) * 0.05 + 0.02),
        "k_zeros": _w((lambda *s: torch.randn(*s, dtype=torch.bfloat16) * 1.6)(B, Hkv, ngk, Dh) + float(qmax) / 2.0),
        "v_scales": _w(torch.abs((lambda *s: torch.randn(*s, dtype=torch.bfloat16) * 0.05)(B, Hkv, Skv, 1)) * 0.05 + 0.02),
        "v_zeros": _w((lambda *s: torch.randn(*s, dtype=torch.bfloat16) * 0.05)(B, Hkv, Skv, 1) + float(qmax) / 2.0),
    }

def reference(q, qk, qv, k_scales, k_zeros, v_scales, v_zeros):
    B, Hq, Sq, Dh = q.shape
    Hkv, Skv = qk.shape[1], qk.shape[2]
    ngk = k_scales.shape[2]
    G = Skv // ngk
    ks = (lambda x, n, axis: torch.repeat_interleave(x, n, dim=axis))(k_scales, G, axis=2)
    kz = (lambda x, n, axis: torch.repeat_interleave(x, n, dim=axis))(k_zeros, G, axis=2)
    k = ((lambda x, dt: x.to(dt))(qk, q.dtype) - kz) * ks
    v = ((lambda x, dt: x.to(dt))(qv, q.dtype) - v_zeros) * v_scales
    rep = Hq // Hkv
    if rep > 1:
        k = (lambda x, n, axis: torch.repeat_interleave(x, n, dim=axis))(k, rep, axis=1)
        v = (lambda x, n, axis: torch.repeat_interleave(x, n, dim=axis))(v, rep, axis=1)
    scale = float(Dh) ** -0.5
    logits = torch.einsum("bhqd,bhkd->bhqk", q, k) * scale
    p = _softmax(logits, axis=-1)
    o = torch.einsum("bhqk,bhkd->bhqd", p, v)
    return o
```

```asm
; @launch grid=(256,1,1) block=(256,1,1) lds=149568
.amdgcn_target "amdgcn-amd-amdhsa--gfx950"
.text
.globl standalone__kv_cache_quant_int4_int2_kv_with_per_channel_or_per_token_scales__prompt_kernel
.p2align 8
.type standalone__kv_cache_quant_int4_int2_kv_with_per_channel_or_per_token_scales__prompt_kernel,@function
standalone__kv_cache_quant_int4_int2_kv_with_per_channel_or_per_token_scales__prompt_kernel:
  s_cmp_ge_u32 s2, 256
  s_cbranch_scc1 L_end
  s_and_b32 s38, s2, 7
  s_lshr_b32 s50, s2, 6
  s_lshl_b32 s50, s50, 3
  s_add_u32 s38, s38, s50
  s_bfe_u32 s39, s2, 0x30003
  s_load_dwordx4 s[88:91], s[0:1], 0
  s_load_dwordx4 s[92:95], s[0:1], 16
  s_load_dwordx4 s[96:99], s[0:1], 32
  s_load_dwordx4 s[52:55], s[0:1], 48
  s_load_dwordx4 s[56:59], s[0:1], 64
  v_lshrrev_b32 v1, 6, v0
  v_and_b32 v0, 63, v0
  v_readfirstlane_b32 s36, v1
  s_mul_i32 s50, s38, 1572864
  s_mul_i32 s37, s36, 3072
  v_lshlrev_b32 v4, 4, v0
  v_and_b32 v1, 15, v0
  v_lshrrev_b32 v2, 4, v0
  v_mul_u32_u24 v184, 768, v1
  v_lshl_add_u32 v184, v2, 5, v184
  v_lshlrev_b32 v185, 4, v2
  v_add_u32 v8, s37, v4
  v_add_u32 v9, 12288, v8
  v_mul_u32_u24 v186, 12, v0
  v_add_u32 v186, s37, v186
  s_lshr_b32 s60, s36, 1
  s_mul_i32 s60, s60, 12288
  s_and_b32 s61, s36, 1
  s_mul_i32 s62, s61, 384
  s_add_u32 s60, s60, s62
  v_add_u32 v184, s60, v184
  s_mul_i32 s62, s61, 192
  v_add_u32 v185, s62, v185
  v_and_b32 v3, 3, v0
  v_bfe_u32 v187, v0, 2, 1
  v_lshlrev_b32 v187, 5, v187
  v_lshl_add_u32 v187, v3, 1, v187
  s_lshl_b32 s60, s36, 3
  v_add_u32 v187, s60, v187
  v_mul_u32_u24 v5, 3072, v2
  v_lshl_add_u32 v5, v1, 4, v5
  v_add_u32 v5, 49152, v5
  s_waitcnt lgkmcnt(0)
  s_add_u32 s4, s58, s50
  s_addc_u32 s5, s59, 0
  s_mov_b32 s6, 1572864
  s_mov_b32 s7, 0x00020000
  s_add_u32 s12, s90, s50
  s_addc_u32 s13, s91, 0
  s_mov_b32 s14, 1572864
  s_mov_b32 s15, 0x00020000
  s_add_u32 s16, s92, s50
  s_addc_u32 s17, s93, 0
  s_mov_b32 s18, 1572864
  s_mov_b32 s19, 0x00020000
  s_mul_i32 s50, s38, 24576
  s_add_u32 s20, s94, s50
  s_addc_u32 s21, s95, 0
  s_mov_b32 s22, 24576
  s_mov_b32 s23, 0x00020000
  s_add_u32 s24, s96, s50
  s_addc_u32 s25, s97, 0
  s_mov_b32 s26, 24576
  s_mov_b32 s27, 0x00020000
  s_lshl_b32 s50, s38, 12
  s_add_u32 s28, s98, s50
  s_addc_u32 s29, s99, 0
  s_mov_b32 s30, 4096
  s_mov_b32 s31, 0x00020000
  s_add_u32 s32, s52, s50
  s_addc_u32 s33, s53, 0
  s_mov_b32 s34, 4096
  s_mov_b32 s35, 0x00020000
  s_mov_b32 s42, 0x3dd53b95
  s_mov_b32 s43, 0x3dd53b95
  s_mov_b32 s44, 0xffff0000
  s_mul_i32 s50, s38, 786432
  s_mul_i32 s51, s39, 98304
  s_add_u32 s50, s50, s51
  s_add_u32 s8, s88, s50
  s_addc_u32 s9, s89, 0
  s_mov_b32 s10, 98304
  s_mov_b32 s11, 0x00020000
  s_add_u32 s80, s54, s50
  s_addc_u32 s81, s55, 0
  s_mov_b32 s82, 98304
  s_mov_b32 s83, 0x00020000
  s_mov_b32 s84, s56
  s_mov_b32 s85, s57
  s_mov_b32 s86, 256
  s_mov_b32 s87, 0x00020000
  s_memrealtime s[88:89]
  s_mov_b32 s6, 0x4000000
  s_mul_i32 s52, s39, 24576
  s_add_u32 s53, s52, 12288
  s_mul_i32 s54, s39, 384
  s_lshl_b32 s55, s39, 6
  v_mov_b32 v148, 0
  v_mov_b32 v149, 0
  v_mov_b32 v10, 0
  v_mov_b32 v11, 0
  buffer_load_dwordx4 v[64:67], v184, s[12:15], s52 offen offset:0 sc0 sc1 nt
  buffer_load_dwordx4 v[68:71], v184, s[12:15], s52 offen offset:16 sc0 sc1 nt
  buffer_load_dwordx4 v[72:75], v185, s[24:27], s54 offen offset:0
  buffer_load_dwordx4 v[76:79], v185, s[20:23], s54 offen offset:0
  buffer_load_dwordx4 v[80:83], v184, s[12:15], s52 offen offset:128 sc0 sc1 nt
  buffer_load_dwordx4 v[84:87], v184, s[12:15], s52 offen offset:144 sc0 sc1 nt
  buffer_load_dwordx4 v[88:91], v185, s[24:27], s54 offen offset:64
  buffer_load_dwordx4 v[92:95], v185, s[20:23], s54 offen offset:64
  buffer_load_dwordx4 v[96:99], v184, s[12:15], s52 offen offset:256 sc0 sc1 nt
  buffer_load_dwordx4 v[100:103], v184, s[12:15], s52 offen offset:272 sc0 sc1 nt
  buffer_load_dwordx4 v[104:107], v185, s[24:27], s54 offen offset:128
  buffer_load_dwordx4 v[108:111], v185, s[20:23], s54 offen offset:128
  buffer_load_short_d16_hi v148, v187, s[32:35], s55 offen
  buffer_load_short_d16_hi v149, v187, s[28:31], s55 offen
  buffer_load_dwordx3 v[112:114], v186, s[16:19], s52 offen offset:0 sc0 sc1 nt
  buffer_load_dwordx3 v[116:118], v186, s[16:19], s52 offen offset:768 sc0 sc1 nt
  buffer_load_dwordx3 v[120:122], v186, s[16:19], s52 offen offset:1536 sc0 sc1 nt
  buffer_load_dwordx3 v[124:126], v186, s[16:19], s52 offen offset:2304 sc0 sc1 nt
  buffer_load_dwordx3 v[128:130], v186, s[16:19], s53 offen offset:0 sc0 sc1 nt
  buffer_load_dwordx3 v[132:134], v186, s[16:19], s53 offen offset:768 sc0 sc1 nt
  buffer_load_dwordx3 v[136:138], v186, s[16:19], s53 offen offset:1536 sc0 sc1 nt
  buffer_load_dwordx3 v[140:142], v186, s[16:19], s53 offen offset:2304 sc0 sc1 nt
  s_waitcnt lgkmcnt(0)
  s_or_b32 s88, s88, 1
  s_lshl_b32 s76, s38, 3
  v_lshl_add_u32 v3, s36, 6, v0
  v_lshlrev_b32 v3, 12, v3
  v_mov_b32 v12, s88
  v_mov_b32 v13, s89
  v_mov_b32 v14, 0
  v_mov_b32 v15, 0
  buffer_atomic_cmpswap_x2 v[12:15], v3, s[84:87], s76 offen sc0 sc1
  v_and_b32 v1, 15, v0
  v_lshrrev_b32 v2, 4, v0
  v_mul_u32_u24 v152, 384, v1
  v_lshl_add_u32 v152, v2, 4, v152
  s_mul_i32 s56, s36, 24576
  buffer_load_dwordx4 v[16:19], v152, s[8:11], s56 offen offset:0 sc0 sc1 nt
  buffer_load_dwordx4 v[20:23], v152, s[8:11], s56 offen offset:64 sc0 sc1 nt
  buffer_load_dwordx4 v[24:27], v152, s[8:11], s56 offen offset:128 sc0 sc1 nt
  s_mov_b32 s77, s52
  s_mov_b32 s57, 0
  s_lshl_b32 s91, s39, 9
  s_mov_b32 s76, s91
  s_sub_u32 s50, 32, s38
  s_mul_i32 s50, s50, 1572864
  s_lshl_b32 s51, s38, 15
  s_add_u32 s50, s50, s51
  s_lshl_b32 s51, s36, 7
  s_add_u32 s50, s50, s51
  v_mov_b32 v2, s50
  v_bfrev_b32 v1, 1
  v_cmp_eq_u32 vcc, 0, v0
  s_nop 1
  v_cndmask_b32 v1, v1, v2, vcc
  s_waitcnt vmcnt(25)
  v_cvt_f32_i32 v64, v64
  v_cvt_f32_i32 v65, v65
  s_waitcnt vmcnt(23)
  v_lshlrev_b32 v144, 16, v72
  v_and_b32 v145, s44, v72
  v_cvt_pk_bf16_f32 v64, 0, v64
  v_cvt_pk_bf16_f32 v65, 0, v65
  s_waitcnt vmcnt(22)
  v_lshlrev_b32 v146, 16, v76
  v_and_b32 v147, s44, v76
  v_pk_add_f32 v[64:65], v[64:65], v[144:145] neg_lo:[0,1] neg_hi:[0,1]
  v_pk_mul_f32 v[146:147], v[146:147], s[42:43]
  v_cvt_pk_bf16_f32 v64, 0, v64
  v_cvt_pk_bf16_f32 v65, 0, v65
  v_pk_mul_f32 v[64:65], v[64:65], v[146:147]
  v_cvt_pk_bf16_f32 v72, v64, v65
  v_cvt_f32_i32 v66, v66
  v_cvt_f32_i32 v67, v67
  v_lshlrev_b32 v144, 16, v73
  v_and_b32 v145, s44, v73
  v_cvt_pk_bf16_f32 v66, 0, v66
  v_cvt_pk_bf16_f32 v67, 0, v67
  v_lshlrev_b32 v146, 16, v77
  v_and_b32 v147, s44, v77
  v_pk_add_f32 v[66:67], v[66:67], v[144:145] neg_lo:[0,1] neg_hi:[0,1]
  v_pk_mul_f32 v[146:147], v[146:147], s[42:43]
  v_cvt_pk_bf16_f32 v66, 0, v66
  v_cvt_pk_bf16_f32 v67, 0, v67
  v_pk_mul_f32 v[66:67], v[66:67], v[146:147]
  v_cvt_pk_bf16_f32 v73, v66, v67
  v_cvt_f32_i32 v68, v68
  v_cvt_f32_i32 v69, v69
  v_lshlrev_b32 v144, 16, v74
  v_and_b32 v145, s44, v74
  v_cvt_pk_bf16_f32 v68, 0, v68
  v_cvt_pk_bf16_f32 v69, 0, v69
  v_lshlrev_b32 v146, 16, v78
  v_and_b32 v147, s44, v78
  v_pk_add_f32 v[68:69], v[68:69], v[144:145] neg_lo:[0,1] neg_hi:[0,1]
  v_pk_mul_f32 v[146:147], v[146:147], s[42:43]
  v_cvt_pk_bf16_f32 v68, 0, v68
  v_cvt_pk_bf16_f32 v69, 0, v69
  v_pk_mul_f32 v[68:69], v[68:69], v[146:147]
  v_cvt_pk_bf16_f32 v74, v68, v69
  v_cvt_f32_i32 v70, v70
  v_cvt_f32_i32 v71, v71
  v_lshlrev_b32 v144, 16, v75
  v_and_b32 v145, s44, v75
  v_cvt_pk_bf16_f32 v70, 0, v70
  v_cvt_pk_bf16_f32 v71, 0, v71
  v_lshlrev_b32 v146, 16, v79
  v_and_b32 v147, s44, v79
  v_pk_add_f32 v[70:71], v[70:71], v[144:145] neg_lo:[0,1] neg_hi:[0,1]
  v_pk_mul_f32 v[146:147], v[146:147], s[42:43]
  v_cvt_pk_bf16_f32 v70, 0, v70
  v_cvt_pk_bf16_f32 v71, 0, v71
  v_pk_mul_f32 v[70:71], v[70:71], v[146:147]
  v_cvt_pk_bf16_f32 v75, v70, v71
  buffer_store_dwordx4 v[72:75], v8, s[4:7], s77 offen offset:0 sc1
  ds_write_b128 v8, v[72:75] offset:0
  s_waitcnt vmcnt(22)
  v_cvt_f32_i32 v80, v80
  v_cvt_f32_i32 v81, v81
  s_waitcnt vmcnt(20)
  v_lshlrev_b32 v144, 16, v88
  v_and_b32 v145, s44, v88
  v_cvt_pk_bf16_f32 v80, 0, v80
  v_cvt_pk_bf16_f32 v81, 0, v81
  s_waitcnt vmcnt(19)
  v_lshlrev_b32 v146, 16, v92
  v_and_b32 v147, s44, v92
  v_pk_add_f32 v[80:81], v[80:81], v[144:145] neg_lo:[0,1] neg_hi:[0,1]
  v_pk_mul_f32 v[146:147], v[146:147], s[42:43]
  v_cvt_pk_bf16_f32 v80, 0, v80
  v_cvt_pk_bf16_f32 v81, 0, v81
  v_pk_mul_f32 v[80:81], v[80:81], v[146:147]
  v_cvt_pk_bf16_f32 v88, v80, v81
  v_cvt_f32_i32 v82, v82
  v_cvt_f32_i32 v83, v83
  v_lshlrev_b32 v144, 16, v89
  v_and_b32 v145, s44, v89
  v_cvt_pk_bf16_f32 v82, 0, v82
  v_cvt_pk_bf16_f32 v83, 0, v83
  v_lshlrev_b32 v146, 16, v93
  v_and_b32 v147, s44, v93
  v_pk_add_f32 v[82:83], v[82:83], v[144:145] neg_lo:[0,1] neg_hi:[0,1]
  v_pk_mul_f32 v[146:147], v[146:147], s[42:43]
  v_cvt_pk_bf16_f32 v82, 0, v82
  v_cvt_pk_bf16_f32 v83, 0, v83
  v_pk_mul_f32 v[82:83], v[82:83], v[146:147]
  v_cvt_pk_bf16_f32 v89, v82, v83
  v_cvt_f32_i32 v84, v84
  v_cvt_f32_i32 v85, v85
  v_lshlrev_b32 v144, 16, v90
  v_and_b32 v145, s44, v90
  v_cvt_pk_bf16_f32 v84, 0, v84
  v_cvt_pk_bf16_f32 v85, 0, v85
  v_lshlrev_b32 v146, 16, v94
  v_and_b32 v147, s44, v94
  v_pk_add_f32 v[84:85], v[84:85], v[144:145] neg_lo:[0,1] neg_hi:[0,1]
  v_pk_mul_f32 v[146:147], v[146:147], s[42:43]
  v_cvt_pk_bf16_f32 v84, 0, v84
  v_cvt_pk_bf16_f32 v85, 0, v85
  v_pk_mul_f32 v[84:85], v[84:85], v[146:147]
  v_cvt_pk_bf16_f32 v90, v84, v85
  v_cvt_f32_i32 v86, v86
  v_cvt_f32_i32 v87, v87
  v_lshlrev_b32 v144, 16, v91
  v_and_b32 v145, s44, v91
  v_cvt_pk_bf16_f32 v86, 0, v86
  v_cvt_pk_bf16_f32 v87, 0, v87
  v_lshlrev_b32 v146, 16, v95
  v_and_b32 v147, s44, v95
  v_pk_add_f32 v[86:87], v[86:87], v[144:145] neg_lo:[0,1] neg_hi:[0,1]
  v_pk_mul_f32 v[146:147], v[146:147], s[42:43]
  v_cvt_pk_bf16_f32 v86, 0, v86
  v_cvt_pk_bf16_f32 v87, 0, v87
  v_pk_mul_f32 v[86:87], v[86:87], v[146:147]
  v_cvt_pk_bf16_f32 v91, v86, v87
  buffer_store_dwordx4 v[88:91], v8, s[4:7], s77 offen offset:1024 sc1
  ds_write_b128 v8, v[88:91] offset:1024
  s_waitcnt vmcnt(19)
  v_cvt_f32_i32 v96, v96
  v_cvt_f32_i32 v97, v97
  s_waitcnt vmcnt(17)
  v_lshlrev_b32 v144, 16, v104
  v_and_b32 v145, s44, v104
  v_cvt_pk_bf16_f32 v96, 0, v96
  v_cvt_pk_bf16_f32 v97, 0, v97
  s_waitcnt vmcnt(16)
  v_lshlrev_b32 v146, 16, v108
  v_and_b32 v147, s44, v108
  v_pk_add_f32 v[96:97], v[96:97], v[144:145] neg_lo:[0,1] neg_hi:[0,1]
  v_pk_mul_f32 v[146:147], v[146:147], s[42:43]
  v_cvt_pk_bf16_f32 v96, 0, v96
  v_cvt_pk_bf16_f32 v97, 0, v97
  v_pk_mul_f32 v[96:97], v[96:97], v[146:147]
  v_cvt_pk_bf16_f32 v104, v96, v97
  v_cvt_f32_i32 v98, v98
  v_cvt_f32_i32 v99, v99
  v_lshlrev_b32 v144, 16, v105
  v_and_b32 v145, s44, v105
  v_cvt_pk_bf16_f32 v98, 0, v98
  v_cvt_pk_bf16_f32 v99, 0, v99
  v_lshlrev_b32 v146, 16, v109
  v_and_b32 v147, s44, v109
  v_pk_add_f32 v[98:99], v[98:99], v[144:145] neg_lo:[0,1] neg_hi:[0,1]
  v_pk_mul_f32 v[146:147], v[146:147], s[42:43]
  v_cvt_pk_bf16_f32 v98, 0, v98
  v_cvt_pk_bf16_f32 v99, 0, v99
  v_pk_mul_f32 v[98:99], v[98:99], v[146:147]
  v_cvt_pk_bf16_f32 v105, v98, v99
  v_cvt_f32_i32 v100, v100
  v_cvt_f32_i32 v101, v101
  v_lshlrev_b32 v144, 16, v106
  v_and_b32 v145, s44, v106
  v_cvt_pk_bf16_f32 v100, 0, v100
  v_cvt_pk_bf16_f32 v101, 0, v101
  v_lshlrev_b32 v146, 16, v110
  v_and_b32 v147, s44, v110
  v_pk_add_f32 v[100:101], v[100:101], v[144:145] neg_lo:[0,1] neg_hi:[0,1]
  v_pk_mul_f32 v[146:147], v[146:147], s[42:43]
  v_cvt_pk_bf16_f32 v100, 0, v100
  v_cvt_pk_bf16_f32 v101, 0, v101
  v_pk_mul_f32 v[100:101], v[100:101], v[146:147]
  v_cvt_pk_bf16_f32 v106, v100, v101
  v_cvt_f32_i32 v102, v102
  v_cvt_f32_i32 v103, v103
  v_lshlrev_b32 v144, 16, v107
  v_and_b32 v145, s44, v107
  v_cvt_pk_bf16_f32 v102, 0, v102
  v_cvt_pk_bf16_f32 v103, 0, v103
  v_lshlrev_b32 v146, 16, v111
  v_and_b32 v147, s44, v111
  v_pk_add_f32 v[102:103], v[102:103], v[144:145] neg_lo:[0,1] neg_hi:[0,1]
  v_pk_mul_f32 v[146:147], v[146:147], s[42:43]
  v_cvt_pk_bf16_f32 v102, 0, v102
  v_cvt_pk_bf16_f32 v103, 0, v103
  v_pk_mul_f32 v[102:103], v[102:103], v[146:147]
  v_cvt_pk_bf16_f32 v107, v102, v103
  buffer_store_dwordx4 v[104:107], v8, s[4:7], s77 offen offset:2048 sc1
  ds_write_b128 v8, v[104:107] offset:2048
  s_waitcnt vmcnt(16)
  v_readlane_b32 s60, v148, 0
  v_readlane_b32 s61, v148, 1
  v_readlane_b32 s62, v148, 2
  v_readlane_b32 s63, v148, 3
  v_readlane_b32 s64, v148, 4
  v_readlane_b32 s65, v148, 5
  v_readlane_b32 s66, v148, 6
  v_readlane_b32 s67, v148, 7
  s_waitcnt vmcnt(15)
  v_readlane_b32 s68, v149, 0
  v_readlane_b32 s69, v149, 1
  v_readlane_b32 s70, v149, 2
  v_readlane_b32 s71, v149, 3
  v_readlane_b32 s72, v149, 4
  v_readlane_b32 s73, v149, 5
  v_readlane_b32 s74, v149, 6
  v_readlane_b32 s75, v149, 7
  s_waitcnt vmcnt(13)
  v_cvt_f32_i32 v119, v118
  v_cvt_f32_i32 v118, v114
  v_cvt_f32_i32 v114, v113
  v_cvt_f32_i32 v115, v117
  v_cvt_f32_i32 v113, v116
  v_cvt_f32_i32 v112, v112
  v_cvt_pk_bf16_f32 v118, 0, v118
  v_cvt_pk_bf16_f32 v119, 0, v119
  v_cvt_pk_bf16_f32 v114, 0, v114
  v_cvt_pk_bf16_f32 v115, 0, v115
  v_cvt_pk_bf16_f32 v112, 0, v112
  v_cvt_pk_bf16_f32 v113, 0, v113
  v_pk_add_f32 v[118:119], v[118:119], s[60:61] neg_lo:[0,1] neg_hi:[0,1]
  v_pk_add_f32 v[114:115], v[114:115], s[60:61] neg_lo:[0,1] neg_hi:[0,1]
  v_pk_add_f32 v[112:113], v[112:113], s[60:61] neg_lo:[0,1] neg_hi:[0,1]
  v_cvt_pk_bf16_f32 v118, 0, v118
  v_cvt_pk_bf16_f32 v119, 0, v119
  v_cvt_pk_bf16_f32 v114, 0, v114
  v_cvt_pk_bf16_f32 v115, 0, v115
  v_cvt_pk_bf16_f32 v112, 0, v112
  v_cvt_pk_bf16_f32 v113, 0, v113
  v_pk_mul_f32 v[118:119], v[118:119], s[68:69]
  v_pk_mul_f32 v[114:115], v[114:115], s[68:69]
  v_pk_mul_f32 v[112:113], v[112:113], s[68:69]
  v_cvt_pk_bf16_f32 v144, v118, v119
  v_cvt_pk_bf16_f32 v116, v114, v115
  v_cvt_pk_bf16_f32 v112, v112, v113
  s_waitcnt vmcnt(11)
  v_cvt_f32_i32 v127, v126
  v_cvt_f32_i32 v126, v122
  v_cvt_f32_i32 v122, v121
  v_cvt_f32_i32 v123, v125
  v_cvt_f32_i32 v121, v124
  v_cvt_f32_i32 v120, v120
  v_cvt_pk_bf16_f32 v126, 0, v126
  v_cvt_pk_bf16_f32 v127, 0, v127
  v_cvt_pk_bf16_f32 v122, 0, v122
  v_cvt_pk_bf16_f32 v123, 0, v123
  v_cvt_pk_bf16_f32 v120, 0, v120
  v_cvt_pk_bf16_f32 v121, 0, v121
  v_pk_add_f32 v[126:127], v[126:127], s[62:63] neg_lo:[0,1] neg_hi:[0,1]
  v_pk_add_f32 v[122:123], v[122:123], s[62:63] neg_lo:[0,1] neg_hi:[0,1]
  v_pk_add_f32 v[120:121], v[120:121], s[62:63] neg_lo:[0,1] neg_hi:[0,1]
  v_cvt_pk_bf16_f32 v126, 0, v126
  v_cvt_pk_bf16_f32 v127, 0, v127
  v_cvt_pk_bf16_f32 v122, 0, v122
  v_cvt_pk_bf16_f32 v123, 0, v123
  v_cvt_pk_bf16_f32 v120, 0, v120
  v_cvt_pk_bf16_f32 v121, 0, v121
  v_pk_mul_f32 v[126:127], v[126:127], s[70:71]
  v_pk_mul_f32 v[122:123], v[122:123], s[70:71]
  v_pk_mul_f32 v[120:121], v[120:121], s[70:71]
  v_cvt_pk_bf16_f32 v145, v126, v127
  v_cvt_pk_bf16_f32 v117, v122, v123
  v_cvt_pk_bf16_f32 v113, v120, v121
  s_waitcnt vmcnt(9)
  v_cvt_f32_i32 v135, v134
  v_cvt_f32_i32 v134, v130
  v_cvt_f32_i32 v130, v129
  v_cvt_f32_i32 v131, v133
  v_cvt_f32_i32 v129, v132
  v_cvt_f32_i32 v128, v128
  v_cvt_pk_bf16_f32 v134, 0, v134
  v_cvt_pk_bf16_f32 v135, 0, v135
  v_cvt_pk_bf16_f32 v130, 0, v130
  v_cvt_pk_bf16_f32 v131, 0, v131
  v_cvt_pk_bf16_f32 v128, 0, v128
  v_cvt_pk_bf16_f32 v129, 0, v129
  v_pk_add_f32 v[134:135], v[134:135], s[64:65] neg_lo:[0,1] neg_hi:[0,1]
  v_pk_add_f32 v[130:131], v[130:131], s[64:65] neg_lo:[0,1] neg_hi:[0,1]
  v_pk_add_f32 v[128:129], v[128:129], s[64:65] neg_lo:[0,1] neg_hi:[0,1]
  v_cvt_pk_bf16_f32 v134, 0, v134
  v_cvt_pk_bf16_f32 v135, 0, v135
  v_cvt_pk_bf16_f32 v130, 0, v130
  v_cvt_pk_bf16_f32 v131, 0, v131
  v_cvt_pk_bf16_f32 v128, 0, v128
  v_cvt_pk_bf16_f32 v129, 0, v129
  v_pk_mul_f32 v[134:135], v[134:135], s[72:73]
  v_pk_mul_f32 v[130:131], v[130:131], s[72:73]
  v_pk_mul_f32 v[128:129], v[128:129], s[72:73]
  v_cvt_pk_bf16_f32 v146, v134, v135
  v_cvt_pk_bf16_f32 v118, v130, v131
  v_cvt_pk_bf16_f32 v114, v128, v129
  s_waitcnt vmcnt(7)
  v_cvt_f32_i32 v143, v142
  v_cvt_f32_i32 v142, v138
  v_cvt_f32_i32 v138, v137
  v_cvt_f32_i32 v139, v141
  v_cvt_f32_i32 v137, v140
  v_cvt_f32_i32 v136, v136
  v_cvt_pk_bf16_f32 v142, 0, v142
  v_cvt_pk_bf16_f32 v143, 0, v143
  v_cvt_pk_bf16_f32 v138, 0, v138
  v_cvt_pk_bf16_f32 v139, 0, v139
  v_cvt_pk_bf16_f32 v136, 0, v136
  v_cvt_pk_bf16_f32 v137, 0, v137
  v_pk_add_f32 v[142:143], v[142:143], s[66:67] neg_lo:[0,1] neg_hi:[0,1]
  v_pk_add_f32 v[138:139], v[138:139], s[66:67] neg_lo:[0,1] neg_hi:[0,1]
  v_pk_add_f32 v[136:137], v[136:137], s[66:67] neg_lo:[0,1] neg_hi:[0,1]
  v_cvt_pk_bf16_f32 v142, 0, v142
  v_cvt_pk_bf16_f32 v143, 0, v143
  v_cvt_pk_bf16_f32 v138, 0, v138
  v_cvt_pk_bf16_f32 v139, 0, v139
  v_cvt_pk_bf16_f32 v136, 0, v136
  v_cvt_pk_bf16_f32 v137, 0, v137
  v_pk_mul_f32 v[142:143], v[142:143], s[74:75]
  v_pk_mul_f32 v[138:139], v[138:139], s[74:75]
  v_pk_mul_f32 v[136:137], v[136:137], s[74:75]
  v_cvt_pk_bf16_f32 v147, v142, v143
  v_cvt_pk_bf16_f32 v119, v138, v139
  v_cvt_pk_bf16_f32 v115, v136, v137
  buffer_store_dwordx4 v[112:115], v9, s[4:7], s77 offen offset:0 sc1
  ds_write_b128 v9, v[112:115] offset:36864
  buffer_store_dwordx4 v[116:119], v9, s[4:7], s77 offen offset:1024 sc1
  ds_write_b128 v9, v[116:119] offset:37888
  buffer_store_dwordx4 v[144:147], v9, s[4:7], s77 offen offset:2048 sc1
  ds_write_b128 v9, v[144:147] offset:38912
  s_waitcnt vmcnt(9)
  v_readfirstlane_b32 s50, v12
  v_readfirstlane_b32 s51, v13
  s_nop 0
  s_cmp_eq_u64 s[50:51], 0
  s_cselect_b64 s[88:89], s[88:89], s[50:51]
  v_mov_b32 v12, s88
  v_mov_b32 v13, s89
  s_lshl_b32 s50, s36, 3
  v_mov_b32 v14, s50
  v_add_u32 v14, 98320, v14
  ds_write_b64 v14, v[12:13]
  buffer_load_dwordx4 v[28:31], v152, s[8:11], s56 offen offset:192 sc0 sc1 nt
  buffer_load_dwordx4 v[32:35], v152, s[8:11], s56 offen offset:256 sc0 sc1 nt
  buffer_load_dwordx4 v[36:39], v152, s[8:11], s56 offen offset:320 sc0 sc1 nt
  s_add_u32 s56, s56, 6144
  buffer_load_dwordx4 v[40:43], v152, s[8:11], s56 offen offset:0 sc0 sc1 nt
  buffer_load_dwordx4 v[44:47], v152, s[8:11], s56 offen offset:64 sc0 sc1 nt
  buffer_load_dwordx4 v[48:51], v152, s[8:11], s56 offen offset:128 sc0 sc1 nt
  v_mov_b32 v14, 98320
  s_waitcnt lgkmcnt(0)
  s_barrier
  ds_read_b64 v[12:13], v14
  ds_read_b128 v[64:67], v4 offset:0
  ds_read_b128 v[68:71], v4 offset:1024
  ds_read_b128 v[72:75], v4 offset:2048
  ds_read_b128 v[76:79], v4 offset:3072
  ds_read_b128 v[80:83], v4 offset:4096
  ds_read_b128 v[84:87], v4 offset:5120
  ds_read_b128 v[88:91], v4 offset:6144
  ds_read_b128 v[92:95], v4 offset:7168
  ds_read_b128 v[96:99], v4 offset:8192
  ds_read_b128 v[100:103], v4 offset:9216
  ds_read_b128 v[104:107], v4 offset:10240
  ds_read_b128 v[108:111], v4 offset:11264
  v_accvgpr_write_b32 a0, 0
  v_accvgpr_write_b32 a1, 0
  v_accvgpr_write_b32 a2, 0
  v_accvgpr_write_b32 a3, 0
  v_accvgpr_write_b32 a4, 0
  v_accvgpr_write_b32 a5, 0
  v_accvgpr_write_b32 a6, 0
  v_accvgpr_write_b32 a7, 0
  v_accvgpr_write_b32 a8, 0
  v_accvgpr_write_b32 a9, 0
  v_accvgpr_write_b32 a10, 0
  v_accvgpr_write_b32 a11, 0
  v_accvgpr_write_b32 a12, 0
  v_accvgpr_write_b32 a13, 0
  v_accvgpr_write_b32 a14, 0
  v_accvgpr_write_b32 a15, 0
  v_accvgpr_write_b32 a16, 0
  v_accvgpr_write_b32 a17, 0
  v_accvgpr_write_b32 a18, 0
  v_accvgpr_write_b32 a19, 0
  v_accvgpr_write_b32 a20, 0
  v_accvgpr_write_b32 a21, 0
  v_accvgpr_write_b32 a22, 0
  v_accvgpr_write_b32 a23, 0
  v_accvgpr_write_b32 a24, 0
  v_accvgpr_write_b32 a25, 0
  v_accvgpr_write_b32 a26, 0
  v_accvgpr_write_b32 a27, 0
  v_accvgpr_write_b32 a28, 0
  v_accvgpr_write_b32 a29, 0
  v_accvgpr_write_b32 a30, 0
  v_accvgpr_write_b32 a31, 0
  v_accvgpr_write_b32 a32, 0
  v_accvgpr_write_b32 a33, 0
  v_accvgpr_write_b32 a34, 0
  v_accvgpr_write_b32 a35, 0
  v_accvgpr_write_b32 a36, 0
  v_accvgpr_write_b32 a37, 0
  v_accvgpr_write_b32 a38, 0
  v_accvgpr_write_b32 a39, 0
  v_accvgpr_write_b32 a40, 0
  v_accvgpr_write_b32 a41, 0
  v_accvgpr_write_b32 a42, 0
  v_accvgpr_write_b32 a43, 0
  v_accvgpr_write_b32 a44, 0
  v_accvgpr_write_b32 a45, 0
  v_accvgpr_write_b32 a46, 0
  v_accvgpr_write_b32 a47, 0
  v_accvgpr_write_b32 a48, 0
  v_accvgpr_write_b32 a49, 0
  v_accvgpr_write_b32 a50, 0
  v_accvgpr_write_b32 a51, 0
  v_accvgpr_write_b32 a52, 0
  v_accvgpr_write_b32 a53, 0
  v_accvgpr_write_b32 a54, 0
  v_accvgpr_write_b32 a55, 0
  v_accvgpr_write_b32 a56, 0
  v_accvgpr_write_b32 a57, 0
  v_accvgpr_write_b32 a58, 0
  v_accvgpr_write_b32 a59, 0
  v_accvgpr_write_b32 a60, 0
  v_accvgpr_write_b32 a61, 0
  v_accvgpr_write_b32 a62, 0
  v_accvgpr_write_b32 a63, 0
  v_accvgpr_write_b32 a64, 0
  v_accvgpr_write_b32 a65, 0
  v_accvgpr_write_b32 a66, 0
  v_accvgpr_write_b32 a67, 0
  v_accvgpr_write_b32 a68, 0
  v_accvgpr_write_b32 a69, 0
  v_accvgpr_write_b32 a70, 0
  v_accvgpr_write_b32 a71, 0
  v_accvgpr_write_b32 a72, 0
  v_accvgpr_write_b32 a73, 0
  v_accvgpr_write_b32 a74, 0
  v_accvgpr_write_b32 a75, 0
  v_accvgpr_write_b32 a76, 0
  v_accvgpr_write_b32 a77, 0
  v_accvgpr_write_b32 a78, 0
  v_accvgpr_write_b32 a79, 0
  v_accvgpr_write_b32 a80, 0
  v_accvgpr_write_b32 a81, 0
  v_accvgpr_write_b32 a82, 0
  v_accvgpr_write_b32 a83, 0
  v_accvgpr_write_b32 a84, 0
  v_accvgpr_write_b32 a85, 0
  v_accvgpr_write_b32 a86, 0
  v_accvgpr_write_b32 a87, 0
  v_accvgpr_write_b32 a88, 0
  v_accvgpr_write_b32 a89, 0
  v_accvgpr_write_b32 a90, 0
  v_accvgpr_write_b32 a91, 0
  v_accvgpr_write_b32 a92, 0
  v_accvgpr_write_b32 a93, 0
  v_accvgpr_write_b32 a94, 0
  v_accvgpr_write_b32 a95, 0
  v_accvgpr_write_b32 a96, 0
  v_accvgpr_write_b32 a97, 0
  v_accvgpr_write_b32 a98, 0
  v_accvgpr_write_b32 a99, 0
  v_accvgpr_write_b32 a100, 0
  v_accvgpr_write_b32 a101, 0
  v_accvgpr_write_b32 a102, 0
  v_accvgpr_write_b32 a103, 0
  v_accvgpr_write_b32 a104, 0
  v_accvgpr_write_b32 a105, 0
  v_accvgpr_write_b32 a106, 0
  v_accvgpr_write_b32 a107, 0
  v_accvgpr_write_b32 a108, 0
  v_accvgpr_write_b32 a109, 0
  v_accvgpr_write_b32 a110, 0
  v_accvgpr_write_b32 a111, 0
  v_accvgpr_write_b32 a112, 0
  v_accvgpr_write_b32 a113, 0
  v_accvgpr_write_b32 a114, 0
  v_accvgpr_write_b32 a115, 0
  v_accvgpr_write_b32 a116, 0
  v_accvgpr_write_b32 a117, 0
  v_accvgpr_write_b32 a118, 0
  v_accvgpr_write_b32 a119, 0
  v_accvgpr_write_b32 a120, 0
  v_accvgpr_write_b32 a121, 0
  v_accvgpr_write_b32 a122, 0
  v_accvgpr_write_b32 a123, 0
  v_accvgpr_write_b32 a124, 0
  v_accvgpr_write_b32 a125, 0
  v_accvgpr_write_b32 a126, 0
  v_accvgpr_write_b32 a127, 0
  v_accvgpr_write_b32 a128, 0
  v_accvgpr_write_b32 a129, 0
  v_accvgpr_write_b32 a130, 0
  v_accvgpr_write_b32 a131, 0
  v_accvgpr_write_b32 a132, 0
  v_accvgpr_write_b32 a133, 0
  v_accvgpr_write_b32 a134, 0
  v_accvgpr_write_b32 a135, 0
  v_accvgpr_write_b32 a136, 0
  v_accvgpr_write_b32 a137, 0
  v_accvgpr_write_b32 a138, 0
  v_accvgpr_write_b32 a139, 0
  v_accvgpr_write_b32 a140, 0
  v_accvgpr_write_b32 a141, 0
  v_accvgpr_write_b32 a142, 0
  v_accvgpr_write_b32 a143, 0
  v_accvgpr_write_b32 a144, 0
  v_accvgpr_write_b32 a145, 0
  v_accvgpr_write_b32 a146, 0
  v_accvgpr_write_b32 a147, 0
  v_accvgpr_write_b32 a148, 0
  v_accvgpr_write_b32 a149, 0
  v_accvgpr_write_b32 a150, 0
  v_accvgpr_write_b32 a151, 0
  v_accvgpr_write_b32 a152, 0
  v_accvgpr_write_b32 a153, 0
  v_accvgpr_write_b32 a154, 0
  v_accvgpr_write_b32 a155, 0
  v_accvgpr_write_b32 a156, 0
  v_accvgpr_write_b32 a157, 0
  v_accvgpr_write_b32 a158, 0
  v_accvgpr_write_b32 a159, 0
  v_accvgpr_write_b32 a160, 0
  v_accvgpr_write_b32 a161, 0
  v_accvgpr_write_b32 a162, 0
  v_accvgpr_write_b32 a163, 0
  v_accvgpr_write_b32 a164, 0
  v_accvgpr_write_b32 a165, 0
  v_accvgpr_write_b32 a166, 0
  v_accvgpr_write_b32 a167, 0
  v_accvgpr_write_b32 a168, 0
  v_accvgpr_write_b32 a169, 0
  v_accvgpr_write_b32 a170, 0
  v_accvgpr_write_b32 a171, 0
  v_accvgpr_write_b32 a172, 0
  v_accvgpr_write_b32 a173, 0
  v_accvgpr_write_b32 a174, 0
  v_accvgpr_write_b32 a175, 0
  v_accvgpr_write_b32 a176, 0
  v_accvgpr_write_b32 a177, 0
  v_accvgpr_write_b32 a178, 0
  v_accvgpr_write_b32 a179, 0
  v_accvgpr_write_b32 a180, 0
  v_accvgpr_write_b32 a181, 0
  v_accvgpr_write_b32 a182, 0
  v_accvgpr_write_b32 a183, 0
  v_accvgpr_write_b32 a184, 0
  v_accvgpr_write_b32 a185, 0
  v_accvgpr_write_b32 a186, 0
  v_accvgpr_write_b32 a187, 0
  v_accvgpr_write_b32 a188, 0
  v_accvgpr_write_b32 a189, 0
  v_accvgpr_write_b32 a190, 0
  v_accvgpr_write_b32 a191, 0
  v_accvgpr_write_b32 a192, 0
  v_accvgpr_write_b32 a193, 0
  v_accvgpr_write_b32 a194, 0
  v_accvgpr_write_b32 a195, 0
  v_accvgpr_write_b32 a196, 0
  v_accvgpr_write_b32 a197, 0
  v_accvgpr_write_b32 a198, 0
  v_accvgpr_write_b32 a199, 0
  v_accvgpr_write_b32 a200, 0
  v_accvgpr_write_b32 a201, 0
  v_accvgpr_write_b32 a202, 0
  v_accvgpr_write_b32 a203, 0
  v_accvgpr_write_b32 a204, 0
  v_accvgpr_write_b32 a205, 0
  v_accvgpr_write_b32 a206, 0
  v_accvgpr_write_b32 a207, 0
  s_waitcnt lgkmcnt(12)
  v_readfirstlane_b32 s88, v12
  v_readfirstlane_b32 s89, v13
  s_nop 0
  v_mov_b32 v188, s88
  v_mov_b32 v189, s89
  s_waitcnt vmcnt(6)
  buffer_store_dwordx2 v[188:189], v1, s[4:7], s91 offen sc1
  s_add_u32 s91, s91, 4096
  v_and_b32 v2, 3, v0
  v_cmp_eq_u32 vcc, 0, v2
  v_mov_b32 v2, 0x3f803f80
  s_nop 0
  v_cndmask_b32 v12, 0, v2, vcc
  v_cndmask_b32 v13, 0, v2, vcc
  v_cndmask_b32 v14, 0, v2, vcc
  v_cndmask_b32 v15, 0, v2, vcc
  buffer_load_dwordx4 v[52:55], v152, s[8:11], s56 offen offset:192 sc0 sc1 nt
  buffer_load_dwordx4 v[56:59], v152, s[8:11], s56 offen offset:256 sc0 sc1 nt
  buffer_load_dwordx4 v[60:63], v152, s[8:11], s56 offen offset:320 sc0 sc1 nt
  s_add_u32 s56, s56, 6144
  buffer_load_dwordx4 a[208:211], v152, s[8:11], s56 offen offset:0 sc0 sc1 nt
  buffer_load_dwordx4 a[212:215], v152, s[8:11], s56 offen offset:64 sc0 sc1 nt
  buffer_load_dwordx4 a[216:219], v152, s[8:11], s56 offen offset:128 sc0 sc1 nt
  s_xor_b32 s79, s39, 1
  s_lshl_b32 s50, s79, 9
  buffer_load_dwordx2 v[144:145], v1, s[4:7], s50 offen sc1
  s_xor_b32 s79, s39, 2
  s_lshl_b32 s50, s79, 9
  buffer_load_dwordx2 v[146:147], v1, s[4:7], s50 offen sc1
  buffer_load_dwordx4 a[220:223], v152, s[8:11], s56 offen offset:192 sc0 sc1 nt
  buffer_load_dwordx4 a[224:227], v152, s[8:11], s56 offen offset:256 sc0 sc1 nt
  buffer_load_dwordx4 a[228:231], v152, s[8:11], s56 offen offset:320 sc0 sc1 nt
  s_add_u32 s56, s56, 6144
  buffer_load_dwordx4 a[232:235], v152, s[8:11], s56 offen offset:0 sc0 sc1 nt
  buffer_load_dwordx4 a[236:239], v152, s[8:11], s56 offen offset:64 sc0 sc1 nt
  buffer_load_dwordx4 a[240:243], v152, s[8:11], s56 offen offset:128 sc0 sc1 nt
  buffer_load_dwordx4 a[244:247], v152, s[8:11], s56 offen offset:192 sc0 sc1 nt
  buffer_load_dwordx4 a[248:251], v152, s[8:11], s56 offen offset:256 sc0 sc1 nt
  buffer_load_dwordx4 a[252:255], v152, s[8:11], s56 offen offset:320 sc0 sc1 nt
  s_xor_b32 s79, s39, 1
  s_waitcnt vmcnt(10)
  v_cmp_eq_u64 vcc, s[88:89], v[144:145]
  s_mul_i32 s40, s79, 24576
  s_waitcnt lgkmcnt(0)
  s_nop 3
  s_cbranch_vccnz L_go1
  s_mov_b32 s100, 0
  s_branch L_wait
L_ret0:
  ds_read_b128 v[64:67], v4 offset:0
  ds_read_b128 v[68:71], v4 offset:1024
  ds_read_b128 v[72:75], v4 offset:2048
  ds_read_b128 v[76:79], v4 offset:3072
  ds_read_b128 v[80:83], v4 offset:4096
  ds_read_b128 v[84:87], v4 offset:5120
  ds_read_b128 v[88:91], v4 offset:6144
  ds_read_b128 v[92:95], v4 offset:7168
  ds_read_b128 v[96:99], v4 offset:8192
  ds_read_b128 v[100:103], v4 offset:9216
  ds_read_b128 v[104:107], v4 offset:10240
  ds_read_b128 v[108:111], v4 offset:11264
  s_waitcnt lgkmcnt(0)
L_go1:
  s_add_u32 m0, s37, 12288
  s_nop 0
  buffer_load_dwordx4 v8, s[4:7], s40 offen offset:0 sc1 lds
  buffer_load_dwordx4 v8, s[4:7], s40 offen offset:1024 sc1 lds
  buffer_load_dwordx4 v8, s[4:7], s40 offen offset:2048 sc1 lds
  s_add_u32 m0, s37, 61440
  s_nop 0
  buffer_load_dwordx4 v9, s[4:7], s40 offen offset:0 sc1 lds
  buffer_load_dwordx4 v9, s[4:7], s40 offen offset:1024 sc1 lds
  buffer_load_dwordx4 v9, s[4:7], s40 offen offset:2048 sc1 lds
  s_xor_b32 s79, s39, 2
  s_waitcnt vmcnt(15)
  v_cmp_eq_u64 vcc, s[88:89], v[146:147]
  s_mul_i32 s48, s79, 24576
  s_waitcnt lgkmcnt(0)
  s_nop 3
  s_cbranch_vccnz L_go2
  s_mov_b32 s100, 1
  s_branch L_wait
L_ret1:
  ds_read_b128 v[64:67], v4 offset:0
  ds_read_b128 v[68:71], v4 offset:1024
  ds_read_b128 v[72:75], v4 offset:2048
  ds_read_b128 v[76:79], v4 offset:3072
  ds_read_b128 v[80:83], v4 offset:4096
  ds_read_b128 v[84:87], v4 offset:5120
  ds_read_b128 v[88:91], v4 offset:6144
  ds_read_b128 v[92:95], v4 offset:7168
  ds_read_b128 v[96:99], v4 offset:8192
  ds_read_b128 v[100:103], v4 offset:9216
  ds_read_b128 v[104:107], v4 offset:10240
  ds_read_b128 v[108:111], v4 offset:11264
  s_waitcnt lgkmcnt(0)
L_go2:
  s_xor_b32 s50, s76, 1536
  buffer_load_dwordx2 v[2:3], v1, s[4:7], s50 offen sc1
  s_add_u32 s50, s39, 8
  s_mul_i32 s45, s50, 24576
  s_add_u32 s49, s45, 12288
  s_mul_i32 s46, s50, 384
  s_lshl_b32 s47, s50, 6
  v_mfma_f32_16x16x32_bf16 v[136:139], v[64:67], v[16:19], 0
  v_mfma_f32_16x16x32_bf16 v[136:139], v[68:71], v[20:23], v[136:139]
  v_mfma_f32_16x16x32_bf16 v[136:139], v[72:75], v[24:27], v[136:139]
  v_mfma_f32_16x16x32_bf16 v[136:139], v[76:79], v[28:31], v[136:139]
  v_mfma_f32_16x16x32_bf16 v[136:139], v[80:83], v[32:35], v[136:139]
  v_mfma_f32_16x16x32_bf16 v[136:139], v[84:87], v[36:39], v[136:139]
  v_mfma_f32_16x16x32_bf16 v[144:147], v[64:67], v[40:43], 0
  v_mfma_f32_16x16x32_bf16 v[144:147], v[68:71], v[44:47], v[144:147]
  v_mfma_f32_16x16x32_bf16 v[144:147], v[72:75], v[48:51], v[144:147]
  v_mfma_f32_16x16x32_bf16 v[144:147], v[76:79], v[52:55], v[144:147]
  v_mfma_f32_16x16x32_bf16 v[144:147], v[80:83], v[56:59], v[144:147]
  v_mfma_f32_16x16x32_bf16 v[144:147], v[84:87], v[60:63], v[144:147]
  v_mfma_f32_16x16x32_bf16 v[152:155], v[64:67], a[208:211], 0
  v_mfma_f32_16x16x32_bf16 v[152:155], v[68:71], a[212:215], v[152:155]
  v_mfma_f32_16x16x32_bf16 v[152:155], v[72:75], a[216:219], v[152:155]
  s_waitcnt vmcnt(15)
  v_mfma_f32_16x16x32_bf16 v[152:155], v[76:79], a[220:223], v[152:155]
  s_waitcnt vmcnt(14)
  v_mfma_f32_16x16x32_bf16 v[152:155], v[80:83], a[224:227], v[152:155]
  s_waitcnt vmcnt(13)
  v_mfma_f32_16x16x32_bf16 v[152:155], v[84:87], a[228:231], v[152:155]
  s_waitcnt vmcnt(12)
  v_mfma_f32_16x16x32_bf16 v[160:163], v[64:67], a[232:235], 0
  s_waitcnt vmcnt(11)
  v_mfma_f32_16x16x32_bf16 v[160:163], v[68:71], a[236:239], v[160:163]
  s_waitcnt vmcnt(10)
  v_mfma_f32_16x16x32_bf16 v[160:163], v[72:75], a[240:243], v[160:163]
  s_waitcnt vmcnt(9)
  v_mfma_f32_16x16x32_bf16 v[160:163], v[76:79], a[244:247], v[160:163]
  s_waitcnt vmcnt(8)
  v_mfma_f32_16x16x32_bf16 v[160:163], v[80:83], a[248:251], v[160:163]
  s_waitcnt vmcnt(7)
  v_mfma_f32_16x16x32_bf16 v[160:163], v[84:87], a[252:255], v[160:163]
  v_max3_f32 v112, v136, v137, v138
  v_max_f32 v112, v112, v139
  v_mov_b32 v113, v112
  v_max3_f32 v116, v144, v145, v146
  v_max_f32 v116, v116, v147
  v_mov_b32 v117, v116
  v_max3_f32 v120, v152, v153, v154
  v_max_f32 v120, v120, v155
  v_mov_b32 v121, v120
  v_max3_f32 v124, v160, v161, v162
  v_max_f32 v124, v124, v163
  v_mov_b32 v125, v124
  v_permlane32_swap_b32 v112, v113
  v_permlane32_swap_b32 v116, v117
  v_permlane32_swap_b32 v120, v121
  v_permlane32_swap_b32 v124, v125
  v_max_f32 v112, v112, v113
  v_mov_b32 v113, v112
  v_max_f32 v116, v116, v117
  v_mov_b32 v117, v116
  v_max_f32 v120, v120, v121
  v_mov_b32 v121, v120
  v_max_f32 v124, v124, v125
  v_mov_b32 v125, v124
  v_permlane16_swap_b32 v112, v113
  v_permlane16_swap_b32 v116, v117
  v_permlane16_swap_b32 v120, v121
  v_permlane16_swap_b32 v124, v125
  v_max_f32 v112, v112, v113
  v_sub_f32 v168, 0xc2200000, v112
  v_mov_b32 v169, v168
  v_mov_b32 v170, v168
  v_mov_b32 v171, v168
  v_max_f32 v116, v116, v117
  v_sub_f32 v172, 0xc2200000, v116
  v_mov_b32 v173, v172
  v_mov_b32 v174, v172
  v_mov_b32 v175, v172
  v_max_f32 v120, v120, v121
  v_sub_f32 v176, 0xc2200000, v120
  v_mov_b32 v177, v176
  v_mov_b32 v178, v176
  v_mov_b32 v179, v176
  v_max_f32 v124, v124, v125
  v_sub_f32 v180, 0xc2200000, v124
  v_mov_b32 v181, v180
  v_mov_b32 v182, v180
  v_mov_b32 v183, v180
  s_add_u32 m0, s37, 24576
  s_nop 0
  buffer_load_dwordx4 v8, s[4:7], s48 offen offset:0 sc1 lds
  buffer_load_dwordx4 v8, s[4:7], s48 offen offset:1024 sc1 lds
  buffer_load_dwordx4 v8, s[4:7], s48 offen offset:2048 sc1 lds
  s_add_u32 m0, s37, 73728
  s_nop 0
  buffer_load_dwordx4 v9, s[4:7], s48 offen offset:0 sc1 lds
  buffer_load_dwordx4 v9, s[4:7], s48 offen offset:1024 sc1 lds
  buffer_load_dwordx4 v9, s[4:7], s48 offen offset:2048 sc1 lds
  s_xor_b32 s50, s76, 1536
  s_mul_i32 s40, s50, 48
  s_xor_b32 s50, s76, 2048
  s_mul_i32 s48, s50, 48
  s_mov_b32 s3, 2048
.p2align 6
L_loopA:
  v_mfma_f32_16x16x32_bf16 v[136:139], v[64:67], v[16:19], v[168:171]
  buffer_load_dwordx4 v[224:227], v184, s[12:15], s45 offen offset:0 sc0 sc1 nt
  v_mfma_f32_16x16x32_bf16 v[136:139], v[68:71], v[20:23], v[136:139]
  ds_read_b128 v[112:115], v5 offset:0
  v_mfma_f32_16x16x32_bf16 v[136:139], v[72:75], v[24:27], v[136:139]
  buffer_load_dwordx4 v[228:231], v184, s[12:15], s45 offen offset:16 sc0 sc1 nt
  v_mfma_f32_16x16x32_bf16 v[136:139], v[76:79], v[28:31], v[136:139]
  ds_read_b128 v[116:119], v5 offset:256
  v_mfma_f32_16x16x32_bf16 v[136:139], v[80:83], v[32:35], v[136:139]
  buffer_load_dwordx4 v[232:235], v185, s[24:27], s46 offen offset:0
  v_mfma_f32_16x16x32_bf16 v[136:139], v[84:87], v[36:39], v[136:139]
  ds_read_b128 v[120:123], v5 offset:512
  v_mfma_f32_16x16x32_bf16 v[140:143], v[88:91], v[16:19], v[168:171]
  buffer_load_dwordx4 v[236:239], v185, s[20:23], s46 offen offset:0
  v_mfma_f32_16x16x32_bf16 v[140:143], v[92:95], v[20:23], v[140:143]
  ds_read_b128 v[124:127], v5 offset:768
  v_mfma_f32_16x16x32_bf16 v[140:143], v[96:99], v[24:27], v[140:143]
  buffer_load_dwordx4 v[240:243], v184, s[12:15], s45 offen offset:128 sc0 sc1 nt
  v_mfma_f32_16x16x32_bf16 v[140:143], v[100:103], v[28:31], v[140:143]
  ds_read_b128 v[128:131], v5 offset:1024
  v_mfma_f32_16x16x32_bf16 v[140:143], v[104:107], v[32:35], v[140:143]
  buffer_load_dwordx4 v[244:247], v184, s[12:15], s45 offen offset:144 sc0 sc1 nt
  v_mfma_f32_16x16x32_bf16 v[140:143], v[108:111], v[36:39], v[140:143]
  ds_read_b128 v[132:135], v5 offset:1280
  v_mfma_f32_16x16x32_bf16 v[144:147], v[64:67], v[40:43], v[172:175]
  v_exp_f32 v136, v136
  v_mfma_f32_16x16x32_bf16 v[144:147], v[68:71], v[44:47], v[144:147]
  v_exp_f32 v137, v137
  v_mfma_f32_16x16x32_bf16 v[144:147], v[72:75], v[48:51], v[144:147]
  v_exp_f32 v138, v138
  v_mfma_f32_16x16x32_bf16 v[144:147], v[76:79], v[52:55], v[144:147]
  v_exp_f32 v139, v139
  v_mfma_f32_16x16x32_bf16 v[144:147], v[80:83], v[56:59], v[144:147]
  v_cvt_pk_bf16_f32 v136, v136, v137
  v_cvt_pk_bf16_f32 v137, v138, v139
  v_mfma_f32_16x16x32_bf16 v[144:147], v[84:87], v[60:63], v[144:147]
  v_exp_f32 v140, v140
  v_mfma_f32_16x16x32_bf16 v[148:151], v[88:91], v[40:43], v[172:175]
  v_exp_f32 v141, v141
  v_mfma_f32_16x16x32_bf16 v[148:151], v[92:95], v[44:47], v[148:151]
  v_exp_f32 v142, v142
  v_mfma_f32_16x16x32_bf16 v[148:151], v[96:99], v[48:51], v[148:151]
  v_exp_f32 v143, v143
  v_mfma_f32_16x16x32_bf16 v[148:151], v[100:103], v[52:55], v[148:151]
  v_cvt_pk_bf16_f32 v138, v140, v141
  v_cvt_pk_bf16_f32 v139, v142, v143
  v_mfma_f32_16x16x32_bf16 v[148:151], v[104:107], v[56:59], v[148:151]
  s_add_u32 s3, s3, 512
  v_mfma_f32_16x16x32_bf16 v[148:151], v[108:111], v[60:63], v[148:151]
  s_xor_b32 s90, s3, s76
  buffer_load_dwordx4 v[248:251], v185, s[24:27], s46 offen offset:64
  v_mfma_f32_16x16x32_bf16 v[152:155], v[64:67], a[208:211], v[176:179]
  v_exp_f32 v144, v144
  v_mfma_f32_16x16x32_bf16 v[152:155], v[68:71], a[212:215], v[152:155]
  v_exp_f32 v145, v145
  v_mfma_f32_16x16x32_bf16 v[152:155], v[72:75], a[216:219], v[152:155]
  v_exp_f32 v146, v146
  v_mfma_f32_16x16x32_bf16 v[152:155], v[76:79], a[220:223], v[152:155]
  v_exp_f32 v147, v147
  v_mfma_f32_16x16x32_bf16 v[152:155], v[80:83], a[224:227], v[152:155]
  v_cvt_pk_bf16_f32 v144, v144, v145
  v_cvt_pk_bf16_f32 v145, v146, v147
  v_mfma_f32_16x16x32_bf16 v[152:155], v[84:87], a[228:231], v[152:155]
  v_exp_f32 v148, v148
  v_mfma_f32_16x16x32_bf16 v[156:159], v[88:91], a[208:211], v[176:179]
  v_exp_f32 v149, v149
  s_xor_b32 s50, s76, 2048
  buffer_load_dwordx2 v[6:7], v1, s[4:7], s50 offen sc1
  v_mfma_f32_16x16x32_bf16 v[156:159], v[92:95], a[212:215], v[156:159]
  v_exp_f32 v150, v150
  v_mfma_f32_16x16x32_bf16 v[156:159], v[96:99], a[216:219], v[156:159]
  v_exp_f32 v151, v151
  v_mfma_f32_16x16x32_bf16 v[156:159], v[100:103], a[220:223], v[156:159]
  v_cvt_pk_bf16_f32 v146, v148, v149
  v_cvt_pk_bf16_f32 v147, v150, v151
  v_mfma_f32_16x16x32_bf16 v[156:159], v[104:107], a[224:227], v[156:159]
  s_and_b32 s90, s90, 0x7e00
  v_mfma_f32_16x16x32_bf16 v[156:159], v[108:111], a[228:231], v[156:159]
  v_mfma_f32_16x16x32_bf16 v[160:163], v[64:67], a[232:235], v[180:183]
  v_exp_f32 v152, v152
  v_mfma_f32_16x16x32_bf16 v[160:163], v[68:71], a[236:239], v[160:163]
  v_exp_f32 v153, v153
  v_mfma_f32_16x16x32_bf16 v[160:163], v[72:75], a[240:243], v[160:163]
  v_exp_f32 v154, v154
  v_mfma_f32_16x16x32_bf16 v[160:163], v[76:79], a[244:247], v[160:163]
  v_exp_f32 v155, v155
  v_mfma_f32_16x16x32_bf16 v[160:163], v[80:83], a[248:251], v[160:163]
  v_cvt_pk_bf16_f32 v152, v152, v153
  v_cvt_pk_bf16_f32 v153, v154, v155
  v_mfma_f32_16x16x32_bf16 v[160:163], v[84:87], a[252:255], v[160:163]
  v_exp_f32 v156, v156
  v_mfma_f32_16x16x32_bf16 v[164:167], v[88:91], a[232:235], v[180:183]
  v_exp_f32 v157, v157
  v_mfma_f32_16x16x32_bf16 v[164:167], v[92:95], a[236:239], v[164:167]
  v_exp_f32 v158, v158
  v_mfma_f32_16x16x32_bf16 v[164:167], v[96:99], a[240:243], v[164:167]
  v_exp_f32 v159, v159
  v_mfma_f32_16x16x32_bf16 v[164:167], v[100:103], a[244:247], v[164:167]
  v_cvt_pk_bf16_f32 v154, v156, v157
  v_cvt_pk_bf16_f32 v155, v158, v159
  v_mfma_f32_16x16x32_bf16 v[164:167], v[104:107], a[248:251], v[164:167]
  buffer_load_dwordx4 v[252:255], v185, s[20:23], s46 offen offset:64
  s_waitcnt lgkmcnt(0)
  v_mfma_f32_16x16x32_bf16 v[164:167], v[108:111], a[252:255], v[164:167]
  buffer_load_short_d16_hi v10, v187, s[32:35], s47 offen
  v_mfma_f32_16x16x32_bf16 a[0:3], v[112:115], v[136:139], a[0:3]
  v_exp_f32 v160, v160
  v_mfma_f32_16x16x32_bf16 a[4:7], v[112:115], v[144:147], a[4:7]
  v_exp_f32 v161, v161
  v_mfma_f32_16x16x32_bf16 a[8:11], v[112:115], v[152:155], a[8:11]
  v_exp_f32 v162, v162
  v_mfma_f32_16x16x32_bf16 a[16:19], v[116:119], v[136:139], a[16:19]
  v_exp_f32 v163, v163
  v_mfma_f32_16x16x32_bf16 a[20:23], v[116:119], v[144:147], a[20:23]
  v_cvt_pk_bf16_f32 v160, v160, v161
  v_cvt_pk_bf16_f32 v161, v162, v163
  v_mfma_f32_16x16x32_bf16 a[24:27], v[116:119], v[152:155], a[24:27]
  v_exp_f32 v164, v164
  v_mfma_f32_16x16x32_bf16 a[32:35], v[120:123], v[136:139], a[32:35]
  v_exp_f32 v165, v165
  v_mfma_f32_16x16x32_bf16 a[36:39], v[120:123], v[144:147], a[36:39]
  v_exp_f32 v166, v166
  v_mfma_f32_16x16x32_bf16 a[40:43], v[120:123], v[152:155], a[40:43]
  v_exp_f32 v167, v167
  v_mfma_f32_16x16x32_bf16 a[48:51], v[124:127], v[136:139], a[48:51]
  v_cvt_pk_bf16_f32 v162, v164, v165
  v_cvt_pk_bf16_f32 v163, v166, v167
  v_mfma_f32_16x16x32_bf16 a[52:55], v[124:127], v[144:147], a[52:55]
  s_waitcnt vmcnt(16)
  v_cmp_eq_u64 vcc, s[88:89], v[2:3]
  s_add_u32 m0, s37, 36864
  v_mfma_f32_16x16x32_bf16 a[56:59], v[124:127], v[152:155], a[56:59]
  s_barrier
  v_mfma_f32_16x16x32_bf16 a[192:195], v[12:15], v[136:139], a[192:195]
  s_cbranch_vccz L_slow2
L_ret2:
  buffer_load_dwordx2 v[2:3], v1, s[4:7], s90 offen sc1
  v_mfma_f32_16x16x32_bf16 a[196:199], v[12:15], v[144:147], a[196:199]
  ds_read_b128 v[64:67], v4 offset:12288
  v_mfma_f32_16x16x32_bf16 a[200:203], v[12:15], v[152:155], a[200:203]
  buffer_load_dwordx4 v8, s[4:7], s40 offen offset:0 sc1 lds
  v_mfma_f32_16x16x32_bf16 a[12:15], v[112:115], v[160:163], a[12:15]
  ds_read_b128 v[68:71], v4 offset:13312
  buffer_load_short_d16_hi v11, v187, s[28:31], s47 offen
  v_mfma_f32_16x16x32_bf16 a[28:31], v[116:119], v[160:163], a[28:31]
  ds_read_b128 v[112:115], v5 offset:1536
  v_mfma_f32_16x16x32_bf16 a[44:47], v[120:123], v[160:163], a[44:47]
  ds_read_b128 v[116:119], v5 offset:1792
  v_mfma_f32_16x16x32_bf16 a[60:63], v[124:127], v[160:163], a[60:63]
  ds_read_b128 v[120:123], v5 offset:2048
  buffer_load_dwordx3 v[192:194], v186, s[16:19], s45 offen offset:0 sc0 sc1 nt
  v_mfma_f32_16x16x32_bf16 a[204:207], v[12:15], v[160:163], a[204:207]
  ds_read_b128 v[124:127], v5 offset:2304
  v_mfma_f32_16x16x32_bf16 a[64:67], v[128:131], v[136:139], a[64:67]
  ds_read_b128 v[72:75], v4 offset:14336
  v_mfma_f32_16x16x32_bf16 a[68:71], v[128:131], v[144:147], a[68:71]
  ds_read_b128 v[76:79], v4 offset:15360
  v_mfma_f32_16x16x32_bf16 a[72:75], v[128:131], v[152:155], a[72:75]
  buffer_load_dwordx4 v8, s[4:7], s40 offen offset:1024 sc1 lds
  buffer_load_dwordx3 v[196:198], v186, s[16:19], s45 offen offset:768 sc0 sc1 nt
  v_mfma_f32_16x16x32_bf16 a[76:79], v[128:131], v[160:163], a[76:79]
  ds_read_b128 v[80:83], v4 offset:16384
  v_mfma_f32_16x16x32_bf16 a[80:83], v[132:135], v[136:139], a[80:83]
  ds_read_b128 v[128:131], v5 offset:2560
  v_mfma_f32_16x16x32_bf16 a[84:87], v[132:135], v[144:147], a[84:87]
  ds_read_b128 v[84:87], v4 offset:17408
  buffer_load_dwordx3 v[200:202], v186, s[16:19], s45 offen offset:1536 sc0 sc1 nt
  v_mfma_f32_16x16x32_bf16 a[88:91], v[132:135], v[152:155], a[88:91]
  ds_read_b128 v[88:91], v4 offset:18432
  v_mfma_f32_16x16x32_bf16 a[92:95], v[132:135], v[160:163], a[92:95]
  ds_read_b128 v[92:95], v4 offset:19456
  s_waitcnt lgkmcnt(10)
  v_mfma_f32_16x16x32_bf16 a[96:99], v[112:115], v[136:139], a[96:99]
  ds_read_b128 v[132:135], v5 offset:2816
  buffer_load_dwordx3 v[204:206], v186, s[16:19], s45 offen offset:2304 sc0 sc1 nt
  v_mfma_f32_16x16x32_bf16 a[100:103], v[112:115], v[144:147], a[100:103]
  ds_read_b128 v[96:99], v4 offset:20480
  v_mfma_f32_16x16x32_bf16 a[104:107], v[112:115], v[152:155], a[104:107]
  buffer_load_dwordx4 v8, s[4:7], s40 offen offset:2048 sc1 lds
  v_mfma_f32_16x16x32_bf16 a[108:111], v[112:115], v[160:163], a[108:111]
  ds_read_b128 v[100:103], v4 offset:21504
  s_waitcnt lgkmcnt(10)
  v_mfma_f32_16x16x32_bf16 a[112:115], v[116:119], v[136:139], a[112:115]
  s_add_u32 m0, s37, 86016
  buffer_load_dwordx3 v[208:210], v186, s[16:19], s49 offen offset:0 sc0 sc1 nt
  v_mfma_f32_16x16x32_bf16 a[116:119], v[116:119], v[144:147], a[116:119]
  ds_read_b128 v[104:107], v4 offset:22528
  v_mfma_f32_16x16x32_bf16 a[120:123], v[116:119], v[152:155], a[120:123]
  buffer_load_dwordx3 v[212:214], v186, s[16:19], s49 offen offset:768 sc0 sc1 nt
  v_mfma_f32_16x16x32_bf16 a[124:127], v[116:119], v[160:163], a[124:127]
  ds_read_b128 v[108:111], v4 offset:23552
  v_mfma_f32_16x16x32_bf16 a[128:131], v[120:123], v[136:139], a[128:131]
  buffer_load_dwordx3 v[216:218], v186, s[16:19], s49 offen offset:1536 sc0 sc1 nt
  v_mfma_f32_16x16x32_bf16 a[132:135], v[120:123], v[144:147], a[132:135]
  v_mfma_f32_16x16x32_bf16 a[136:139], v[120:123], v[152:155], a[136:139]
  buffer_load_dwordx4 v9, s[4:7], s40 offen offset:0 sc1 lds
  buffer_load_dwordx3 v[220:222], v186, s[16:19], s49 offen offset:2304 sc0 sc1 nt
  v_mfma_f32_16x16x32_bf16 a[140:143], v[120:123], v[160:163], a[140:143]
  v_mfma_f32_16x16x32_bf16 a[144:147], v[124:127], v[136:139], a[144:147]
  s_mov_b32 s77, s45
  v_mfma_f32_16x16x32_bf16 a[148:151], v[124:127], v[144:147], a[148:151]
  v_mfma_f32_16x16x32_bf16 a[152:155], v[124:127], v[152:155], a[152:155]
  s_mov_b32 s78, s46
  v_mfma_f32_16x16x32_bf16 a[156:159], v[124:127], v[160:163], a[156:159]
  s_add_u32 s45, s45, 196608
  s_waitcnt lgkmcnt(4)
  v_mfma_f32_16x16x32_bf16 a[160:163], v[128:131], v[136:139], a[160:163]
  buffer_load_dwordx4 v9, s[4:7], s40 offen offset:1024 sc1 lds
  v_mfma_f32_16x16x32_bf16 a[164:167], v[128:131], v[144:147], a[164:167]
  v_mfma_f32_16x16x32_bf16 a[168:171], v[128:131], v[152:155], a[168:171]
  s_add_u32 s49, s49, 196608
  v_mfma_f32_16x16x32_bf16 a[172:175], v[128:131], v[160:163], a[172:175]
  s_add_u32 s46, s46, 3072
  v_mfma_f32_16x16x32_bf16 a[176:179], v[132:135], v[136:139], a[176:179]
  v_mfma_f32_16x16x32_bf16 a[180:183], v[132:135], v[144:147], a[180:183]
  s_add_u32 s47, s47, 512
  v_mfma_f32_16x16x32_bf16 a[184:187], v[132:135], v[152:155], a[184:187]
  buffer_load_dwordx4 v9, s[4:7], s40 offen offset:2048 sc1 lds
  v_mfma_f32_16x16x32_bf16 a[188:191], v[132:135], v[160:163], a[188:191]
  s_mul_i32 s40, s90, 48
  v_mfma_f32_16x16x32_bf16 v[136:139], v[64:67], v[16:19], v[168:171]
  v_mfma_f32_16x16x32_bf16 v[136:139], v[68:71], v[20:23], v[136:139]
  ds_read_b128 v[112:115], v5 offset:12288
  v_mfma_f32_16x16x32_bf16 v[136:139], v[72:75], v[24:27], v[136:139]
  v_mfma_f32_16x16x32_bf16 v[136:139], v[76:79], v[28:31], v[136:139]
  ds_read_b128 v[116:119], v5 offset:12544
  s_waitcnt lgkmcnt(2)
  v_mfma_f32_16x16x32_bf16 v[136:139], v[80:83], v[32:35], v[136:139]
  v_mfma_f32_16x16x32_bf16 v[136:139], v[84:87], v[36:39], v[136:139]
  ds_read_b128 v[120:123], v5 offset:12800
  v_mfma_f32_16x16x32_bf16 v[140:143], v[88:91], v[16:19], v[168:171]
  v_mfma_f32_16x16x32_bf16 v[140:143], v[92:95], v[20:23], v[140:143]
  ds_read_b128 v[124:127], v5 offset:13056
  v_mfma_f32_16x16x32_bf16 v[140:143], v[96:99], v[24:27], v[140:143]
  v_mfma_f32_16x16x32_bf16 v[140:143], v[100:103], v[28:31], v[140:143]
  ds_read_b128 v[128:131], v5 offset:13312
  v_mfma_f32_16x16x32_bf16 v[140:143], v[104:107], v[32:35], v[140:143]
  v_mfma_f32_16x16x32_bf16 v[140:143], v[108:111], v[36:39], v[140:143]
  ds_read_b128 v[132:135], v5 offset:13568
  v_mfma_f32_16x16x32_bf16 v[144:147], v[64:67], v[40:43], v[172:175]
  v_exp_f32 v136, v136
  v_mfma_f32_16x16x32_bf16 v[144:147], v[68:71], v[44:47], v[144:147]
  v_exp_f32 v137, v137
  v_mfma_f32_16x16x32_bf16 v[144:147], v[72:75], v[48:51], v[144:147]
  v_exp_f32 v138, v138
  v_mfma_f32_16x16x32_bf16 v[144:147], v[76:79], v[52:55], v[144:147]
  v_exp_f32 v139, v139
  v_mfma_f32_16x16x32_bf16 v[144:147], v[80:83], v[56:59], v[144:147]
  v_cvt_pk_bf16_f32 v136, v136, v137
  v_cvt_pk_bf16_f32 v137, v138, v139
  v_mfma_f32_16x16x32_bf16 v[144:147], v[84:87], v[60:63], v[144:147]
  v_exp_f32 v140, v140
  v_mfma_f32_16x16x32_bf16 v[148:151], v[88:91], v[40:43], v[172:175]
  v_exp_f32 v141, v141
  v_mfma_f32_16x16x32_bf16 v[148:151], v[92:95], v[44:47], v[148:151]
  v_exp_f32 v142, v142
  v_mfma_f32_16x16x32_bf16 v[148:151], v[96:99], v[48:51], v[148:151]
  v_exp_f32 v143, v143
  v_mfma_f32_16x16x32_bf16 v[148:151], v[100:103], v[52:55], v[148:151]
  v_cvt_pk_bf16_f32 v138, v140, v141
  v_cvt_pk_bf16_f32 v139, v142, v143
  v_mfma_f32_16x16x32_bf16 v[148:151], v[104:107], v[56:59], v[148:151]
  s_add_u32 s3, s3, 512
  v_mfma_f32_16x16x32_bf16 v[148:151], v[108:111], v[60:63], v[148:151]
  s_xor_b32 s90, s3, s76
  v_mfma_f32_16x16x32_bf16 v[152:155], v[64:67], a[208:211], v[176:179]
  v_exp_f32 v144, v144
  v_mfma_f32_16x16x32_bf16 v[152:155], v[68:71], a[212:215], v[152:155]
  v_exp_f32 v145, v145
  v_mfma_f32_16x16x32_bf16 v[152:155], v[72:75], a[216:219], v[152:155]
  v_exp_f32 v146, v146
  v_mfma_f32_16x16x32_bf16 v[152:155], v[76:79], a[220:223], v[152:155]
  v_exp_f32 v147, v147
  v_mfma_f32_16x16x32_bf16 v[152:155], v[80:83], a[224:227], v[152:155]
  v_cvt_pk_bf16_f32 v144, v144, v145
  v_cvt_pk_bf16_f32 v145, v146, v147
  v_mfma_f32_16x16x32_bf16 v[152:155], v[84:87], a[228:231], v[152:155]
  v_exp_f32 v148, v148
  v_mfma_f32_16x16x32_bf16 v[156:159], v[88:91], a[208:211], v[176:179]
  v_exp_f32 v149, v149
  s_waitcnt vmcnt(25)
  v_cvt_f32_i32 v224, v224
  v_mfma_f32_16x16x32_bf16 v[156:159], v[92:95], a[212:215], v[156:159]
  v_exp_f32 v150, v150
  v_cvt_f32_i32 v225, v225
  v_mfma_f32_16x16x32_bf16 v[156:159], v[96:99], a[216:219], v[156:159]
  v_exp_f32 v151, v151
  s_waitcnt vmcnt(23)
  v_lshlrev_b32 v188, 16, v232
  v_mfma_f32_16x16x32_bf16 v[156:159], v[100:103], a[220:223], v[156:159]
  v_cvt_pk_bf16_f32 v146, v148, v149
  v_cvt_pk_bf16_f32 v147, v150, v151
  v_and_b32 v189, s44, v232
  v_mfma_f32_16x16x32_bf16 v[156:159], v[104:107], a[224:227], v[156:159]
  s_and_b32 s90, s90, 0x7e00
  v_cvt_pk_bf16_f32 v224, 0, v224
  v_mfma_f32_16x16x32_bf16 v[156:159], v[108:111], a[228:231], v[156:159]
  v_cvt_pk_bf16_f32 v225, 0, v225
  s_waitcnt vmcnt(22)
  v_lshlrev_b32 v190, 16, v236
  v_mfma_f32_16x16x32_bf16 v[160:163], v[64:67], a[232:235], v[180:183]
  v_exp_f32 v152, v152
  v_and_b32 v191, s44, v236
  v_mfma_f32_16x16x32_bf16 v[160:163], v[68:71], a[236:239], v[160:163]
  v_exp_f32 v153, v153
  v_subrev_f32 v224, v188, v224
  v_mfma_f32_16x16x32_bf16 v[160:163], v[72:75], a[240:243], v[160:163]
  v_exp_f32 v154, v154
  v_subrev_f32 v225, v189, v225
  v_mfma_f32_16x16x32_bf16 v[160:163], v[76:79], a[244:247], v[160:163]
  v_exp_f32 v155, v155
  v_mfma_f32_16x16x32_bf16 v[160:163], v[80:83], a[248:251], v[160:163]
  v_cvt_pk_bf16_f32 v152, v152, v153
  v_cvt_pk_bf16_f32 v153, v154, v155
  v_mul_f32 v190, s42, v190
  v_mfma_f32_16x16x32_bf16 v[160:163], v[84:87], a[252:255], v[160:163]
  v_exp_f32 v156, v156
  v_mul_f32 v191, s43, v191
  v_mfma_f32_16x16x32_bf16 v[164:167], v[88:91], a[232:235], v[180:183]
  v_exp_f32 v157, v157
  v_cvt_pk_bf16_f32 v224, 0, v224
  v_mfma_f32_16x16x32_bf16 v[164:167], v[92:95], a[236:239], v[164:167]
  v_exp_f32 v158, v158
  v_mfma_f32_16x16x32_bf16 v[164:167], v[96:99], a[240:243], v[164:167]
  v_exp_f32 v159, v159
  v_cvt_pk_bf16_f32 v225, 0, v225
  v_mfma_f32_16x16x32_bf16 v[164:167], v[100:103], a[244:247], v[164:167]
  v_cvt_pk_bf16_f32 v154, v156, v157
  v_cvt_pk_bf16_f32 v155, v158, v159
  v_mul_f32 v224, v190, v224
  v_mfma_f32_16x16x32_bf16 v[164:167], v[104:107], a[248:251], v[164:167]
  v_mul_f32 v225, v191, v225
  v_cvt_pk_bf16_f32 v232, v224, v225
  s_waitcnt lgkmcnt(0)
  v_mfma_f32_16x16x32_bf16 v[164:167], v[108:111], a[252:255], v[164:167]
  v_cvt_f32_i32 v226, v226
  v_cvt_f32_i32 v227, v227
  v_mfma_f32_16x16x32_bf16 a[0:3], v[112:115], v[136:139], a[0:3]
  v_exp_f32 v160, v160
  v_lshlrev_b32 v188, 16, v233
  v_mfma_f32_16x16x32_bf16 a[4:7], v[112:115], v[144:147], a[4:7]
  v_exp_f32 v161, v161
  v_and_b32 v189, s44, v233
  v_mfma_f32_16x16x32_bf16 a[8:11], v[112:115], v[152:155], a[8:11]
  v_exp_f32 v162, v162
  v_cvt_pk_bf16_f32 v226, 0, v226
  v_mfma_f32_16x16x32_bf16 a[16:19], v[116:119], v[136:139], a[16:19]
  v_exp_f32 v163, v163
  v_cvt_pk_bf16_f32 v227, 0, v227
  v_mfma_f32_16x16x32_bf16 a[20:23], v[116:119], v[144:147], a[20:23]
  v_cvt_pk_bf16_f32 v160, v160, v161
  v_cvt_pk_bf16_f32 v161, v162, v163
  v_mfma_f32_16x16x32_bf16 a[24:27], v[116:119], v[152:155], a[24:27]
  v_exp_f32 v164, v164
  v_lshlrev_b32 v190, 16, v237
  v_mfma_f32_16x16x32_bf16 a[32:35], v[120:123], v[136:139], a[32:35]
  v_exp_f32 v165, v165
  v_and_b32 v191, s44, v237
  v_mfma_f32_16x16x32_bf16 a[36:39], v[120:123], v[144:147], a[36:39]
  v_exp_f32 v166, v166
  v_subrev_f32 v226, v188, v226
  v_mfma_f32_16x16x32_bf16 a[40:43], v[120:123], v[152:155], a[40:43]
  v_exp_f32 v167, v167
  v_mfma_f32_16x16x32_bf16 a[48:51], v[124:127], v[136:139], a[48:51]
  v_cvt_pk_bf16_f32 v162, v164, v165
  v_cvt_pk_bf16_f32 v163, v166, v167
  v_subrev_f32 v227, v189, v227
  v_mfma_f32_16x16x32_bf16 a[52:55], v[124:127], v[144:147], a[52:55]
  s_waitcnt vmcnt(18)
  v_cmp_eq_u64 vcc, s[88:89], v[6:7]
  s_add_u32 m0, s37, 0
  v_mul_f32 v190, s42, v190
  v_mfma_f32_16x16x32_bf16 a[56:59], v[124:127], v[152:155], a[56:59]
  s_barrier
  v_mfma_f32_16x16x32_bf16 a[192:195], v[12:15], v[136:139], a[192:195]
  s_cbranch_vccz L_slow3
L_ret3:
  buffer_load_dwordx2 v[6:7], v1, s[4:7], s90 offen sc1
  v_mfma_f32_16x16x32_bf16 a[196:199], v[12:15], v[144:147], a[196:199]
  ds_read_b128 v[64:67], v4 offset:24576
  v_mul_f32 v191, s43, v191
  v_mfma_f32_16x16x32_bf16 a[200:203], v[12:15], v[152:155], a[200:203]
  buffer_load_dwordx4 v8, s[4:7], s48 offen offset:0 sc1 lds
  v_cvt_pk_bf16_f32 v226, 0, v226
  v_cvt_pk_bf16_f32 v227, 0, v227
  v_mfma_f32_16x16x32_bf16 a[12:15], v[112:115], v[160:163], a[12:15]
  ds_read_b128 v[68:71], v4 offset:25600
  v_mul_f32 v226, v190, v226
  v_mfma_f32_16x16x32_bf16 a[28:31], v[116:119], v[160:163], a[28:31]
  ds_read_b128 v[112:115], v5 offset:13824
  v_mul_f32 v227, v191, v227
  v_cvt_pk_bf16_f32 v233, v226, v227
  v_mfma_f32_16x16x32_bf16 a[44:47], v[120:123], v[160:163], a[44:47]
  ds_read_b128 v[116:119], v5 offset:14080
  v_cvt_f32_i32 v228, v228
  v_mfma_f32_16x16x32_bf16 a[60:63], v[124:127], v[160:163], a[60:63]
  ds_read_b128 v[120:123], v5 offset:14336
  v_cvt_f32_i32 v229, v229
  v_lshlrev_b32 v188, 16, v234
  v_mfma_f32_16x16x32_bf16 a[204:207], v[12:15], v[160:163], a[204:207]
  ds_read_b128 v[124:127], v5 offset:14592
  v_and_b32 v189, s44, v234
  v_mfma_f32_16x16x32_bf16 a[64:67], v[128:131], v[136:139], a[64:67]
  ds_read_b128 v[72:75], v4 offset:26624
  v_cvt_pk_bf16_f32 v228, 0, v228
  v_cvt_pk_bf16_f32 v229, 0, v229
  v_mfma_f32_16x16x32_bf16 a[68:71], v[128:131], v[144:147], a[68:71]
  ds_read_b128 v[76:79], v4 offset:27648
  v_lshlrev_b32 v190, 16, v238
  v_mfma_f32_16x16x32_bf16 a[72:75], v[128:131], v[152:155], a[72:75]
  buffer_load_dwordx4 v8, s[4:7], s48 offen offset:1024 sc1 lds
  v_and_b32 v191, s44, v238
  v_subrev_f32 v228, v188, v228
  v_mfma_f32_16x16x32_bf16 a[76:79], v[128:131], v[160:163], a[76:79]
  ds_read_b128 v[80:83], v4 offset:28672
  v_subrev_f32 v229, v189, v229
  v_mul_f32 v190, s42, v190
  v_mfma_f32_16x16x32_bf16 a[80:83], v[132:135], v[136:139], a[80:83]
  ds_read_b128 v[128:131], v5 offset:14848
  v_mul_f32 v191, s43, v191
  v_mfma_f32_16x16x32_bf16 a[84:87], v[132:135], v[144:147], a[84:87]
  ds_read_b128 v[84:87], v4 offset:29696
  v_cvt_pk_bf16_f32 v228, 0, v228
  v_cvt_pk_bf16_f32 v229, 0, v229
  v_mfma_f32_16x16x32_bf16 a[88:91], v[132:135], v[152:155], a[88:91]
  ds_read_b128 v[88:91], v4 offset:30720
  v_mul_f32 v228, v190, v228
  v_mfma_f32_16x16x32_bf16 a[92:95], v[132:135], v[160:163], a[92:95]
  ds_read_b128 v[92:95], v4 offset:31744
  v_mul_f32 v229, v191, v229
  v_cvt_pk_bf16_f32 v234, v228, v229
  s_waitcnt lgkmcnt(10)
  v_mfma_f32_16x16x32_bf16 a[96:99], v[112:115], v[136:139], a[96:99]
  ds_read_b128 v[132:135], v5 offset:15104
  v_cvt_f32_i32 v230, v230
  v_mfma_f32_16x16x32_bf16 a[100:103], v[112:115], v[144:147], a[100:103]
  ds_read_b128 v[96:99], v4 offset:32768
  v_cvt_f32_i32 v231, v231
  v_lshlrev_b32 v188, 16, v235
  v_mfma_f32_16x16x32_bf16 a[104:107], v[112:115], v[152:155], a[104:107]
  buffer_load_dwordx4 v8, s[4:7], s48 offen offset:2048 sc1 lds
  v_and_b32 v189, s44, v235
  v_mfma_f32_16x16x32_bf16 a[108:111], v[112:115], v[160:163], a[108:111]
  ds_read_b128 v[100:103], v4 offset:33792
  v_cvt_pk_bf16_f32 v230, 0, v230
  v_cvt_pk_bf16_f32 v231, 0, v231
  s_waitcnt lgkmcnt(10)
  v_mfma_f32_16x16x32_bf16 a[112:115], v[116:119], v[136:139], a[112:115]
  s_add_u32 m0, s37, 49152
  v_lshlrev_b32 v190, 16, v239
  v_mfma_f32_16x16x32_bf16 a[116:119], v[116:119], v[144:147], a[116:119]
  ds_read_b128 v[104:107], v4 offset:34816
  v_and_b32 v191, s44, v239
  v_subrev_f32 v230, v188, v230
  v_mfma_f32_16x16x32_bf16 a[120:123], v[116:119], v[152:155], a[120:123]
  v_subrev_f32 v231, v189, v231
  v_mul_f32 v190, s42, v190
  v_mfma_f32_16x16x32_bf16 a[124:127], v[116:119], v[160:163], a[124:127]
  ds_read_b128 v[108:111], v4 offset:35840
  v_mul_f32 v191, s43, v191
  v_mfma_f32_16x16x32_bf16 a[128:131], v[120:123], v[136:139], a[128:131]
  v_cvt_pk_bf16_f32 v230, 0, v230
  v_cvt_pk_bf16_f32 v231, 0, v231
  v_mul_f32 v230, v190, v230
  v_mfma_f32_16x16x32_bf16 a[132:135], v[120:123], v[144:147], a[132:135]
  v_mul_f32 v231, v191, v231
  v_cvt_pk_bf16_f32 v235, v230, v231
  v_mfma_f32_16x16x32_bf16 a[136:139], v[120:123], v[152:155], a[136:139]
  buffer_load_dwordx4 v9, s[4:7], s48 offen offset:0 sc1 lds
  buffer_store_dwordx4 v[232:235], v8, s[4:7], s77 offen offset:0 sc1
  v_cvt_f32_i32 v240, v240
  v_mfma_f32_16x16x32_bf16 a[140:143], v[120:123], v[160:163], a[140:143]
  v_cvt_f32_i32 v241, v241
  v_lshlrev_b32 v188, 16, v248
  v_mfma_f32_16x16x32_bf16 a[144:147], v[124:127], v[136:139], a[144:147]
  v_and_b32 v189, s44, v248
  v_cvt_pk_bf16_f32 v240, 0, v240
  v_mfma_f32_16x16x32_bf16 a[148:151], v[124:127], v[144:147], a[148:151]
  v_cvt_pk_bf16_f32 v241, 0, v241
  buffer_load_dwordx4 v[224:227], v184, s[12:15], s77 offen offset:256 sc0 sc1 nt
  v_mfma_f32_16x16x32_bf16 a[152:155], v[124:127], v[152:155], a[152:155]
  s_waitcnt vmcnt(24)
  v_lshlrev_b32 v190, 16, v252
  v_and_b32 v191, s44, v252
  v_subrev_f32 v240, v188, v240
  v_mfma_f32_16x16x32_bf16 a[156:159], v[124:127], v[160:163], a[156:159]
  v_subrev_f32 v241, v189, v241
  v_mul_f32 v190, s42, v190
  s_waitcnt lgkmcnt(4)
  v_mfma_f32_16x16x32_bf16 a[160:163], v[128:131], v[136:139], a[160:163]
  buffer_load_dwordx4 v9, s[4:7], s48 offen offset:1024 sc1 lds
  v_mul_f32 v191, s43, v191
  v_mfma_f32_16x16x32_bf16 a[164:167], v[128:131], v[144:147], a[164:167]
  v_cvt_pk_bf16_f32 v240, 0, v240
  v_cvt_pk_bf16_f32 v241, 0, v241
  buffer_load_dwordx4 v[228:231], v184, s[12:15], s77 offen offset:272 sc0 sc1 nt
  v_mfma_f32_16x16x32_bf16 a[168:171], v[128:131], v[152:155], a[168:171]
  v_mul_f32 v240, v190, v240
  v_mul_f32 v241, v191, v241
  v_mfma_f32_16x16x32_bf16 a[172:175], v[128:131], v[160:163], a[172:175]
  v_cvt_pk_bf16_f32 v248, v240, v241
  v_cvt_f32_i32 v242, v242
  v_mfma_f32_16x16x32_bf16 a[176:179], v[132:135], v[136:139], a[176:179]
  v_cvt_f32_i32 v243, v243
  v_lshlrev_b32 v188, 16, v249
  v_and_b32 v189, s44, v249
  v_mfma_f32_16x16x32_bf16 a[180:183], v[132:135], v[144:147], a[180:183]
  buffer_load_dwordx4 v[232:235], v185, s[24:27], s78 offen offset:128
  v_cvt_pk_bf16_f32 v242, 0, v242
  v_mfma_f32_16x16x32_bf16 a[184:187], v[132:135], v[152:155], a[184:187]
  buffer_load_dwordx4 v9, s[4:7], s48 offen offset:2048 sc1 lds
  v_cvt_pk_bf16_f32 v243, 0, v243
  v_mfma_f32_16x16x32_bf16 a[188:191], v[132:135], v[160:163], a[188:191]
  s_mul_i32 s48, s90, 48
  v_lshlrev_b32 v190, 16, v253
  v_and_b32 v191, s44, v253
  v_mfma_f32_16x16x32_bf16 v[136:139], v[64:67], v[16:19], v[168:171]
  v_subrev_f32 v242, v188, v242
  v_subrev_f32 v243, v189, v243
  v_mfma_f32_16x16x32_bf16 v[136:139], v[68:71], v[20:23], v[136:139]
  ds_read_b128 v[112:115], v5 offset:24576
  v_mul_f32 v190, s42, v190
  v_mul_f32 v191, s43, v191
  v_mfma_f32_16x16x32_bf16 v[136:139], v[72:75], v[24:27], v[136:139]
  buffer_load_dwordx4 v[236:239], v185, s[20:23], s78 offen offset:128
  v_cvt_pk_bf16_f32 v242, 0, v242
  v_mfma_f32_16x16x32_bf16 v[136:139], v[76:79], v[28:31], v[136:139]
  ds_read_b128 v[116:119], v5 offset:24832
  v_cvt_pk_bf16_f32 v243, 0, v243
  s_waitcnt lgkmcnt(2)
  v_mfma_f32_16x16x32_bf16 v[136:139], v[80:83], v[32:35], v[136:139]
  v_mul_f32 v242, v190, v242
  v_mul_f32 v243, v191, v243
  v_cvt_pk_bf16_f32 v249, v242, v243
  v_mfma_f32_16x16x32_bf16 v[136:139], v[84:87], v[36:39], v[136:139]
  ds_read_b128 v[120:123], v5 offset:25088
  v_cvt_f32_i32 v244, v244
  v_mfma_f32_16x16x32_bf16 v[140:143], v[88:91], v[16:19], v[168:171]
  v_cvt_f32_i32 v245, v245
  v_lshlrev_b32 v188, 16, v250
  v_and_b32 v189, s44, v250
  v_mfma_f32_16x16x32_bf16 v[140:143], v[92:95], v[20:23], v[140:143]
  ds_read_b128 v[124:127], v5 offset:25344
  v_cvt_pk_bf16_f32 v244, 0, v244
  v_mfma_f32_16x16x32_bf16 v[140:143], v[96:99], v[24:27], v[140:143]
  v_cvt_pk_bf16_f32 v245, 0, v245
  v_lshlrev_b32 v190, 16, v254
  v_mfma_f32_16x16x32_bf16 v[140:143], v[100:103], v[28:31], v[140:143]
  ds_read_b128 v[128:131], v5 offset:25600
  v_and_b32 v191, s44, v254
  v_subrev_f32 v244, v188, v244
  v_mfma_f32_16x16x32_bf16 v[140:143], v[104:107], v[32:35], v[140:143]
  v_subrev_f32 v245, v189, v245
  v_mul_f32 v190, s42, v190
  v_mfma_f32_16x16x32_bf16 v[140:143], v[108:111], v[36:39], v[140:143]
  ds_read_b128 v[132:135], v5 offset:25856
  v_mul_f32 v191, s43, v191
  v_cvt_pk_bf16_f32 v244, 0, v244
  v_mfma_f32_16x16x32_bf16 v[144:147], v[64:67], v[40:43], v[172:175]
  v_exp_f32 v136, v136
  v_mfma_f32_16x16x32_bf16 v[144:147], v[68:71], v[44:47], v[144:147]
  v_exp_f32 v137, v137
  v_cvt_pk_bf16_f32 v245, 0, v245
  v_mfma_f32_16x16x32_bf16 v[144:147], v[72:75], v[48:51], v[144:147]
  v_exp_f32 v138, v138
  v_mul_f32 v244, v190, v244
  v_mfma_f32_16x16x32_bf16 v[144:147], v[76:79], v[52:55], v[144:147]
  v_exp_f32 v139, v139
  v_mul_f32 v245, v191, v245
  v_mfma_f32_16x16x32_bf16 v[144:147], v[80:83], v[56:59], v[144:147]
  v_cvt_pk_bf16_f32 v136, v136, v137
  v_cvt_pk_bf16_f32 v137, v138, v139
  v_mfma_f32_16x16x32_bf16 v[144:147], v[84:87], v[60:63], v[144:147]
  v_exp_f32 v140, v140
  v_cvt_pk_bf16_f32 v250, v244, v245
  v_mfma_f32_16x16x32_bf16 v[148:151], v[88:91], v[40:43], v[172:175]
  v_exp_f32 v141, v141
  v_cvt_f32_i32 v246, v246
  v_mfma_f32_16x16x32_bf16 v[148:151], v[92:95], v[44:47], v[148:151]
  v_exp_f32 v142, v142
  v_cvt_f32_i32 v247, v247
  v_mfma_f32_16x16x32_bf16 v[148:151], v[96:99], v[48:51], v[148:151]
  v_exp_f32 v143, v143
  v_mfma_f32_16x16x32_bf16 v[148:151], v[100:103], v[52:55], v[148:151]
  v_cvt_pk_bf16_f32 v138, v140, v141
  v_cvt_pk_bf16_f32 v139, v142, v143
  v_lshlrev_b32 v188, 16, v251
  v_mfma_f32_16x16x32_bf16 v[148:151], v[104:107], v[56:59], v[148:151]
  s_add_u32 s3, s3, 512
  v_and_b32 v189, s44, v251
  v_cvt_pk_bf16_f32 v246, 0, v246
  v_mfma_f32_16x16x32_bf16 v[148:151], v[108:111], v[60:63], v[148:151]
  s_xor_b32 s90, s3, s76
  v_cvt_pk_bf16_f32 v247, 0, v247
  v_mfma_f32_16x16x32_bf16 v[152:155], v[64:67], a[208:211], v[176:179]
  v_exp_f32 v144, v144
  v_lshlrev_b32 v190, 16, v255
  v_mfma_f32_16x16x32_bf16 v[152:155], v[68:71], a[212:215], v[152:155]
  v_exp_f32 v145, v145
  v_and_b32 v191, s44, v255
  v_mfma_f32_16x16x32_bf16 v[152:155], v[72:75], a[216:219], v[152:155]
  v_exp_f32 v146, v146
  v_subrev_f32 v246, v188, v246
  v_mfma_f32_16x16x32_bf16 v[152:155], v[76:79], a[220:223], v[152:155]
  v_exp_f32 v147, v147
  v_mfma_f32_16x16x32_bf16 v[152:155], v[80:83], a[224:227], v[152:155]
  v_cvt_pk_bf16_f32 v144, v144, v145
  v_cvt_pk_bf16_f32 v145, v146, v147
  v_subrev_f32 v247, v189, v247
  v_mfma_f32_16x16x32_bf16 v[152:155], v[84:87], a[228:231], v[152:155]
  v_exp_f32 v148, v148
  v_mul_f32 v190, s42, v190
  v_mfma_f32_16x16x32_bf16 v[156:159], v[88:91], a[208:211], v[176:179]
  v_exp_f32 v149, v149
  v_mul_f32 v191, s43, v191
  v_mfma_f32_16x16x32_bf16 v[156:159], v[92:95], a[212:215], v[156:159]
  v_exp_f32 v150, v150
  v_mfma_f32_16x16x32_bf16 v[156:159], v[96:99], a[216:219], v[156:159]
  v_exp_f32 v151, v151
  v_cvt_pk_bf16_f32 v246, 0, v246
  v_mfma_f32_16x16x32_bf16 v[156:159], v[100:103], a[220:223], v[156:159]
  v_cvt_pk_bf16_f32 v146, v148, v149
  v_cvt_pk_bf16_f32 v147, v150, v151
  v_cvt_pk_bf16_f32 v247, 0, v247
  v_mfma_f32_16x16x32_bf16 v[156:159], v[104:107], a[224:227], v[156:159]
  s_and_b32 s90, s90, 0x7e00
  v_mul_f32 v246, v190, v246
  v_mfma_f32_16x16x32_bf16 v[156:159], v[108:111], a[228:231], v[156:159]
  v_mul_f32 v247, v191, v247
  v_cvt_pk_bf16_f32 v251, v246, v247
  buffer_store_dwordx4 v[248:251], v8, s[4:7], s77 offen offset:1024 sc1
  v_mfma_f32_16x16x32_bf16 v[160:163], v[64:67], a[232:235], v[180:183]
  v_exp_f32 v152, v152
  v_mfma_f32_16x16x32_bf16 v[160:163], v[68:71], a[236:239], v[160:163]
  v_exp_f32 v153, v153
  s_waitcnt vmcnt(29)
  v_readlane_b32 s60, v10, 0
  v_mfma_f32_16x16x32_bf16 v[160:163], v[72:75], a[240:243], v[160:163]
  v_exp_f32 v154, v154
  v_readlane_b32 s61, v10, 1
  v_mfma_f32_16x16x32_bf16 v[160:163], v[76:79], a[244:247], v[160:163]
  v_exp_f32 v155, v155
  v_readlane_b32 s62, v10, 2
  v_mfma_f32_16x16x32_bf16 v[160:163], v[80:83], a[248:251], v[160:163]
  v_cvt_pk_bf16_f32 v152, v152, v153
  v_cvt_pk_bf16_f32 v153, v154, v155
  v_mfma_f32_16x16x32_bf16 v[160:163], v[84:87], a[252:255], v[160:163]
  v_exp_f32 v156, v156
  v_readlane_b32 s63, v10, 3
  v_mfma_f32_16x16x32_bf16 v[164:167], v[88:91], a[232:235], v[180:183]
  v_exp_f32 v157, v157
  v_readlane_b32 s64, v10, 4
  v_mfma_f32_16x16x32_bf16 v[164:167], v[92:95], a[236:239], v[164:167]
  v_exp_f32 v158, v158
  v_readlane_b32 s65, v10, 5
  v_mfma_f32_16x16x32_bf16 v[164:167], v[96:99], a[240:243], v[164:167]
  v_exp_f32 v159, v159
  v_mfma_f32_16x16x32_bf16 v[164:167], v[100:103], a[244:247], v[164:167]
  v_cvt_pk_bf16_f32 v154, v156, v157
  v_cvt_pk_bf16_f32 v155, v158, v159
  v_readlane_b32 s66, v10, 6
  v_mfma_f32_16x16x32_bf16 v[164:167], v[104:107], a[248:251], v[164:167]
  v_readlane_b32 s67, v10, 7
  s_waitcnt vmcnt(26)
  v_readlane_b32 s68, v11, 0
  v_readlane_b32 s69, v11, 1
  s_waitcnt lgkmcnt(0)
  v_mfma_f32_16x16x32_bf16 v[164:167], v[108:111], a[252:255], v[164:167]
  v_readlane_b32 s70, v11, 2
  v_readlane_b32 s71, v11, 3
  v_mfma_f32_16x16x32_bf16 a[0:3], v[112:115], v[136:139], a[0:3]
  v_exp_f32 v160, v160
  v_readlane_b32 s72, v11, 4
  v_mfma_f32_16x16x32_bf16 a[4:7], v[112:115], v[144:147], a[4:7]
  v_exp_f32 v161, v161
  v_mfma_f32_16x16x32_bf16 a[8:11], v[112:115], v[152:155], a[8:11]
  v_exp_f32 v162, v162
  v_readlane_b32 s73, v11, 5
  v_mfma_f32_16x16x32_bf16 a[16:19], v[116:119], v[136:139], a[16:19]
  v_exp_f32 v163, v163
  v_readlane_b32 s74, v11, 6
  v_mfma_f32_16x16x32_bf16 a[20:23], v[116:119], v[144:147], a[20:23]
  v_cvt_pk_bf16_f32 v160, v160, v161
  v_cvt_pk_bf16_f32 v161, v162, v163
  v_readlane_b32 s75, v11, 7
  v_mfma_f32_16x16x32_bf16 a[24:27], v[116:119], v[152:155], a[24:27]
  v_exp_f32 v164, v164
  v_mfma_f32_16x16x32_bf16 a[32:35], v[120:123], v[136:139], a[32:35]
  v_exp_f32 v165, v165
  s_waitcnt vmcnt(23)
  v_cvt_f32_i32 v199, v198
  v_mfma_f32_16x16x32_bf16 a[36:39], v[120:123], v[144:147], a[36:39]
  v_exp_f32 v166, v166
  v_cvt_f32_i32 v198, v194
  v_mfma_f32_16x16x32_bf16 a[40:43], v[120:123], v[152:155], a[40:43]
  v_exp_f32 v167, v167
  v_cvt_f32_i32 v194, v193
  v_mfma_f32_16x16x32_bf16 a[48:51], v[124:127], v[136:139], a[48:51]
  v_cvt_pk_bf16_f32 v162, v164, v165
  v_cvt_pk_bf16_f32 v163, v166, v167
  v_mfma_f32_16x16x32_bf16 a[52:55], v[124:127], v[144:147], a[52:55]
  v_cmp_eq_u64 vcc, s[88:89], v[2:3]
  s_add_u32 m0, s37, 12288
  v_cvt_f32_i32 v195, v197
  v_mfma_f32_16x16x32_bf16 a[56:59], v[124:127], v[152:155], a[56:59]
  s_waitcnt vmcnt(13)
  s_barrier
  v_mfma_f32_16x16x32_bf16 a[192:195], v[12:15], v[136:139], a[192:195]
  s_cbranch_vccz L_slow4
L_ret4:
  buffer_load_dwordx2 v[2:3], v1, s[4:7], s90 offen sc1
  v_mfma_f32_16x16x32_bf16 a[196:199], v[12:15], v[144:147], a[196:199]
  ds_read_b128 v[64:67], v4 offset:36864
  v_cvt_f32_i32 v193, v196
  v_cvt_f32_i32 v192, v192
  v_mfma_f32_16x16x32_bf16 a[200:203], v[12:15], v[152:155], a[200:203]
  buffer_load_dwordx4 v8, s[4:7], s40 offen offset:0 sc1 lds
  v_cvt_pk_bf16_f32 v198, 0, v198
  v_mfma_f32_16x16x32_bf16 a[12:15], v[112:115], v[160:163], a[12:15]
  ds_read_b128 v[68:71], v4 offset:37888
  v_cvt_pk_bf16_f32 v199, 0, v199
  v_cvt_pk_bf16_f32 v194, 0, v194
  v_mfma_f32_16x16x32_bf16 a[28:31], v[116:119], v[160:163], a[28:31]
  ds_read_b128 v[112:115], v5 offset:26112
  v_cvt_pk_bf16_f32 v195, 0, v195
  v_mfma_f32_16x16x32_bf16 a[44:47], v[120:123], v[160:163], a[44:47]
  ds_read_b128 v[116:119], v5 offset:26368
  v_cvt_pk_bf16_f32 v192, 0, v192
  v_cvt_pk_bf16_f32 v193, 0, v193
  v_mfma_f32_16x16x32_bf16 a[60:63], v[124:127], v[160:163], a[60:63]
  ds_read_b128 v[120:123], v5 offset:26624
  v_subrev_f32 v198, s60, v198
  v_mfma_f32_16x16x32_bf16 a[204:207], v[12:15], v[160:163], a[204:207]
  ds_read_b128 v[124:127], v5 offset:26880
  v_subrev_f32 v199, s61, v199
  v_subrev_f32 v194, s60, v194
  v_mfma_f32_16x16x32_bf16 a[64:67], v[128:131], v[136:139], a[64:67]
  ds_read_b128 v[72:75], v4 offset:38912
  v_subrev_f32 v195, s61, v195
  v_mfma_f32_16x16x32_bf16 a[68:71], v[128:131], v[144:147], a[68:71]
  ds_read_b128 v[76:79], v4 offset:39936
  v_subrev_f32 v192, s60, v192
  v_subrev_f32 v193, s61, v193
  v_mfma_f32_16x16x32_bf16 a[72:75], v[128:131], v[152:155], a[72:75]
  buffer_load_dwordx4 v8, s[4:7], s40 offen offset:1024 sc1 lds
  v_cvt_pk_bf16_f32 v198, 0, v198
  v_mfma_f32_16x16x32_bf16 a[76:79], v[128:131], v[160:163], a[76:79]
  ds_read_b128 v[80:83], v4 offset:40960
  v_cvt_pk_bf16_f32 v199, 0, v199
  v_cvt_pk_bf16_f32 v194, 0, v194
  v_mfma_f32_16x16x32_bf16 a[80:83], v[132:135], v[136:139], a[80:83]
  ds_read_b128 v[128:131], v5 offset:27136
  v_cvt_pk_bf16_f32 v195, 0, v195
  v_mfma_f32_16x16x32_bf16 a[84:87], v[132:135], v[144:147], a[84:87]
  ds_read_b128 v[84:87], v4 offset:41984
  v_cvt_pk_bf16_f32 v192, 0, v192
  v_cvt_pk_bf16_f32 v193, 0, v193
  v_mfma_f32_16x16x32_bf16 a[88:91], v[132:135], v[152:155], a[88:91]
  ds_read_b128 v[88:91], v4 offset:43008
  v_mul_f32 v198, s68, v198
  v_mfma_f32_16x16x32_bf16 a[92:95], v[132:135], v[160:163], a[92:95]
  ds_read_b128 v[92:95], v4 offset:44032
  v_mul_f32 v199, s69, v199
  v_mul_f32 v194, s68, v194
  s_waitcnt lgkmcnt(10)
  v_mfma_f32_16x16x32_bf16 a[96:99], v[112:115], v[136:139], a[96:99]
  ds_read_b128 v[132:135], v5 offset:27392
  v_mul_f32 v195, s69, v195
  v_mfma_f32_16x16x32_bf16 a[100:103], v[112:115], v[144:147], a[100:103]
  ds_read_b128 v[96:99], v4 offset:45056
  v_mul_f32 v192, s68, v192
  v_mul_f32 v193, s69, v193
  v_mfma_f32_16x16x32_bf16 a[104:107], v[112:115], v[152:155], a[104:107]
  buffer_load_dwordx4 v8, s[4:7], s40 offen offset:2048 sc1 lds
  v_cvt_pk_bf16_f32 v188, v198, v199
  v_mfma_f32_16x16x32_bf16 a[108:111], v[112:115], v[160:163], a[108:111]
  ds_read_b128 v[100:103], v4 offset:46080
  v_cvt_pk_bf16_f32 v196, v194, v195
  v_cvt_pk_bf16_f32 v192, v192, v193
  s_waitcnt lgkmcnt(10)
  v_mfma_f32_16x16x32_bf16 a[112:115], v[116:119], v[136:139], a[112:115]
  s_add_u32 m0, s37, 61440
  v_cvt_f32_i32 v207, v206
  v_cvt_f32_i32 v206, v202
  v_mfma_f32_16x16x32_bf16 a[116:119], v[116:119], v[144:147], a[116:119]
  ds_read_b128 v[104:107], v4 offset:47104
  v_cvt_f32_i32 v202, v201
  v_mfma_f32_16x16x32_bf16 a[120:123], v[116:119], v[152:155], a[120:123]
  v_cvt_f32_i32 v203, v205
  v_cvt_f32_i32 v201, v204
  v_mfma_f32_16x16x32_bf16 a[124:127], v[116:119], v[160:163], a[124:127]
  ds_read_b128 v[108:111], v4 offset:48128
  v_cvt_f32_i32 v200, v200
  v_cvt_pk_bf16_f32 v206, 0, v206
  v_mfma_f32_16x16x32_bf16 a[128:131], v[120:123], v[136:139], a[128:131]
  v_cvt_pk_bf16_f32 v207, 0, v207
  v_cvt_pk_bf16_f32 v202, 0, v202
  v_mfma_f32_16x16x32_bf16 a[132:135], v[120:123], v[144:147], a[132:135]
  v_cvt_pk_bf16_f32 v203, 0, v203
  v_cvt_pk_bf16_f32 v200, 0, v200
  v_mfma_f32_16x16x32_bf16 a[136:139], v[120:123], v[152:155], a[136:139]
  buffer_load_dwordx4 v9, s[4:7], s40 offen offset:0 sc1 lds
  v_cvt_pk_bf16_f32 v201, 0, v201
  v_subrev_f32 v206, s62, v206
  v_mfma_f32_16x16x32_bf16 a[140:143], v[120:123], v[160:163], a[140:143]
  v_subrev_f32 v207, s63, v207
  v_subrev_f32 v202, s62, v202
  v_mfma_f32_16x16x32_bf16 a[144:147], v[124:127], v[136:139], a[144:147]
  v_subrev_f32 v203, s63, v203
  v_subrev_f32 v200, s62, v200
  v_mfma_f32_16x16x32_bf16 a[148:151], v[124:127], v[144:147], a[148:151]
  v_subrev_f32 v201, s63, v201
  v_cvt_pk_bf16_f32 v206, 0, v206
  v_cvt_pk_bf16_f32 v207, 0, v207
  v_mfma_f32_16x16x32_bf16 a[152:155], v[124:127], v[152:155], a[152:155]
  v_cvt_pk_bf16_f32 v202, 0, v202
  v_cvt_pk_bf16_f32 v203, 0, v203
  v_mfma_f32_16x16x32_bf16 a[156:159], v[124:127], v[160:163], a[156:159]
  v_cvt_pk_bf16_f32 v200, 0, v200
  v_cvt_pk_bf16_f32 v201, 0, v201
  s_waitcnt lgkmcnt(4)
  v_mfma_f32_16x16x32_bf16 a[160:163], v[128:131], v[136:139], a[160:163]
  buffer_load_dwordx4 v9, s[4:7], s40 offen offset:1024 sc1 lds
  v_mul_f32 v206, s70, v206
  v_mul_f32 v207, s71, v207
  v_mfma_f32_16x16x32_bf16 a[164:167], v[128:131], v[144:147], a[164:167]
  v_mul_f32 v202, s70, v202
  v_mul_f32 v203, s71, v203
  v_mfma_f32_16x16x32_bf16 a[168:171], v[128:131], v[152:155], a[168:171]
  v_mul_f32 v200, s70, v200
  v_mul_f32 v201, s71, v201
  v_mfma_f32_16x16x32_bf16 a[172:175], v[128:131], v[160:163], a[172:175]
  v_cvt_pk_bf16_f32 v189, v206, v207
  v_cvt_pk_bf16_f32 v197, v202, v203
  v_cvt_pk_bf16_f32 v193, v200, v201
  v_mfma_f32_16x16x32_bf16 a[176:179], v[132:135], v[136:139], a[176:179]
  v_cvt_f32_i32 v215, v214
  v_cvt_f32_i32 v214, v210
  v_mfma_f32_16x16x32_bf16 a[180:183], v[132:135], v[144:147], a[180:183]
  v_cvt_f32_i32 v210, v209
  v_cvt_f32_i32 v211, v213
  v_mfma_f32_16x16x32_bf16 a[184:187], v[132:135], v[152:155], a[184:187]
  buffer_load_dwordx4 v9, s[4:7], s40 offen offset:2048 sc1 lds
  v_cvt_f32_i32 v209, v212
  v_cvt_f32_i32 v208, v208
  v_mfma_f32_16x16x32_bf16 a[188:191], v[132:135], v[160:163], a[188:191]
  s_mul_i32 s40, s90, 48
  v_cvt_pk_bf16_f32 v214, 0, v214
  v_mfma_f32_16x16x32_bf16 v[136:139], v[64:67], v[16:19], v[168:171]
  v_cvt_pk_bf16_f32 v215, 0, v215
  v_cvt_pk_bf16_f32 v210, 0, v210
  v_mfma_f32_16x16x32_bf16 v[136:139], v[68:71], v[20:23], v[136:139]
  ds_read_b128 v[112:115], v5 offset:36864
  v_cvt_pk_bf16_f32 v211, 0, v211
  v_cvt_pk_bf16_f32 v208, 0, v208
  v_mfma_f32_16x16x32_bf16 v[136:139], v[72:75], v[24:27], v[136:139]
  v_cvt_pk_bf16_f32 v209, 0, v209
  v_subrev_f32 v214, s64, v214
  v_mfma_f32_16x16x32_bf16 v[136:139], v[76:79], v[28:31], v[136:139]
  ds_read_b128 v[116:119], v5 offset:37120
  v_subrev_f32 v215, s65, v215
  v_subrev_f32 v210, s64, v210
  s_waitcnt lgkmcnt(2)
  v_mfma_f32_16x16x32_bf16 v[136:139], v[80:83], v[32:35], v[136:139]
  v_subrev_f32 v211, s65, v211
  v_subrev_f32 v208, s64, v208
  v_mfma_f32_16x16x32_bf16 v[136:139], v[84:87], v[36:39], v[136:139]
  ds_read_b128 v[120:123], v5 offset:37376
  v_subrev_f32 v209, s65, v209
  v_cvt_pk_bf16_f32 v214, 0, v214
  v_mfma_f32_16x16x32_bf16 v[140:143], v[88:91], v[16:19], v[168:171]
  v_cvt_pk_bf16_f32 v215, 0, v215
  v_cvt_pk_bf16_f32 v210, 0, v210
  v_mfma_f32_16x16x32_bf16 v[140:143], v[92:95], v[20:23], v[140:143]
  ds_read_b128 v[124:127], v5 offset:37632
  v_cvt_pk_bf16_f32 v211, 0, v211
  v_mfma_f32_16x16x32_bf16 v[140:143], v[96:99], v[24:27], v[140:143]
  v_cvt_pk_bf16_f32 v208, 0, v208
  v_cvt_pk_bf16_f32 v209, 0, v209
  v_mul_f32 v214, s72, v214
  v_mfma_f32_16x16x32_bf16 v[140:143], v[100:103], v[28:31], v[140:143]
  ds_read_b128 v[128:131], v5 offset:37888
  v_mul_f32 v215, s73, v215
  v_mfma_f32_16x16x32_bf16 v[140:143], v[104:107], v[32:35], v[140:143]
  v_mul_f32 v210, s72, v210
  v_mul_f32 v211, s73, v211
  v_mfma_f32_16x16x32_bf16 v[140:143], v[108:111], v[36:39], v[140:143]
  ds_read_b128 v[132:135], v5 offset:38144
  v_mul_f32 v208, s72, v208
  v_mul_f32 v209, s73, v209
  v_mfma_f32_16x16x32_bf16 v[144:147], v[64:67], v[40:43], v[172:175]
  v_exp_f32 v136, v136
  v_cvt_pk_bf16_f32 v190, v214, v215
  v_mfma_f32_16x16x32_bf16 v[144:147], v[68:71], v[44:47], v[144:147]
  v_exp_f32 v137, v137
  v_mfma_f32_16x16x32_bf16 v[144:147], v[72:75], v[48:51], v[144:147]
  v_exp_f32 v138, v138
  v_cvt_pk_bf16_f32 v198, v210, v211
  v_mfma_f32_16x16x32_bf16 v[144:147], v[76:79], v[52:55], v[144:147]
  v_exp_f32 v139, v139
  v_cvt_pk_bf16_f32 v194, v208, v209
  v_mfma_f32_16x16x32_bf16 v[144:147], v[80:83], v[56:59], v[144:147]
  v_cvt_pk_bf16_f32 v136, v136, v137
  v_cvt_pk_bf16_f32 v137, v138, v139
  v_cvt_f32_i32 v223, v222
  v_mfma_f32_16x16x32_bf16 v[144:147], v[84:87], v[60:63], v[144:147]
  v_exp_f32 v140, v140
  v_cvt_f32_i32 v222, v218
  v_mfma_f32_16x16x32_bf16 v[148:151], v[88:91], v[40:43], v[172:175]
  v_exp_f32 v141, v141
  v_mfma_f32_16x16x32_bf16 v[148:151], v[92:95], v[44:47], v[148:151]
  v_exp_f32 v142, v142
  v_cvt_f32_i32 v218, v217
  v_mfma_f32_16x16x32_bf16 v[148:151], v[96:99], v[48:51], v[148:151]
  v_exp_f32 v143, v143
  v_cvt_f32_i32 v219, v221
  v_mfma_f32_16x16x32_bf16 v[148:151], v[100:103], v[52:55], v[148:151]
  v_cvt_pk_bf16_f32 v138, v140, v141
  v_cvt_pk_bf16_f32 v139, v142, v143
  v_cvt_f32_i32 v217, v220
  v_mfma_f32_16x16x32_bf16 v[148:151], v[104:107], v[56:59], v[148:151]
  s_add_u32 s3, s3, 512
  v_cvt_f32_i32 v216, v216
  v_mfma_f32_16x16x32_bf16 v[148:151], v[108:111], v[60:63], v[148:151]
  s_xor_b32 s90, s3, s76
  v_cvt_pk_bf16_f32 v222, 0, v222
  v_cvt_pk_bf16_f32 v223, 0, v223
  v_mfma_f32_16x16x32_bf16 v[152:155], v[64:67], a[208:211], v[176:179]
  v_exp_f32 v144, v144
  v_mfma_f32_16x16x32_bf16 v[152:155], v[68:71], a[212:215], v[152:155]
  v_exp_f32 v145, v145
  v_cvt_pk_bf16_f32 v218, 0, v218
  v_mfma_f32_16x16x32_bf16 v[152:155], v[72:75], a[216:219], v[152:155]
  v_exp_f32 v146, v146
  v_cvt_pk_bf16_f32 v219, 0, v219
  v_mfma_f32_16x16x32_bf16 v[152:155], v[76:79], a[220:223], v[152:155]
  v_exp_f32 v147, v147
  v_cvt_pk_bf16_f32 v216, 0, v216
  v_mfma_f32_16x16x32_bf16 v[152:155], v[80:83], a[224:227], v[152:155]
  v_cvt_pk_bf16_f32 v144, v144, v145
  v_cvt_pk_bf16_f32 v145, v146, v147
  v_mfma_f32_16x16x32_bf16 v[152:155], v[84:87], a[228:231], v[152:155]
  v_exp_f32 v148, v148
  v_cvt_pk_bf16_f32 v217, 0, v217
  v_mfma_f32_16x16x32_bf16 v[156:159], v[88:91], a[208:211], v[176:179]
  v_exp_f32 v149, v149
  v_subrev_f32 v222, s66, v222
  v_mfma_f32_16x16x32_bf16 v[156:159], v[92:95], a[212:215], v[156:159]
  v_exp_f32 v150, v150
  v_subrev_f32 v223, s67, v223
  v_mfma_f32_16x16x32_bf16 v[156:159], v[96:99], a[216:219], v[156:159]
  v_exp_f32 v151, v151
  v_mfma_f32_16x16x32_bf16 v[156:159], v[100:103], a[220:223], v[156:159]
  v_cvt_pk_bf16_f32 v146, v148, v149
  v_cvt_pk_bf16_f32 v147, v150, v151
  v_subrev_f32 v218, s66, v218
  v_mfma_f32_16x16x32_bf16 v[156:159], v[104:107], a[224:227], v[156:159]
  s_and_b32 s90, s90, 0x7e00
  v_subrev_f32 v219, s67, v219
  v_subrev_f32 v216, s66, v216
  v_mfma_f32_16x16x32_bf16 v[156:159], v[108:111], a[228:231], v[156:159]
  v_subrev_f32 v217, s67, v217
  v_cvt_pk_bf16_f32 v222, 0, v222
  v_mfma_f32_16x16x32_bf16 v[160:163], v[64:67], a[232:235], v[180:183]
  v_exp_f32 v152, v152
  v_cvt_pk_bf16_f32 v223, 0, v223
  v_mfma_f32_16x16x32_bf16 v[160:163], v[68:71], a[236:239], v[160:163]
  v_exp_f32 v153, v153
  v_cvt_pk_bf16_f32 v218, 0, v218
  v_mfma_f32_16x16x32_bf16 v[160:163], v[72:75], a[240:243], v[160:163]
  v_exp_f32 v154, v154
  v_mfma_f32_16x16x32_bf16 v[160:163], v[76:79], a[244:247], v[160:163]
  v_exp_f32 v155, v155
  v_cvt_pk_bf16_f32 v219, 0, v219
  v_mfma_f32_16x16x32_bf16 v[160:163], v[80:83], a[248:251], v[160:163]
  v_cvt_pk_bf16_f32 v152, v152, v153
  v_cvt_pk_bf16_f32 v153, v154, v155
  v_cvt_pk_bf16_f32 v216, 0, v216
  v_mfma_f32_16x16x32_bf16 v[160:163], v[84:87], a[252:255], v[160:163]
  v_exp_f32 v156, v156
  v_cvt_pk_bf16_f32 v217, 0, v217
  v_mfma_f32_16x16x32_bf16 v[164:167], v[88:91], a[232:235], v[180:183]
  v_exp_f32 v157, v157
  v_mfma_f32_16x16x32_bf16 v[164:167], v[92:95], a[236:239], v[164:167]
  v_exp_f32 v158, v158
  v_mul_f32 v222, s74, v222
  v_mfma_f32_16x16x32_bf16 v[164:167], v[96:99], a[240:243], v[164:167]
  v_exp_f32 v159, v159
  v_mul_f32 v223, s75, v223
  v_mfma_f32_16x16x32_bf16 v[164:167], v[100:103], a[244:247], v[164:167]
  v_cvt_pk_bf16_f32 v154, v156, v157
  v_cvt_pk_bf16_f32 v155, v158, v159
  v_mul_f32 v218, s74, v218
  v_mfma_f32_16x16x32_bf16 v[164:167], v[104:107], a[248:251], v[164:167]
  v_mul_f32 v219, s75, v219
  v_mul_f32 v216, s74, v216
  s_waitcnt lgkmcnt(0)
  v_mfma_f32_16x16x32_bf16 v[164:167], v[108:111], a[252:255], v[164:167]
  v_mul_f32 v217, s75, v217
  v_cvt_pk_bf16_f32 v191, v222, v223
  v_mfma_f32_16x16x32_bf16 a[0:3], v[112:115], v[136:139], a[0:3]
  v_exp_f32 v160, v160
  v_cvt_pk_bf16_f32 v199, v218, v219
  v_mfma_f32_16x16x32_bf16 a[4:7], v[112:115], v[144:147], a[4:7]
  v_exp_f32 v161, v161
  v_cvt_pk_bf16_f32 v195, v216, v217
  v_mfma_f32_16x16x32_bf16 a[8:11], v[112:115], v[152:155], a[8:11]
  v_exp_f32 v162, v162
  v_mfma_f32_16x16x32_bf16 a[16:19], v[116:119], v[136:139], a[16:19]
  v_exp_f32 v163, v163
  buffer_store_dwordx4 v[188:191], v9, s[4:7], s77 offen offset:2048 sc1
  v_mfma_f32_16x16x32_bf16 a[20:23], v[116:119], v[144:147], a[20:23]
  v_cvt_pk_bf16_f32 v160, v160, v161
  v_cvt_pk_bf16_f32 v161, v162, v163
  s_waitcnt vmcnt(14)
  v_cvt_f32_i32 v224, v224
  v_mfma_f32_16x16x32_bf16 a[24:27], v[116:119], v[152:155], a[24:27]
  v_exp_f32 v164, v164
  v_cvt_f32_i32 v225, v225
  v_mfma_f32_16x16x32_bf16 a[32:35], v[120:123], v[136:139], a[32:35]
  v_exp_f32 v165, v165
  v_mfma_f32_16x16x32_bf16 a[36:39], v[120:123], v[144:147], a[36:39]
  v_exp_f32 v166, v166
  s_waitcnt vmcnt(11)
  v_lshlrev_b32 v188, 16, v232
  v_mfma_f32_16x16x32_bf16 a[40:43], v[120:123], v[152:155], a[40:43]
  v_exp_f32 v167, v167
  v_and_b32 v189, s44, v232
  v_mfma_f32_16x16x32_bf16 a[48:51], v[124:127], v[136:139], a[48:51]
  v_cvt_pk_bf16_f32 v162, v164, v165
  v_cvt_pk_bf16_f32 v163, v166, v167
  v_cvt_pk_bf16_f32 v224, 0, v224
  v_mfma_f32_16x16x32_bf16 a[52:55], v[124:127], v[144:147], a[52:55]
  v_cmp_eq_u64 vcc, s[88:89], v[6:7]
  s_add_u32 m0, s37, 24576
  v_mfma_f32_16x16x32_bf16 a[56:59], v[124:127], v[152:155], a[56:59]
  s_waitcnt vmcnt(10)
  s_barrier
  v_mfma_f32_16x16x32_bf16 a[192:195], v[12:15], v[136:139], a[192:195]
  s_cbranch_vccz L_slow5
L_ret5:
  v_mfma_f32_16x16x32_bf16 a[196:199], v[12:15], v[144:147], a[196:199]
  ds_read_b128 v[64:67], v4 offset:0
  v_cvt_pk_bf16_f32 v225, 0, v225
  buffer_store_dwordx4 v[192:195], v9, s[4:7], s77 offen offset:0 sc1
  v_mfma_f32_16x16x32_bf16 a[200:203], v[12:15], v[152:155], a[200:203]
  buffer_load_dwordx4 v8, s[4:7], s48 offen offset:0 sc1 lds
  s_waitcnt vmcnt(11)
  v_lshlrev_b32 v190, 16, v236
  v_and_b32 v191, s44, v236
  v_mfma_f32_16x16x32_bf16 a[12:15], v[112:115], v[160:163], a[12:15]
  ds_read_b128 v[68:71], v4 offset:1024
  v_subrev_f32 v224, v188, v224
  v_mfma_f32_16x16x32_bf16 a[28:31], v[116:119], v[160:163], a[28:31]
  ds_read_b128 v[112:115], v5 offset:38400
  v_subrev_f32 v225, v189, v225
  v_mul_f32 v190, s42, v190
  v_mfma_f32_16x16x32_bf16 a[44:47], v[120:123], v[160:163], a[44:47]
  ds_read_b128 v[116:119], v5 offset:38656
  v_mul_f32 v191, s43, v191
  v_mfma_f32_16x16x32_bf16 a[60:63], v[124:127], v[160:163], a[60:63]
  ds_read_b128 v[120:123], v5 offset:38912
  v_cvt_pk_bf16_f32 v224, 0, v224
  v_cvt_pk_bf16_f32 v225, 0, v225
  v_mfma_f32_16x16x32_bf16 a[204:207], v[12:15], v[160:163], a[204:207]
  ds_read_b128 v[124:127], v5 offset:39168
  buffer_store_dwordx4 v[196:199], v9, s[4:7], s77 offen offset:1024 sc1
  v_mfma_f32_16x16x32_bf16 a[64:67], v[128:131], v[136:139], a[64:67]
  ds_read_b128 v[72:75], v4 offset:2048
  v_mul_f32 v224, v190, v224
  v_mul_f32 v225, v191, v225
  v_mfma_f32_16x16x32_bf16 a[68:71], v[128:131], v[144:147], a[68:71]
  ds_read_b128 v[76:79], v4 offset:3072
  v_cvt_pk_bf16_f32 v232, v224, v225
  v_mfma_f32_16x16x32_bf16 a[72:75], v[128:131], v[152:155], a[72:75]
  buffer_load_dwordx4 v8, s[4:7], s48 offen offset:1024 sc1 lds
  v_cvt_f32_i32 v226, v226
  v_cvt_f32_i32 v227, v227
  v_mfma_f32_16x16x32_bf16 a[76:79], v[128:131], v[160:163], a[76:79]
  ds_read_b128 v[80:83], v4 offset:4096
  v_lshlrev_b32 v188, 16, v233
  v_mfma_f32_16x16x32_bf16 a[80:83], v[132:135], v[136:139], a[80:83]
  ds_read_b128 v[128:131], v5 offset:39424
  v_and_b32 v189, s44, v233
  v_cvt_pk_bf16_f32 v226, 0, v226
  v_mfma_f32_16x16x32_bf16 a[84:87], v[132:135], v[144:147], a[84:87]
  ds_read_b128 v[84:87], v4 offset:5120
  v_cvt_pk_bf16_f32 v227, 0, v227
  v_mfma_f32_16x16x32_bf16 a[88:91], v[132:135], v[152:155], a[88:91]
  ds_read_b128 v[88:91], v4 offset:6144
  v_lshlrev_b32 v190, 16, v237
  v_and_b32 v191, s44, v237
  v_mfma_f32_16x16x32_bf16 a[92:95], v[132:135], v[160:163], a[92:95]
  ds_read_b128 v[92:95], v4 offset:7168
  v_subrev_f32 v226, v188, v226
  s_waitcnt lgkmcnt(10)
  v_mfma_f32_16x16x32_bf16 a[96:99], v[112:115], v[136:139], a[96:99]
  ds_read_b128 v[132:135], v5 offset:39680
  v_subrev_f32 v227, v189, v227
  v_mul_f32 v190, s42, v190
  v_mfma_f32_16x16x32_bf16 a[100:103], v[112:115], v[144:147], a[100:103]
  ds_read_b128 v[96:99], v4 offset:8192
  v_mul_f32 v191, s43, v191
  v_mfma_f32_16x16x32_bf16 a[104:107], v[112:115], v[152:155], a[104:107]
  buffer_load_dwordx4 v8, s[4:7], s48 offen offset:2048 sc1 lds
  v_cvt_pk_bf16_f32 v226, 0, v226
  v_cvt_pk_bf16_f32 v227, 0, v227
  v_mfma_f32_16x16x32_bf16 a[108:111], v[112:115], v[160:163], a[108:111]
  ds_read_b128 v[100:103], v4 offset:9216
  v_mul_f32 v226, v190, v226
  s_waitcnt lgkmcnt(10)
  v_mfma_f32_16x16x32_bf16 a[112:115], v[116:119], v[136:139], a[112:115]
  s_add_u32 m0, s37, 73728
  v_mul_f32 v227, v191, v227
  v_cvt_pk_bf16_f32 v233, v226, v227
  v_mfma_f32_16x16x32_bf16 a[116:119], v[116:119], v[144:147], a[116:119]
  ds_read_b128 v[104:107], v4 offset:10240
  v_cvt_f32_i32 v228, v228
  v_mfma_f32_16x16x32_bf16 a[120:123], v[116:119], v[152:155], a[120:123]
  v_cvt_f32_i32 v229, v229
  v_lshlrev_b32 v188, 16, v234
  v_and_b32 v189, s44, v234
  v_mfma_f32_16x16x32_bf16 a[124:127], v[116:119], v[160:163], a[124:127]
  ds_read_b128 v[108:111], v4 offset:11264
  v_cvt_pk_bf16_f32 v228, 0, v228
  v_mfma_f32_16x16x32_bf16 a[128:131], v[120:123], v[136:139], a[128:131]
  v_cvt_pk_bf16_f32 v229, 0, v229
  v_lshlrev_b32 v190, 16, v238
  v_mfma_f32_16x16x32_bf16 a[132:135], v[120:123], v[144:147], a[132:135]
  v_and_b32 v191, s44, v238
  v_subrev_f32 v228, v188, v228
  v_subrev_f32 v229, v189, v229
  v_mfma_f32_16x16x32_bf16 a[136:139], v[120:123], v[152:155], a[136:139]
  buffer_load_dwordx4 v9, s[4:7], s48 offen offset:0 sc1 lds
  v_mul_f32 v190, s42, v190
  v_mfma_f32_16x16x32_bf16 a[140:143], v[120:123], v[160:163], a[140:143]
  v_mul_f32 v191, s43, v191
  v_cvt_pk_bf16_f32 v228, 0, v228
  v_mfma_f32_16x16x32_bf16 a[144:147], v[124:127], v[136:139], a[144:147]
  v_cvt_pk_bf16_f32 v229, 0, v229
  v_mul_f32 v228, v190, v228
  v_mul_f32 v229, v191, v229
  v_mfma_f32_16x16x32_bf16 a[148:151], v[124:127], v[144:147], a[148:151]
  v_cvt_pk_bf16_f32 v234, v228, v229
  v_cvt_f32_i32 v230, v230
  v_mfma_f32_16x16x32_bf16 a[152:155], v[124:127], v[152:155], a[152:155]
  v_cvt_f32_i32 v231, v231
  v_lshlrev_b32 v188, 16, v235
  v_mfma_f32_16x16x32_bf16 a[156:159], v[124:127], v[160:163], a[156:159]
  v_and_b32 v189, s44, v235
  v_cvt_pk_bf16_f32 v230, 0, v230
  v_cvt_pk_bf16_f32 v231, 0, v231
  s_waitcnt lgkmcnt(4)
  v_mfma_f32_16x16x32_bf16 a[160:163], v[128:131], v[136:139], a[160:163]
  buffer_load_dwordx4 v9, s[4:7], s48 offen offset:1024 sc1 lds
  v_lshlrev_b32 v190, 16, v239
  v_mfma_f32_16x16x32_bf16 a[164:167], v[128:131], v[144:147], a[164:167]
  v_and_b32 v191, s44, v239
  v_subrev_f32 v230, v188, v230
  v_mfma_f32_16x16x32_bf16 a[168:171], v[128:131], v[152:155], a[168:171]
  v_subrev_f32 v231, v189, v231
  v_mul_f32 v190, s42, v190
  v_mul_f32 v191, s43, v191
  v_mfma_f32_16x16x32_bf16 a[172:175], v[128:131], v[160:163], a[172:175]
  v_cvt_pk_bf16_f32 v230, 0, v230
  v_cvt_pk_bf16_f32 v231, 0, v231
  v_mfma_f32_16x16x32_bf16 a[176:179], v[132:135], v[136:139], a[176:179]
  v_mul_f32 v230, v190, v230
  v_mul_f32 v231, v191, v231
  v_mfma_f32_16x16x32_bf16 a[180:183], v[132:135], v[144:147], a[180:183]
  v_cvt_pk_bf16_f32 v235, v230, v231
  buffer_store_dwordx4 v[232:235], v8, s[4:7], s77 offen offset:2048 sc1
  v_mfma_f32_16x16x32_bf16 a[184:187], v[132:135], v[152:155], a[184:187]
  buffer_load_dwordx4 v9, s[4:7], s48 offen offset:2048 sc1 lds
  v_mfma_f32_16x16x32_bf16 a[188:191], v[132:135], v[160:163], a[188:191]
  s_mul_i32 s48, s90, 48
  v_mfma_f32_16x16x32_bf16 v[136:139], v[64:67], v[16:19], v[168:171]
  buffer_load_dwordx4 v[240:243], v184, s[12:15], s45 offen offset:128 sc0 sc1 nt
  buffer_load_dwordx4 v[244:247], v184, s[12:15], s45 offen offset:144 sc0 sc1 nt
  v_mfma_f32_16x16x32_bf16 v[136:139], v[68:71], v[20:23], v[136:139]
  ds_read_b128 v[112:115], v5 offset:0
  buffer_load_dwordx4 v[248:251], v185, s[24:27], s46 offen offset:64
  v_mfma_f32_16x16x32_bf16 v[136:139], v[72:75], v[24:27], v[136:139]
  buffer_load_dwordx4 v[252:255], v185, s[20:23], s46 offen offset:64
  buffer_load_dwordx4 v[224:227], v184, s[12:15], s45 offen offset:0 sc0 sc1 nt
  v_mfma_f32_16x16x32_bf16 v[136:139], v[76:79], v[28:31], v[136:139]
  ds_read_b128 v[116:119], v5 offset:256
  buffer_load_dwordx4 v[228:231], v184, s[12:15], s45 offen offset:16 sc0 sc1 nt
  s_waitcnt lgkmcnt(2)
  v_mfma_f32_16x16x32_bf16 v[136:139], v[80:83], v[32:35], v[136:139]
  buffer_load_dwordx4 v[232:235], v185, s[24:27], s46 offen offset:0
  buffer_load_dwordx4 v[236:239], v185, s[20:23], s46 offen offset:0
  v_mfma_f32_16x16x32_bf16 v[136:139], v[84:87], v[36:39], v[136:139]
  ds_read_b128 v[120:123], v5 offset:512
  v_mfma_f32_16x16x32_bf16 v[140:143], v[88:91], v[16:19], v[168:171]
  buffer_load_short_d16_hi v10, v187, s[32:35], s47 offen
  buffer_load_short_d16_hi v11, v187, s[28:31], s47 offen
  v_mfma_f32_16x16x32_bf16 v[140:143], v[92:95], v[20:23], v[140:143]
  ds_read_b128 v[124:127], v5 offset:768
  buffer_load_dwordx3 v[192:194], v186, s[16:19], s45 offen offset:0 sc0 sc1 nt
  v_mfma_f32_16x16x32_bf16 v[140:143], v[96:99], v[24:27], v[140:143]
  buffer_load_dwordx3 v[196:198], v186, s[16:19], s45 offen offset:768 sc0 sc1 nt
  buffer_load_dwordx3 v[200:202], v186, s[16:19], s45 offen offset:1536 sc0 sc1 nt
  v_mfma_f32_16x16x32_bf16 v[140:143], v[100:103], v[28:31], v[140:143]
  ds_read_b128 v[128:131], v5 offset:1024
  buffer_load_dwordx3 v[204:206], v186, s[16:19], s45 offen offset:2304 sc0 sc1 nt
  v_mfma_f32_16x16x32_bf16 v[140:143], v[104:107], v[32:35], v[140:143]
  buffer_load_dwordx3 v[208:210], v186, s[16:19], s49 offen offset:0 sc0 sc1 nt
  buffer_load_dwordx3 v[212:214], v186, s[16:19], s49 offen offset:768 sc0 sc1 nt
  v_mfma_f32_16x16x32_bf16 v[140:143], v[108:111], v[36:39], v[140:143]
  ds_read_b128 v[132:135], v5 offset:1280
  v_mfma_f32_16x16x32_bf16 v[144:147], v[64:67], v[40:43], v[172:175]
  v_exp_f32 v136, v136
  v_mfma_f32_16x16x32_bf16 v[144:147], v[68:71], v[44:47], v[144:147]
  v_exp_f32 v137, v137
  v_mfma_f32_16x16x32_bf16 v[144:147], v[72:75], v[48:51], v[144:147]
  v_exp_f32 v138, v138
  v_mfma_f32_16x16x32_bf16 v[144:147], v[76:79], v[52:55], v[144:147]
  v_exp_f32 v139, v139
  v_mfma_f32_16x16x32_bf16 v[144:147], v[80:83], v[56:59], v[144:147]
  v_cvt_pk_bf16_f32 v136, v136, v137
  v_cvt_pk_bf16_f32 v137, v138, v139
  v_mfma_f32_16x16x32_bf16 v[144:147], v[84:87], v[60:63], v[144:147]
  v_exp_f32 v140, v140
  v_mfma_f32_16x16x32_bf16 v[148:151], v[88:91], v[40:43], v[172:175]
  v_exp_f32 v141, v141
  v_mfma_f32_16x16x32_bf16 v[148:151], v[92:95], v[44:47], v[148:151]
  v_exp_f32 v142, v142
  v_mfma_f32_16x16x32_bf16 v[148:151], v[96:99], v[48:51], v[148:151]
  v_exp_f32 v143, v143
  v_mfma_f32_16x16x32_bf16 v[148:151], v[100:103], v[52:55], v[148:151]
  v_cvt_pk_bf16_f32 v138, v140, v141
  v_cvt_pk_bf16_f32 v139, v142, v143
  v_mfma_f32_16x16x32_bf16 v[148:151], v[104:107], v[56:59], v[148:151]
  s_add_u32 s3, s3, 512
  buffer_load_dwordx3 v[216:218], v186, s[16:19], s49 offen offset:1536 sc0 sc1 nt
  v_mfma_f32_16x16x32_bf16 v[148:151], v[108:111], v[60:63], v[148:151]
  s_xor_b32 s90, s3, s76
  buffer_load_dwordx3 v[220:222], v186, s[16:19], s49 offen offset:2304 sc0 sc1 nt
  v_mfma_f32_16x16x32_bf16 v[152:155], v[64:67], a[208:211], v[176:179]
  v_exp_f32 v144, v144
  v_mfma_f32_16x16x32_bf16 v[152:155], v[68:71], a[212:215], v[152:155]
  v_exp_f32 v145, v145
  v_mfma_f32_16x16x32_bf16 v[152:155], v[72:75], a[216:219], v[152:155]
  v_exp_f32 v146, v146
  v_mfma_f32_16x16x32_bf16 v[152:155], v[76:79], a[220:223], v[152:155]
  v_exp_f32 v147, v147
  v_mfma_f32_16x16x32_bf16 v[152:155], v[80:83], a[224:227], v[152:155]
  v_cvt_pk_bf16_f32 v144, v144, v145
  v_cvt_pk_bf16_f32 v145, v146, v147
  v_mfma_f32_16x16x32_bf16 v[152:155], v[84:87], a[228:231], v[152:155]
  v_exp_f32 v148, v148
  v_mfma_f32_16x16x32_bf16 v[156:159], v[88:91], a[208:211], v[176:179]
  v_exp_f32 v149, v149
  v_mfma_f32_16x16x32_bf16 v[156:159], v[92:95], a[212:215], v[156:159]
  v_exp_f32 v150, v150
  v_mfma_f32_16x16x32_bf16 v[156:159], v[96:99], a[216:219], v[156:159]
  v_exp_f32 v151, v151
  v_mfma_f32_16x16x32_bf16 v[156:159], v[100:103], a[220:223], v[156:159]
  v_cvt_pk_bf16_f32 v146, v148, v149
  v_cvt_pk_bf16_f32 v147, v150, v151
  v_mfma_f32_16x16x32_bf16 v[156:159], v[104:107], a[224:227], v[156:159]
  s_and_b32 s90, s90, 0x7e00
  s_mov_b32 s77, s45
  v_mfma_f32_16x16x32_bf16 v[156:159], v[108:111], a[228:231], v[156:159]
  s_mov_b32 s78, s46
  s_add_u32 s45, s45, 196608
  v_mfma_f32_16x16x32_bf16 v[160:163], v[64:67], a[232:235], v[180:183]
  v_exp_f32 v152, v152
  v_mfma_f32_16x16x32_bf16 v[160:163], v[68:71], a[236:239], v[160:163]
  v_exp_f32 v153, v153
  v_mfma_f32_16x16x32_bf16 v[160:163], v[72:75], a[240:243], v[160:163]
  v_exp_f32 v154, v154
  v_mfma_f32_16x16x32_bf16 v[160:163], v[76:79], a[244:247], v[160:163]
  v_exp_f32 v155, v155
  v_mfma_f32_16x16x32_bf16 v[160:163], v[80:83], a[248:251], v[160:163]
  v_cvt_pk_bf16_f32 v152, v152, v153
  v_cvt_pk_bf16_f32 v153, v154, v155
  v_mfma_f32_16x16x32_bf16 v[160:163], v[84:87], a[252:255], v[160:163]
  v_exp_f32 v156, v156
  v_mfma_f32_16x16x32_bf16 v[164:167], v[88:91], a[232:235], v[180:183]
  v_exp_f32 v157, v157
  v_mfma_f32_16x16x32_bf16 v[164:167], v[92:95], a[236:239], v[164:167]
  v_exp_f32 v158, v158
  v_mfma_f32_16x16x32_bf16 v[164:167], v[96:99], a[240:243], v[164:167]
  v_exp_f32 v159, v159
  v_mfma_f32_16x16x32_bf16 v[164:167], v[100:103], a[244:247], v[164:167]
  v_cvt_pk_bf16_f32 v154, v156, v157
  v_cvt_pk_bf16_f32 v155, v158, v159
  v_mfma_f32_16x16x32_bf16 v[164:167], v[104:107], a[248:251], v[164:167]
  s_add_u32 s49, s49, 196608
  s_add_u32 s46, s46, 3072
  s_waitcnt lgkmcnt(0)
  v_mfma_f32_16x16x32_bf16 v[164:167], v[108:111], a[252:255], v[164:167]
  s_add_u32 s47, s47, 512
  v_mfma_f32_16x16x32_bf16 a[0:3], v[112:115], v[136:139], a[0:3]
  v_exp_f32 v160, v160
  v_mfma_f32_16x16x32_bf16 a[4:7], v[112:115], v[144:147], a[4:7]
  v_exp_f32 v161, v161
  v_mfma_f32_16x16x32_bf16 a[8:11], v[112:115], v[152:155], a[8:11]
  v_exp_f32 v162, v162
  v_mfma_f32_16x16x32_bf16 a[16:19], v[116:119], v[136:139], a[16:19]
  v_exp_f32 v163, v163
  v_mfma_f32_16x16x32_bf16 a[20:23], v[116:119], v[144:147], a[20:23]
  v_cvt_pk_bf16_f32 v160, v160, v161
  v_cvt_pk_bf16_f32 v161, v162, v163
  v_mfma_f32_16x16x32_bf16 a[24:27], v[116:119], v[152:155], a[24:27]
  v_exp_f32 v164, v164
  v_mfma_f32_16x16x32_bf16 a[32:35], v[120:123], v[136:139], a[32:35]
  v_exp_f32 v165, v165
  v_mfma_f32_16x16x32_bf16 a[36:39], v[120:123], v[144:147], a[36:39]
  v_exp_f32 v166, v166
  v_mfma_f32_16x16x32_bf16 a[40:43], v[120:123], v[152:155], a[40:43]
  v_exp_f32 v167, v167
  v_mfma_f32_16x16x32_bf16 a[48:51], v[124:127], v[136:139], a[48:51]
  v_cvt_pk_bf16_f32 v162, v164, v165
  v_cvt_pk_bf16_f32 v163, v166, v167
  v_mfma_f32_16x16x32_bf16 a[52:55], v[124:127], v[144:147], a[52:55]
  s_waitcnt vmcnt(34)
  v_cmp_eq_u64 vcc, s[88:89], v[2:3]
  s_add_u32 m0, s37, 36864
  v_mfma_f32_16x16x32_bf16 a[56:59], v[124:127], v[152:155], a[56:59]
  s_waitcnt vmcnt(28)
  s_barrier
  v_mfma_f32_16x16x32_bf16 a[192:195], v[12:15], v[136:139], a[192:195]
  s_cbranch_vccz L_slow6
L_ret6:
  v_mfma_f32_16x16x32_bf16 a[196:199], v[12:15], v[144:147], a[196:199]
  ds_read_b128 v[64:67], v4 offset:12288
  v_mfma_f32_16x16x32_bf16 a[200:203], v[12:15], v[152:155], a[200:203]
  buffer_load_dwordx4 v8, s[4:7], s40 offen offset:0 sc1 lds
  v_mfma_f32_16x16x32_bf16 a[12:15], v[112:115], v[160:163], a[12:15]
  ds_read_b128 v[68:71], v4 offset:13312
  v_mfma_f32_16x16x32_bf16 a[28:31], v[116:119], v[160:163], a[28:31]
  ds_read_b128 v[112:115], v5 offset:1536
  v_mfma_f32_16x16x32_bf16 a[44:47], v[120:123], v[160:163], a[44:47]
  ds_read_b128 v[116:119], v5 offset:1792
  v_mfma_f32_16x16x32_bf16 a[60:63], v[124:127], v[160:163], a[60:63]
  ds_read_b128 v[120:123], v5 offset:2048
  v_mfma_f32_16x16x32_bf16 a[204:207], v[12:15], v[160:163], a[204:207]
  ds_read_b128 v[124:127], v5 offset:2304
  v_mfma_f32_16x16x32_bf16 a[64:67], v[128:131], v[136:139], a[64:67]
  ds_read_b128 v[72:75], v4 offset:14336
  v_mfma_f32_16x16x32_bf16 a[68:71], v[128:131], v[144:147], a[68:71]
  ds_read_b128 v[76:79], v4 offset:15360
  v_mfma_f32_16x16x32_bf16 a[72:75], v[128:131], v[152:155], a[72:75]
  buffer_load_dwordx4 v8, s[4:7], s40 offen offset:1024 sc1 lds
  v_mfma_f32_16x16x32_bf16 a[76:79], v[128:131], v[160:163], a[76:79]
  ds_read_b128 v[80:83], v4 offset:16384
  v_mfma_f32_16x16x32_bf16 a[80:83], v[132:135], v[136:139], a[80:83]
  ds_read_b128 v[128:131], v5 offset:2560
  v_mfma_f32_16x16x32_bf16 a[84:87], v[132:135], v[144:147], a[84:87]
  ds_read_b128 v[84:87], v4 offset:17408
  v_mfma_f32_16x16x32_bf16 a[88:91], v[132:135], v[152:155], a[88:91]
  ds_read_b128 v[88:91], v4 offset:18432
  v_mfma_f32_16x16x32_bf16 a[92:95], v[132:135], v[160:163], a[92:95]
  ds_read_b128 v[92:95], v4 offset:19456
  s_waitcnt lgkmcnt(10)
  v_mfma_f32_16x16x32_bf16 a[96:99], v[112:115], v[136:139], a[96:99]
  ds_read_b128 v[132:135], v5 offset:2816
  v_mfma_f32_16x16x32_bf16 a[100:103], v[112:115], v[144:147], a[100:103]
  ds_read_b128 v[96:99], v4 offset:20480
  v_mfma_f32_16x16x32_bf16 a[104:107], v[112:115], v[152:155], a[104:107]
  buffer_load_dwordx4 v8, s[4:7], s40 offen offset:2048 sc1 lds
  v_mfma_f32_16x16x32_bf16 a[108:111], v[112:115], v[160:163], a[108:111]
  ds_read_b128 v[100:103], v4 offset:21504
  s_waitcnt lgkmcnt(10)
  v_mfma_f32_16x16x32_bf16 a[112:115], v[116:119], v[136:139], a[112:115]
  s_add_u32 m0, s37, 86016
  v_mfma_f32_16x16x32_bf16 a[116:119], v[116:119], v[144:147], a[116:119]
  ds_read_b128 v[104:107], v4 offset:22528
  v_mfma_f32_16x16x32_bf16 a[120:123], v[116:119], v[152:155], a[120:123]
  v_mfma_f32_16x16x32_bf16 a[124:127], v[116:119], v[160:163], a[124:127]
  ds_read_b128 v[108:111], v4 offset:23552
  v_mfma_f32_16x16x32_bf16 a[128:131], v[120:123], v[136:139], a[128:131]
  v_mfma_f32_16x16x32_bf16 a[132:135], v[120:123], v[144:147], a[132:135]
  v_mfma_f32_16x16x32_bf16 a[136:139], v[120:123], v[152:155], a[136:139]
  buffer_load_dwordx4 v9, s[4:7], s40 offen offset:0 sc1 lds
  v_mfma_f32_16x16x32_bf16 a[140:143], v[120:123], v[160:163], a[140:143]
  v_mfma_f32_16x16x32_bf16 a[144:147], v[124:127], v[136:139], a[144:147]
  v_mfma_f32_16x16x32_bf16 a[148:151], v[124:127], v[144:147], a[148:151]
  v_mfma_f32_16x16x32_bf16 a[152:155], v[124:127], v[152:155], a[152:155]
  v_mfma_f32_16x16x32_bf16 a[156:159], v[124:127], v[160:163], a[156:159]
  s_waitcnt lgkmcnt(4)
  v_mfma_f32_16x16x32_bf16 a[160:163], v[128:131], v[136:139], a[160:163]
  buffer_load_dwordx4 v9, s[4:7], s40 offen offset:1024 sc1 lds
  v_mfma_f32_16x16x32_bf16 a[164:167], v[128:131], v[144:147], a[164:167]
  v_mfma_f32_16x16x32_bf16 a[168:171], v[128:131], v[152:155], a[168:171]
  v_mfma_f32_16x16x32_bf16 a[172:175], v[128:131], v[160:163], a[172:175]
  v_mfma_f32_16x16x32_bf16 a[176:179], v[132:135], v[136:139], a[176:179]
  v_mfma_f32_16x16x32_bf16 a[180:183], v[132:135], v[144:147], a[180:183]
  v_mfma_f32_16x16x32_bf16 a[184:187], v[132:135], v[152:155], a[184:187]
  buffer_load_dwordx4 v9, s[4:7], s40 offen offset:2048 sc1 lds
  v_mfma_f32_16x16x32_bf16 a[188:191], v[132:135], v[160:163], a[188:191]
  s_mul_i32 s40, s90, 48
  v_mfma_f32_16x16x32_bf16 v[136:139], v[64:67], v[16:19], v[168:171]
  s_waitcnt vmcnt(23)
  v_cvt_f32_i32 v240, v240
  v_cvt_f32_i32 v241, v241
  v_mfma_f32_16x16x32_bf16 v[136:139], v[68:71], v[20:23], v[136:139]
  ds_read_b128 v[112:115], v5 offset:12288
  s_waitcnt vmcnt(21)
  v_lshlrev_b32 v188, 16, v248
  v_mfma_f32_16x16x32_bf16 v[136:139], v[72:75], v[24:27], v[136:139]
  v_and_b32 v189, s44, v248
  v_cvt_pk_bf16_f32 v240, 0, v240
  v_mfma_f32_16x16x32_bf16 v[136:139], v[76:79], v[28:31], v[136:139]
  ds_read_b128 v[116:119], v5 offset:12544
  v_cvt_pk_bf16_f32 v241, 0, v241
  s_waitcnt lgkmcnt(2)
  v_mfma_f32_16x16x32_bf16 v[136:139], v[80:83], v[32:35], v[136:139]
  s_waitcnt vmcnt(20)
  v_lshlrev_b32 v190, 16, v252
  v_mfma_f32_16x16x32_bf16 v[136:139], v[84:87], v[36:39], v[136:139]
  ds_read_b128 v[120:123], v5 offset:12800
  v_and_b32 v191, s44, v252
  v_mfma_f32_16x16x32_bf16 v[140:143], v[88:91], v[16:19], v[168:171]
  v_subrev_f32 v240, v188, v240
  v_subrev_f32 v241, v189, v241
  v_mfma_f32_16x16x32_bf16 v[140:143], v[92:95], v[20:23], v[140:143]
  ds_read_b128 v[124:127], v5 offset:13056
  v_mul_f32 v190, s42, v190
  v_mfma_f32_16x16x32_bf16 v[140:143], v[96:99], v[24:27], v[140:143]
  v_mul_f32 v191, s43, v191
  v_cvt_pk_bf16_f32 v240, 0, v240
  v_mfma_f32_16x16x32_bf16 v[140:143], v[100:103], v[28:31], v[140:143]
  ds_read_b128 v[128:131], v5 offset:13312
  v_cvt_pk_bf16_f32 v241, 0, v241
  v_mfma_f32_16x16x32_bf16 v[140:143], v[104:107], v[32:35], v[140:143]
  v_mul_f32 v240, v190, v240
  v_mfma_f32_16x16x32_bf16 v[140:143], v[108:111], v[36:39], v[140:143]
  ds_read_b128 v[132:135], v5 offset:13568
  v_mul_f32 v241, v191, v241
  v_mfma_f32_16x16x32_bf16 v[144:147], v[64:67], v[40:43], v[172:175]
  v_exp_f32 v136, v136
  v_mfma_f32_16x16x32_bf16 v[144:147], v[68:71], v[44:47], v[144:147]
  v_exp_f32 v137, v137
  v_mfma_f32_16x16x32_bf16 v[144:147], v[72:75], v[48:51], v[144:147]
  v_exp_f32 v138, v138
  v_mfma_f32_16x16x32_bf16 v[144:147], v[76:79], v[52:55], v[144:147]
  v_exp_f32 v139, v139
  v_mfma_f32_16x16x32_bf16 v[144:147], v[80:83], v[56:59], v[144:147]
  v_cvt_pk_bf16_f32 v136, v136, v137
  v_cvt_pk_bf16_f32 v137, v138, v139
  v_mfma_f32_16x16x32_bf16 v[144:147], v[84:87], v[60:63], v[144:147]
  v_exp_f32 v140, v140
  v_mfma_f32_16x16x32_bf16 v[148:151], v[88:91], v[40:43], v[172:175]
  v_exp_f32 v141, v141
  v_mfma_f32_16x16x32_bf16 v[148:151], v[92:95], v[44:47], v[148:151]
  v_exp_f32 v142, v142
  v_mfma_f32_16x16x32_bf16 v[148:151], v[96:99], v[48:51], v[148:151]
  v_exp_f32 v143, v143
  v_mov_b32 v6, s88
  v_mov_b32 v7, s89
  buffer_store_dwordx2 v[6:7], v1, s[4:7], s91 offen sc1
  s_add_u32 s91, s91, 4096
  v_mfma_f32_16x16x32_bf16 v[148:151], v[100:103], v[52:55], v[148:151]
  v_cvt_pk_bf16_f32 v138, v140, v141
  v_cvt_pk_bf16_f32 v139, v142, v143
  v_mfma_f32_16x16x32_bf16 v[148:151], v[104:107], v[56:59], v[148:151]
  s_add_u32 s3, s3, 512
  v_cvt_pk_bf16_f32 v248, v240, v241
  v_mfma_f32_16x16x32_bf16 v[148:151], v[108:111], v[60:63], v[148:151]
  s_xor_b32 s90, s3, s76
  v_cvt_f32_i32 v242, v242
  v_mfma_f32_16x16x32_bf16 v[152:155], v[64:67], a[208:211], v[176:179]
  v_exp_f32 v144, v144
  v_mfma_f32_16x16x32_bf16 v[152:155], v[68:71], a[212:215], v[152:155]
  v_exp_f32 v145, v145
  v_mfma_f32_16x16x32_bf16 v[152:155], v[72:75], a[216:219], v[152:155]
  v_exp_f32 v146, v146
  v_mfma_f32_16x16x32_bf16 v[152:155], v[76:79], a[220:223], v[152:155]
  v_exp_f32 v147, v147
  v_mfma_f32_16x16x32_bf16 v[152:155], v[80:83], a[224:227], v[152:155]
  v_cvt_pk_bf16_f32 v144, v144, v145
  v_cvt_pk_bf16_f32 v145, v146, v147
  v_mfma_f32_16x16x32_bf16 v[152:155], v[84:87], a[228:231], v[152:155]
  v_exp_f32 v148, v148
  v_mfma_f32_16x16x32_bf16 v[156:159], v[88:91], a[208:211], v[176:179]
  v_exp_f32 v149, v149
  v_mfma_f32_16x16x32_bf16 v[156:159], v[92:95], a[212:215], v[156:159]
  v_exp_f32 v150, v150
  v_mfma_f32_16x16x32_bf16 v[156:159], v[96:99], a[216:219], v[156:159]
  v_exp_f32 v151, v151
  v_mfma_f32_16x16x32_bf16 v[156:159], v[100:103], a[220:223], v[156:159]
  v_cvt_pk_bf16_f32 v146, v148, v149
  v_cvt_pk_bf16_f32 v147, v150, v151
  v_mfma_f32_16x16x32_bf16 v[156:159], v[104:107], a[224:227], v[156:159]
  s_and_b32 s90, s90, 0x7e00
  v_cvt_f32_i32 v243, v243
  v_mfma_f32_16x16x32_bf16 v[156:159], v[108:111], a[228:231], v[156:159]
  v_lshlrev_b32 v188, 16, v249
  v_and_b32 v189, s44, v249
  v_mfma_f32_16x16x32_bf16 v[160:163], v[64:67], a[232:235], v[180:183]
  v_exp_f32 v152, v152
  v_mfma_f32_16x16x32_bf16 v[160:163], v[68:71], a[236:239], v[160:163]
  v_exp_f32 v153, v153
  v_mfma_f32_16x16x32_bf16 v[160:163], v[72:75], a[240:243], v[160:163]
  v_exp_f32 v154, v154
  v_mfma_f32_16x16x32_bf16 v[160:163], v[76:79], a[244:247], v[160:163]
  v_exp_f32 v155, v155
  v_mfma_f32_16x16x32_bf16 v[160:163], v[80:83], a[248:251], v[160:163]
  v_cvt_pk_bf16_f32 v152, v152, v153
  v_cvt_pk_bf16_f32 v153, v154, v155
  v_mfma_f32_16x16x32_bf16 v[160:163], v[84:87], a[252:255], v[160:163]
  v_exp_f32 v156, v156
  v_mfma_f32_16x16x32_bf16 v[164:167], v[88:91], a[232:235], v[180:183]
  v_exp_f32 v157, v157
  v_mfma_f32_16x16x32_bf16 v[164:167], v[92:95], a[236:239], v[164:167]
  v_exp_f32 v158, v158
  v_mfma_f32_16x16x32_bf16 v[164:167], v[96:99], a[240:243], v[164:167]
  v_exp_f32 v159, v159
  v_mfma_f32_16x16x32_bf16 v[164:167], v[100:103], a[244:247], v[164:167]
  v_cvt_pk_bf16_f32 v154, v156, v157
  v_cvt_pk_bf16_f32 v155, v158, v159
  v_mfma_f32_16x16x32_bf16 v[164:167], v[104:107], a[248:251], v[164:167]
  v_cvt_pk_bf16_f32 v242, 0, v242
  s_waitcnt lgkmcnt(0)
  v_mfma_f32_16x16x32_bf16 v[164:167], v[108:111], a[252:255], v[164:167]
  v_cvt_pk_bf16_f32 v243, 0, v243
  v_lshlrev_b32 v190, 16, v253
  v_mfma_f32_16x16x32_bf16 a[0:3], v[112:115], v[136:139], a[0:3]
  v_exp_f32 v160, v160
  v_mfma_f32_16x16x32_bf16 a[4:7], v[112:115], v[144:147], a[4:7]
  v_exp_f32 v161, v161
  v_mfma_f32_16x16x32_bf16 a[8:11], v[112:115], v[152:155], a[8:11]
  v_exp_f32 v162, v162
  v_mfma_f32_16x16x32_bf16 a[16:19], v[116:119], v[136:139], a[16:19]
  v_exp_f32 v163, v163
  v_mfma_f32_16x16x32_bf16 a[20:23], v[116:119], v[144:147], a[20:23]
  v_cvt_pk_bf16_f32 v160, v160, v161
  v_cvt_pk_bf16_f32 v161, v162, v163
  v_mfma_f32_16x16x32_bf16 a[24:27], v[116:119], v[152:155], a[24:27]
  v_exp_f32 v164, v164
  v_mfma_f32_16x16x32_bf16 a[32:35], v[120:123], v[136:139], a[32:35]
  v_exp_f32 v165, v165
  v_mfma_f32_16x16x32_bf16 a[36:39], v[120:123], v[144:147], a[36:39]
  v_exp_f32 v166, v166
  v_mfma_f32_16x16x32_bf16 a[40:43], v[120:123], v[152:155], a[40:43]
  v_exp_f32 v167, v167
  v_mfma_f32_16x16x32_bf16 a[48:51], v[124:127], v[136:139], a[48:51]
  v_cvt_pk_bf16_f32 v162, v164, v165
  v_cvt_pk_bf16_f32 v163, v166, v167
  v_mfma_f32_16x16x32_bf16 a[52:55], v[124:127], v[144:147], a[52:55]
  s_add_u32 m0, s37, 0
  v_and_b32 v191, s44, v253
  v_mfma_f32_16x16x32_bf16 a[56:59], v[124:127], v[152:155], a[56:59]
  s_barrier
  v_mfma_f32_16x16x32_bf16 a[192:195], v[12:15], v[136:139], a[192:195]
  v_mfma_f32_16x16x32_bf16 a[196:199], v[12:15], v[144:147], a[196:199]
  ds_read_b128 v[64:67], v4 offset:24576
  v_subrev_f32 v242, v188, v242
  v_mfma_f32_16x16x32_bf16 a[200:203], v[12:15], v[152:155], a[200:203]
  buffer_load_dwordx4 v8, s[4:7], s48 offen offset:0 sc1 lds
  v_subrev_f32 v243, v189, v243
  v_mfma_f32_16x16x32_bf16 a[12:15], v[112:115], v[160:163], a[12:15]
  ds_read_b128 v[68:71], v4 offset:25600
  v_mul_f32 v190, s42, v190
  v_mfma_f32_16x16x32_bf16 a[28:31], v[116:119], v[160:163], a[28:31]
  ds_read_b128 v[112:115], v5 offset:13824
  v_mfma_f32_16x16x32_bf16 a[44:47], v[120:123], v[160:163], a[44:47]
  ds_read_b128 v[116:119], v5 offset:14080
  v_mul_f32 v191, s43, v191
  v_mfma_f32_16x16x32_bf16 a[60:63], v[124:127], v[160:163], a[60:63]
  ds_read_b128 v[120:123], v5 offset:14336
  v_cvt_pk_bf16_f32 v242, 0, v242
  v_mfma_f32_16x16x32_bf16 a[204:207], v[12:15], v[160:163], a[204:207]
  ds_read_b128 v[124:127], v5 offset:14592
  v_cvt_pk_bf16_f32 v243, 0, v243
  v_mfma_f32_16x16x32_bf16 a[64:67], v[128:131], v[136:139], a[64:67]
  ds_read_b128 v[72:75], v4 offset:26624
  v_mul_f32 v242, v190, v242
  v_mfma_f32_16x16x32_bf16 a[68:71], v[128:131], v[144:147], a[68:71]
  ds_read_b128 v[76:79], v4 offset:27648
  v_mul_f32 v243, v191, v243
  v_mfma_f32_16x16x32_bf16 a[72:75], v[128:131], v[152:155], a[72:75]
  buffer_load_dwordx4 v8, s[4:7], s48 offen offset:1024 sc1 lds
  v_cvt_pk_bf16_f32 v249, v242, v243
  v_mfma_f32_16x16x32_bf16 a[76:79], v[128:131], v[160:163], a[76:79]
  ds_read_b128 v[80:83], v4 offset:28672
  v_mfma_f32_16x16x32_bf16 a[80:83], v[132:135], v[136:139], a[80:83]
  ds_read_b128 v[128:131], v5 offset:14848
  v_cvt_f32_i32 v244, v244
  v_mfma_f32_16x16x32_bf16 a[84:87], v[132:135], v[144:147], a[84:87]
  ds_read_b128 v[84:87], v4 offset:29696
  v_cvt_f32_i32 v245, v245
  v_mfma_f32_16x16x32_bf16 a[88:91], v[132:135], v[152:155], a[88:91]
  ds_read_b128 v[88:91], v4 offset:30720
  v_lshlrev_b32 v188, 16, v250
  v_mfma_f32_16x16x32_bf16 a[92:95], v[132:135], v[160:163], a[92:95]
  ds_read_b128 v[92:95], v4 offset:31744
  v_and_b32 v189, s44, v250
  s_waitcnt lgkmcnt(10)
  v_mfma_f32_16x16x32_bf16 a[96:99], v[112:115], v[136:139], a[96:99]
  ds_read_b128 v[132:135], v5 offset:15104
  v_cvt_pk_bf16_f32 v244, 0, v244
  v_mfma_f32_16x16x32_bf16 a[100:103], v[112:115], v[144:147], a[100:103]
  ds_read_b128 v[96:99], v4 offset:32768
  v_cvt_pk_bf16_f32 v245, 0, v245
  v_mfma_f32_16x16x32_bf16 a[104:107], v[112:115], v[152:155], a[104:107]
  buffer_load_dwordx4 v8, s[4:7], s48 offen offset:2048 sc1 lds
  v_lshlrev_b32 v190, 16, v254
  v_mfma_f32_16x16x32_bf16 a[108:111], v[112:115], v[160:163], a[108:111]
  ds_read_b128 v[100:103], v4 offset:33792
  s_waitcnt lgkmcnt(10)
  v_mfma_f32_16x16x32_bf16 a[112:115], v[116:119], v[136:139], a[112:115]
  s_add_u32 m0, s37, 49152
  v_and_b32 v191, s44, v254
  v_mfma_f32_16x16x32_bf16 a[116:119], v[116:119], v[144:147], a[116:119]
  ds_read_b128 v[104:107], v4 offset:34816
  v_subrev_f32 v244, v188, v244
  v_mfma_f32_16x16x32_bf16 a[120:123], v[116:119], v[152:155], a[120:123]
  v_subrev_f32 v245, v189, v245
  v_mul_f32 v190, s42, v190
  v_mfma_f32_16x16x32_bf16 a[124:127], v[116:119], v[160:163], a[124:127]
  ds_read_b128 v[108:111], v4 offset:35840
  v_mul_f32 v191, s43, v191
  v_mfma_f32_16x16x32_bf16 a[128:131], v[120:123], v[136:139], a[128:131]
  v_cvt_pk_bf16_f32 v244, 0, v244
  v_cvt_pk_bf16_f32 v245, 0, v245
  v_mfma_f32_16x16x32_bf16 a[132:135], v[120:123], v[144:147], a[132:135]
  v_mul_f32 v244, v190, v244
  v_mfma_f32_16x16x32_bf16 a[136:139], v[120:123], v[152:155], a[136:139]
  buffer_load_dwordx4 v9, s[4:7], s48 offen offset:0 sc1 lds
  v_mul_f32 v245, v191, v245
  v_mfma_f32_16x16x32_bf16 a[140:143], v[120:123], v[160:163], a[140:143]
  v_cvt_pk_bf16_f32 v250, v244, v245
  v_cvt_f32_i32 v246, v246
  v_mfma_f32_16x16x32_bf16 a[144:147], v[124:127], v[136:139], a[144:147]
  v_cvt_f32_i32 v247, v247
  v_lshlrev_b32 v188, 16, v251
  v_mfma_f32_16x16x32_bf16 a[148:151], v[124:127], v[144:147], a[148:151]
  v_and_b32 v189, s44, v251
  v_mfma_f32_16x16x32_bf16 a[152:155], v[124:127], v[152:155], a[152:155]
  v_cvt_pk_bf16_f32 v246, 0, v246
  v_cvt_pk_bf16_f32 v247, 0, v247
  v_mfma_f32_16x16x32_bf16 a[156:159], v[124:127], v[160:163], a[156:159]
  v_lshlrev_b32 v190, 16, v255
  v_and_b32 v191, s44, v255
  s_waitcnt lgkmcnt(4)
  v_mfma_f32_16x16x32_bf16 a[160:163], v[128:131], v[136:139], a[160:163]
  buffer_load_dwordx4 v9, s[4:7], s48 offen offset:1024 sc1 lds
  v_subrev_f32 v246, v188, v246
  v_mfma_f32_16x16x32_bf16 a[164:167], v[128:131], v[144:147], a[164:167]
  v_subrev_f32 v247, v189, v247
  v_mul_f32 v190, s42, v190
  v_mfma_f32_16x16x32_bf16 a[168:171], v[128:131], v[152:155], a[168:171]
  v_mul_f32 v191, s43, v191
  v_mfma_f32_16x16x32_bf16 a[172:175], v[128:131], v[160:163], a[172:175]
  v_cvt_pk_bf16_f32 v246, 0, v246
  v_cvt_pk_bf16_f32 v247, 0, v247
  v_mfma_f32_16x16x32_bf16 a[176:179], v[132:135], v[136:139], a[176:179]
  v_mul_f32 v246, v190, v246
  v_mul_f32 v247, v191, v247
  v_mfma_f32_16x16x32_bf16 a[180:183], v[132:135], v[144:147], a[180:183]
  v_cvt_pk_bf16_f32 v251, v246, v247
  v_mfma_f32_16x16x32_bf16 a[184:187], v[132:135], v[152:155], a[184:187]
  buffer_load_dwordx4 v9, s[4:7], s48 offen offset:2048 sc1 lds
  v_mfma_f32_16x16x32_bf16 a[188:191], v[132:135], v[160:163], a[188:191]
  s_mul_i32 s48, s90, 48
  v_mfma_f32_16x16x32_bf16 v[136:139], v[64:67], v[16:19], v[168:171]
  buffer_store_dwordx4 v[248:251], v8, s[4:7], s77 offen offset:1024 sc1
  s_waitcnt vmcnt(27)
  v_cvt_f32_i32 v224, v224
  v_mfma_f32_16x16x32_bf16 v[136:139], v[68:71], v[20:23], v[136:139]
  ds_read_b128 v[112:115], v5 offset:24576
  v_cvt_f32_i32 v225, v225
  v_mfma_f32_16x16x32_bf16 v[136:139], v[72:75], v[24:27], v[136:139]
  s_waitcnt vmcnt(25)
  v_lshlrev_b32 v188, 16, v232
  v_and_b32 v189, s44, v232
  v_mfma_f32_16x16x32_bf16 v[136:139], v[76:79], v[28:31], v[136:139]
  ds_read_b128 v[116:119], v5 offset:24832
  v_cvt_pk_bf16_f32 v224, 0, v224
  s_waitcnt lgkmcnt(2)
  v_mfma_f32_16x16x32_bf16 v[136:139], v[80:83], v[32:35], v[136:139]
  buffer_load_dwordx4 v[240:243], v184, s[12:15], s45 offen offset:128 sc0 sc1 nt
  v_cvt_pk_bf16_f32 v225, 0, v225
  v_mfma_f32_16x16x32_bf16 v[136:139], v[84:87], v[36:39], v[136:139]
  ds_read_b128 v[120:123], v5 offset:25088
  s_waitcnt vmcnt(25)
  v_lshlrev_b32 v190, 16, v236
  v_mfma_f32_16x16x32_bf16 v[140:143], v[88:91], v[16:19], v[168:171]
  v_and_b32 v191, s44, v236
  v_subrev_f32 v224, v188, v224
  v_mfma_f32_16x16x32_bf16 v[140:143], v[92:95], v[20:23], v[140:143]
  ds_read_b128 v[124:127], v5 offset:25344
  v_subrev_f32 v225, v189, v225
  v_mfma_f32_16x16x32_bf16 v[140:143], v[96:99], v[24:27], v[140:143]
  s_xor_b32 s50, s76, 4608
  buffer_load_dwordx2 v[2:3], v1, s[4:7], s50 offen sc1
  buffer_load_dwordx4 v[244:247], v184, s[12:15], s45 offen offset:144 sc0 sc1 nt
  v_mfma_f32_16x16x32_bf16 v[140:143], v[100:103], v[28:31], v[140:143]
  ds_read_b128 v[128:131], v5 offset:25600
  v_mul_f32 v190, s42, v190
  v_mfma_f32_16x16x32_bf16 v[140:143], v[104:107], v[32:35], v[140:143]
  v_mul_f32 v191, s43, v191
  v_cvt_pk_bf16_f32 v224, 0, v224
  v_mfma_f32_16x16x32_bf16 v[140:143], v[108:111], v[36:39], v[140:143]
  ds_read_b128 v[132:135], v5 offset:25856
  v_cvt_pk_bf16_f32 v225, 0, v225
  v_mfma_f32_16x16x32_bf16 v[144:147], v[64:67], v[40:43], v[172:175]
  v_exp_f32 v136, v136
  v_mfma_f32_16x16x32_bf16 v[144:147], v[68:71], v[44:47], v[144:147]
  v_exp_f32 v137, v137
  buffer_load_dwordx4 v[248:251], v185, s[24:27], s46 offen offset:64
  v_mfma_f32_16x16x32_bf16 v[144:147], v[72:75], v[48:51], v[144:147]
  v_exp_f32 v138, v138
  v_mfma_f32_16x16x32_bf16 v[144:147], v[76:79], v[52:55], v[144:147]
  v_exp_f32 v139, v139
  v_mfma_f32_16x16x32_bf16 v[144:147], v[80:83], v[56:59], v[144:147]
  v_cvt_pk_bf16_f32 v136, v136, v137
  v_cvt_pk_bf16_f32 v137, v138, v139
  v_mfma_f32_16x16x32_bf16 v[144:147], v[84:87], v[60:63], v[144:147]
  v_exp_f32 v140, v140
  v_mfma_f32_16x16x32_bf16 v[148:151], v[88:91], v[40:43], v[172:175]
  v_exp_f32 v141, v141
  buffer_load_dwordx4 v[252:255], v185, s[20:23], s46 offen offset:64
  v_mfma_f32_16x16x32_bf16 v[148:151], v[92:95], v[44:47], v[148:151]
  v_exp_f32 v142, v142
  v_mfma_f32_16x16x32_bf16 v[148:151], v[96:99], v[48:51], v[148:151]
  v_exp_f32 v143, v143
  v_mfma_f32_16x16x32_bf16 v[148:151], v[100:103], v[52:55], v[148:151]
  v_cvt_pk_bf16_f32 v138, v140, v141
  v_cvt_pk_bf16_f32 v139, v142, v143
  v_mfma_f32_16x16x32_bf16 v[148:151], v[104:107], v[56:59], v[148:151]
  s_add_u32 s3, s3, 512
  v_mul_f32 v224, v190, v224
  v_mfma_f32_16x16x32_bf16 v[148:151], v[108:111], v[60:63], v[148:151]
  s_xor_b32 s90, s3, s76
  v_mul_f32 v225, v191, v225
  v_mfma_f32_16x16x32_bf16 v[152:155], v[64:67], a[208:211], v[176:179]
  v_exp_f32 v144, v144
  v_mfma_f32_16x16x32_bf16 v[152:155], v[68:71], a[212:215], v[152:155]
  v_exp_f32 v145, v145
  v_mfma_f32_16x16x32_bf16 v[152:155], v[72:75], a[216:219], v[152:155]
  v_exp_f32 v146, v146
  v_mfma_f32_16x16x32_bf16 v[152:155], v[76:79], a[220:223], v[152:155]
  v_exp_f32 v147, v147
  v_mfma_f32_16x16x32_bf16 v[152:155], v[80:83], a[224:227], v[152:155]
  v_cvt_pk_bf16_f32 v144, v144, v145
  v_cvt_pk_bf16_f32 v145, v146, v147
  v_mfma_f32_16x16x32_bf16 v[152:155], v[84:87], a[228:231], v[152:155]
  v_exp_f32 v148, v148
  v_mfma_f32_16x16x32_bf16 v[156:159], v[88:91], a[208:211], v[176:179]
  v_exp_f32 v149, v149
  v_mfma_f32_16x16x32_bf16 v[156:159], v[92:95], a[212:215], v[156:159]
  v_exp_f32 v150, v150
  v_mfma_f32_16x16x32_bf16 v[156:159], v[96:99], a[216:219], v[156:159]
  v_exp_f32 v151, v151
  v_mfma_f32_16x16x32_bf16 v[156:159], v[100:103], a[220:223], v[156:159]
  v_cvt_pk_bf16_f32 v146, v148, v149
  v_cvt_pk_bf16_f32 v147, v150, v151
  v_mfma_f32_16x16x32_bf16 v[156:159], v[104:107], a[224:227], v[156:159]
  s_and_b32 s90, s90, 0x7e00
  v_cvt_pk_bf16_f32 v232, v224, v225
  v_mfma_f32_16x16x32_bf16 v[156:159], v[108:111], a[228:231], v[156:159]
  v_cvt_f32_i32 v226, v226
  v_mfma_f32_16x16x32_bf16 v[160:163], v[64:67], a[232:235], v[180:183]
  v_exp_f32 v152, v152
  v_mfma_f32_16x16x32_bf16 v[160:163], v[68:71], a[236:239], v[160:163]
  v_exp_f32 v153, v153
  v_mfma_f32_16x16x32_bf16 v[160:163], v[72:75], a[240:243], v[160:163]
  v_exp_f32 v154, v154
  v_mfma_f32_16x16x32_bf16 v[160:163], v[76:79], a[244:247], v[160:163]
  v_exp_f32 v155, v155
  v_mfma_f32_16x16x32_bf16 v[160:163], v[80:83], a[248:251], v[160:163]
  v_cvt_pk_bf16_f32 v152, v152, v153
  v_cvt_pk_bf16_f32 v153, v154, v155
  v_mfma_f32_16x16x32_bf16 v[160:163], v[84:87], a[252:255], v[160:163]
  v_exp_f32 v156, v156
  v_mfma_f32_16x16x32_bf16 v[164:167], v[88:91], a[232:235], v[180:183]
  v_exp_f32 v157, v157
  v_mfma_f32_16x16x32_bf16 v[164:167], v[92:95], a[236:239], v[164:167]
  v_exp_f32 v158, v158
  v_mfma_f32_16x16x32_bf16 v[164:167], v[96:99], a[240:243], v[164:167]
  v_exp_f32 v159, v159
  v_mfma_f32_16x16x32_bf16 v[164:167], v[100:103], a[244:247], v[164:167]
  v_cvt_pk_bf16_f32 v154, v156, v157
  v_cvt_pk_bf16_f32 v155, v158, v159
  v_mfma_f32_16x16x32_bf16 v[164:167], v[104:107], a[248:251], v[164:167]
  v_cvt_f32_i32 v227, v227
  v_lshlrev_b32 v188, 16, v233
  s_waitcnt lgkmcnt(0)
  v_mfma_f32_16x16x32_bf16 v[164:167], v[108:111], a[252:255], v[164:167]
  v_and_b32 v189, s44, v233
  v_cvt_pk_bf16_f32 v226, 0, v226
  v_mfma_f32_16x16x32_bf16 a[0:3], v[112:115], v[136:139], a[0:3]
  v_exp_f32 v160, v160
  v_mfma_f32_16x16x32_bf16 a[4:7], v[112:115], v[144:147], a[4:7]
  v_exp_f32 v161, v161
  v_mfma_f32_16x16x32_bf16 a[8:11], v[112:115], v[152:155], a[8:11]
  v_exp_f32 v162, v162
  v_mfma_f32_16x16x32_bf16 a[16:19], v[116:119], v[136:139], a[16:19]
  v_exp_f32 v163, v163
  v_mfma_f32_16x16x32_bf16 a[20:23], v[116:119], v[144:147], a[20:23]
  v_cvt_pk_bf16_f32 v160, v160, v161
  v_cvt_pk_bf16_f32 v161, v162, v163
  v_mfma_f32_16x16x32_bf16 a[24:27], v[116:119], v[152:155], a[24:27]
  v_exp_f32 v164, v164
  v_mfma_f32_16x16x32_bf16 a[32:35], v[120:123], v[136:139], a[32:35]
  v_exp_f32 v165, v165
  v_mfma_f32_16x16x32_bf16 a[36:39], v[120:123], v[144:147], a[36:39]
  v_exp_f32 v166, v166
  v_mfma_f32_16x16x32_bf16 a[40:43], v[120:123], v[152:155], a[40:43]
  v_exp_f32 v167, v167
  v_mfma_f32_16x16x32_bf16 a[48:51], v[124:127], v[136:139], a[48:51]
  v_cvt_pk_bf16_f32 v162, v164, v165
  v_cvt_pk_bf16_f32 v163, v166, v167
  v_mfma_f32_16x16x32_bf16 a[52:55], v[124:127], v[144:147], a[52:55]
  s_waitcnt vmcnt(3)
  v_cmp_eq_u64 vcc, s[88:89], v[2:3]
  s_add_u32 m0, s37, 12288
  v_mfma_f32_16x16x32_bf16 a[56:59], v[124:127], v[152:155], a[56:59]
  s_barrier
  v_mfma_f32_16x16x32_bf16 a[192:195], v[12:15], v[136:139], a[192:195]
  s_cbranch_vccz L_slow7
L_ret7:
  buffer_load_dwordx2 v[2:3], v1, s[4:7], s90 offen sc1
  v_mfma_f32_16x16x32_bf16 a[196:199], v[12:15], v[144:147], a[196:199]
  ds_read_b128 v[64:67], v4 offset:36864
  s_xor_b32 s50, s76, 5120
  buffer_load_dwordx2 v[6:7], v1, s[4:7], s50 offen sc1
  v_mfma_f32_16x16x32_bf16 a[200:203], v[12:15], v[152:155], a[200:203]
  buffer_load_dwordx4 v8, s[4:7], s40 offen offset:0 sc1 lds
  v_cvt_pk_bf16_f32 v227, 0, v227
  v_mfma_f32_16x16x32_bf16 a[12:15], v[112:115], v[160:163], a[12:15]
  ds_read_b128 v[68:71], v4 offset:37888
  v_lshlrev_b32 v190, 16, v237
  v_mfma_f32_16x16x32_bf16 a[28:31], v[116:119], v[160:163], a[28:31]
  ds_read_b128 v[112:115], v5 offset:26112
  v_and_b32 v191, s44, v237
  v_mfma_f32_16x16x32_bf16 a[44:47], v[120:123], v[160:163], a[44:47]
  ds_read_b128 v[116:119], v5 offset:26368
  v_subrev_f32 v226, v188, v226
  v_mfma_f32_16x16x32_bf16 a[60:63], v[124:127], v[160:163], a[60:63]
  ds_read_b128 v[120:123], v5 offset:26624
  v_subrev_f32 v227, v189, v227
  v_mfma_f32_16x16x32_bf16 a[204:207], v[12:15], v[160:163], a[204:207]
  ds_read_b128 v[124:127], v5 offset:26880
  v_mul_f32 v190, s42, v190
  v_mfma_f32_16x16x32_bf16 a[64:67], v[128:131], v[136:139], a[64:67]
  ds_read_b128 v[72:75], v4 offset:38912
  v_mul_f32 v191, s43, v191
  v_mfma_f32_16x16x32_bf16 a[68:71], v[128:131], v[144:147], a[68:71]
  ds_read_b128 v[76:79], v4 offset:39936
  v_cvt_pk_bf16_f32 v226, 0, v226
  v_mfma_f32_16x16x32_bf16 a[72:75], v[128:131], v[152:155], a[72:75]
  buffer_load_dwordx4 v8, s[4:7], s40 offen offset:1024 sc1 lds
  v_cvt_pk_bf16_f32 v227, 0, v227
  v_mfma_f32_16x16x32_bf16 a[76:79], v[128:131], v[160:163], a[76:79]
  ds_read_b128 v[80:83], v4 offset:40960
  v_mul_f32 v226, v190, v226
  v_mfma_f32_16x16x32_bf16 a[80:83], v[132:135], v[136:139], a[80:83]
  ds_read_b128 v[128:131], v5 offset:27136
  v_mul_f32 v227, v191, v227
  v_mfma_f32_16x16x32_bf16 a[84:87], v[132:135], v[144:147], a[84:87]
  ds_read_b128 v[84:87], v4 offset:41984
  v_cvt_pk_bf16_f32 v233, v226, v227
  v_mfma_f32_16x16x32_bf16 a[88:91], v[132:135], v[152:155], a[88:91]
  ds_read_b128 v[88:91], v4 offset:43008
  v_mfma_f32_16x16x32_bf16 a[92:95], v[132:135], v[160:163], a[92:95]
  ds_read_b128 v[92:95], v4 offset:44032
  v_cvt_f32_i32 v228, v228
  s_waitcnt lgkmcnt(10)
  v_mfma_f32_16x16x32_bf16 a[96:99], v[112:115], v[136:139], a[96:99]
  ds_read_b128 v[132:135], v5 offset:27392
  v_cvt_f32_i32 v229, v229
  v_mfma_f32_16x16x32_bf16 a[100:103], v[112:115], v[144:147], a[100:103]
  ds_read_b128 v[96:99], v4 offset:45056
  v_lshlrev_b32 v188, 16, v234
  v_mfma_f32_16x16x32_bf16 a[104:107], v[112:115], v[152:155], a[104:107]
  buffer_load_dwordx4 v8, s[4:7], s40 offen offset:2048 sc1 lds
  v_and_b32 v189, s44, v234
  v_mfma_f32_16x16x32_bf16 a[108:111], v[112:115], v[160:163], a[108:111]
  ds_read_b128 v[100:103], v4 offset:46080
  v_cvt_pk_bf16_f32 v228, 0, v228
  s_waitcnt lgkmcnt(10)
  v_mfma_f32_16x16x32_bf16 a[112:115], v[116:119], v[136:139], a[112:115]
  s_add_u32 m0, s37, 61440
  v_cvt_pk_bf16_f32 v229, 0, v229
  v_mfma_f32_16x16x32_bf16 a[116:119], v[116:119], v[144:147], a[116:119]
  ds_read_b128 v[104:107], v4 offset:47104
  v_lshlrev_b32 v190, 16, v238
  v_mfma_f32_16x16x32_bf16 a[120:123], v[116:119], v[152:155], a[120:123]
  v_and_b32 v191, s44, v238
  v_subrev_f32 v228, v188, v228
  v_mfma_f32_16x16x32_bf16 a[124:127], v[116:119], v[160:163], a[124:127]
  ds_read_b128 v[108:111], v4 offset:48128
  v_subrev_f32 v229, v189, v229
  v_mfma_f32_16x16x32_bf16 a[128:131], v[120:123], v[136:139], a[128:131]
  v_mul_f32 v190, s42, v190
  v_mul_f32 v191, s43, v191
  v_mfma_f32_16x16x32_bf16 a[132:135], v[120:123], v[144:147], a[132:135]
  v_cvt_pk_bf16_f32 v228, 0, v228
  v_cvt_pk_bf16_f32 v229, 0, v229
  v_mfma_f32_16x16x32_bf16 a[136:139], v[120:123], v[152:155], a[136:139]
  buffer_load_dwordx4 v9, s[4:7], s40 offen offset:0 sc1 lds
  v_mul_f32 v228, v190, v228
  v_mfma_f32_16x16x32_bf16 a[140:143], v[120:123], v[160:163], a[140:143]
  v_mul_f32 v229, v191, v229
  v_cvt_pk_bf16_f32 v234, v228, v229
  v_mfma_f32_16x16x32_bf16 a[144:147], v[124:127], v[136:139], a[144:147]
  v_cvt_f32_i32 v230, v230
  v_mfma_f32_16x16x32_bf16 a[148:151], v[124:127], v[144:147], a[148:151]
  v_cvt_f32_i32 v231, v231
  v_lshlrev_b32 v188, 16, v235
  v_mfma_f32_16x16x32_bf16 a[152:155], v[124:127], v[152:155], a[152:155]
  v_and_b32 v189, s44, v235
  v_cvt_pk_bf16_f32 v230, 0, v230
  v_mfma_f32_16x16x32_bf16 a[156:159], v[124:127], v[160:163], a[156:159]
  v_cvt_pk_bf16_f32 v231, 0, v231
  v_lshlrev_b32 v190, 16, v239
  s_waitcnt lgkmcnt(4)
  v_mfma_f32_16x16x32_bf16 a[160:163], v[128:131], v[136:139], a[160:163]
  buffer_load_dwordx4 v9, s[4:7], s40 offen offset:1024 sc1 lds
  v_and_b32 v191, s44, v239
  v_mfma_f32_16x16x32_bf16 a[164:167], v[128:131], v[144:147], a[164:167]
  v_subrev_f32 v230, v188, v230
  v_subrev_f32 v231, v189, v231
  v_mfma_f32_16x16x32_bf16 a[168:171], v[128:131], v[152:155], a[168:171]
  v_mul_f32 v190, s42, v190
  v_mul_f32 v191, s43, v191
  v_mfma_f32_16x16x32_bf16 a[172:175], v[128:131], v[160:163], a[172:175]
  v_cvt_pk_bf16_f32 v230, 0, v230
  v_cvt_pk_bf16_f32 v231, 0, v231
  v_mfma_f32_16x16x32_bf16 a[176:179], v[132:135], v[136:139], a[176:179]
  v_mul_f32 v230, v190, v230
  v_mul_f32 v231, v191, v231
  v_mfma_f32_16x16x32_bf16 a[180:183], v[132:135], v[144:147], a[180:183]
  v_cvt_pk_bf16_f32 v235, v230, v231
  v_mfma_f32_16x16x32_bf16 a[184:187], v[132:135], v[152:155], a[184:187]
  buffer_load_dwordx4 v9, s[4:7], s40 offen offset:2048 sc1 lds
  v_mfma_f32_16x16x32_bf16 a[188:191], v[132:135], v[160:163], a[188:191]
  s_mul_i32 s40, s90, 48
  v_mfma_f32_16x16x32_bf16 v[136:139], v[64:67], v[16:19], v[168:171]
  buffer_store_dwordx4 v[232:235], v8, s[4:7], s77 offen offset:0 sc1
  v_readlane_b32 s60, v10, 0
  v_mfma_f32_16x16x32_bf16 v[136:139], v[68:71], v[20:23], v[136:139]
  ds_read_b128 v[112:115], v5 offset:36864
  v_readlane_b32 s61, v10, 1
  v_mfma_f32_16x16x32_bf16 v[136:139], v[72:75], v[24:27], v[136:139]
  v_readlane_b32 s62, v10, 2
  v_readlane_b32 s63, v10, 3
  v_mfma_f32_16x16x32_bf16 v[136:139], v[76:79], v[28:31], v[136:139]
  ds_read_b128 v[116:119], v5 offset:37120
  v_readlane_b32 s64, v10, 4
  s_waitcnt lgkmcnt(2)
  v_mfma_f32_16x16x32_bf16 v[136:139], v[80:83], v[32:35], v[136:139]
  buffer_load_dwordx4 v[224:227], v184, s[12:15], s77 offen offset:256 sc0 sc1 nt
  v_readlane_b32 s65, v10, 5
  v_mfma_f32_16x16x32_bf16 v[136:139], v[84:87], v[36:39], v[136:139]
  ds_read_b128 v[120:123], v5 offset:37376
  v_readlane_b32 s66, v10, 6
  v_mfma_f32_16x16x32_bf16 v[140:143], v[88:91], v[16:19], v[168:171]
  v_readlane_b32 s67, v10, 7
  v_readlane_b32 s68, v11, 0
  v_mfma_f32_16x16x32_bf16 v[140:143], v[92:95], v[20:23], v[140:143]
  ds_read_b128 v[124:127], v5 offset:37632
  v_readlane_b32 s69, v11, 1
  v_mfma_f32_16x16x32_bf16 v[140:143], v[96:99], v[24:27], v[140:143]
  buffer_load_dwordx4 v[228:231], v184, s[12:15], s77 offen offset:272 sc0 sc1 nt
  v_readlane_b32 s70, v11, 2
  v_mfma_f32_16x16x32_bf16 v[140:143], v[100:103], v[28:31], v[140:143]
  ds_read_b128 v[128:131], v5 offset:37888
  v_readlane_b32 s71, v11, 3
  v_mfma_f32_16x16x32_bf16 v[140:143], v[104:107], v[32:35], v[140:143]
  v_readlane_b32 s72, v11, 4
  v_readlane_b32 s73, v11, 5
  v_mfma_f32_16x16x32_bf16 v[140:143], v[108:111], v[36:39], v[140:143]
  ds_read_b128 v[132:135], v5 offset:38144
  v_readlane_b32 s74, v11, 6
  v_mfma_f32_16x16x32_bf16 v[144:147], v[64:67], v[40:43], v[172:175]
  v_exp_f32 v136, v136
  v_mfma_f32_16x16x32_bf16 v[144:147], v[68:71], v[44:47], v[144:147]
  v_exp_f32 v137, v137
  buffer_load_dwordx4 v[232:235], v185, s[24:27], s78 offen offset:128
  v_mfma_f32_16x16x32_bf16 v[144:147], v[72:75], v[48:51], v[144:147]
  v_exp_f32 v138, v138
  v_mfma_f32_16x16x32_bf16 v[144:147], v[76:79], v[52:55], v[144:147]
  v_exp_f32 v139, v139
  v_mfma_f32_16x16x32_bf16 v[144:147], v[80:83], v[56:59], v[144:147]
  v_cvt_pk_bf16_f32 v136, v136, v137
  v_cvt_pk_bf16_f32 v137, v138, v139
  v_mfma_f32_16x16x32_bf16 v[144:147], v[84:87], v[60:63], v[144:147]
  v_exp_f32 v140, v140
  v_mfma_f32_16x16x32_bf16 v[148:151], v[88:91], v[40:43], v[172:175]
  v_exp_f32 v141, v141
  buffer_load_dwordx4 v[236:239], v185, s[20:23], s78 offen offset:128
  v_mfma_f32_16x16x32_bf16 v[148:151], v[92:95], v[44:47], v[148:151]
  v_exp_f32 v142, v142
  v_mfma_f32_16x16x32_bf16 v[148:151], v[96:99], v[48:51], v[148:151]
  v_exp_f32 v143, v143
  v_mfma_f32_16x16x32_bf16 v[148:151], v[100:103], v[52:55], v[148:151]
  v_cvt_pk_bf16_f32 v138, v140, v141
  v_cvt_pk_bf16_f32 v139, v142, v143
  v_mfma_f32_16x16x32_bf16 v[148:151], v[104:107], v[56:59], v[148:151]
  s_add_u32 s3, s3, 512
  v_readlane_b32 s75, v11, 7
  v_mfma_f32_16x16x32_bf16 v[148:151], v[108:111], v[60:63], v[148:151]
  s_xor_b32 s90, s3, s76
  v_cvt_f32_i32 v199, v198
  v_mfma_f32_16x16x32_bf16 v[152:155], v[64:67], a[208:211], v[176:179]
  v_exp_f32 v144, v144
  v_mfma_f32_16x16x32_bf16 v[152:155], v[68:71], a[212:215], v[152:155]
  v_exp_f32 v145, v145
  v_mfma_f32_16x16x32_bf16 v[152:155], v[72:75], a[216:219], v[152:155]
  v_exp_f32 v146, v146
  v_mfma_f32_16x16x32_bf16 v[152:155], v[76:79], a[220:223], v[152:155]
  v_exp_f32 v147, v147
  v_mfma_f32_16x16x32_bf16 v[152:155], v[80:83], a[224:227], v[152:155]
  v_cvt_pk_bf16_f32 v144, v144, v145
  v_cvt_pk_bf16_f32 v145, v146, v147
  v_mfma_f32_16x16x32_bf16 v[152:155], v[84:87], a[228:231], v[152:155]
  v_exp_f32 v148, v148
  v_mfma_f32_16x16x32_bf16 v[156:159], v[88:91], a[208:211], v[176:179]
  v_exp_f32 v149, v149
  v_mfma_f32_16x16x32_bf16 v[156:159], v[92:95], a[212:215], v[156:159]
  v_exp_f32 v150, v150
  v_mfma_f32_16x16x32_bf16 v[156:159], v[96:99], a[216:219], v[156:159]
  v_exp_f32 v151, v151
  v_mfma_f32_16x16x32_bf16 v[156:159], v[100:103], a[220:223], v[156:159]
  v_cvt_pk_bf16_f32 v146, v148, v149
  v_cvt_pk_bf16_f32 v147, v150, v151
  v_mfma_f32_16x16x32_bf16 v[156:159], v[104:107], a[224:227], v[156:159]
  s_and_b32 s90, s90, 0x7e00
  v_cvt_f32_i32 v198, v194
  v_mfma_f32_16x16x32_bf16 v[156:159], v[108:111], a[228:231], v[156:159]
  v_cvt_f32_i32 v194, v193
  v_cvt_f32_i32 v195, v197
  v_mfma_f32_16x16x32_bf16 v[160:163], v[64:67], a[232:235], v[180:183]
  v_exp_f32 v152, v152
  v_mfma_f32_16x16x32_bf16 v[160:163], v[68:71], a[236:239], v[160:163]
  v_exp_f32 v153, v153
  v_mfma_f32_16x16x32_bf16 v[160:163], v[72:75], a[240:243], v[160:163]
  v_exp_f32 v154, v154
  v_mfma_f32_16x16x32_bf16 v[160:163], v[76:79], a[244:247], v[160:163]
  v_exp_f32 v155, v155
  v_mfma_f32_16x16x32_bf16 v[160:163], v[80:83], a[248:251], v[160:163]
  v_cvt_pk_bf16_f32 v152, v152, v153
  v_cvt_pk_bf16_f32 v153, v154, v155
  v_mfma_f32_16x16x32_bf16 v[160:163], v[84:87], a[252:255], v[160:163]
  v_exp_f32 v156, v156
  v_mfma_f32_16x16x32_bf16 v[164:167], v[88:91], a[232:235], v[180:183]
  v_exp_f32 v157, v157
  v_mfma_f32_16x16x32_bf16 v[164:167], v[92:95], a[236:239], v[164:167]
  v_exp_f32 v158, v158
  v_mfma_f32_16x16x32_bf16 v[164:167], v[96:99], a[240:243], v[164:167]
  v_exp_f32 v159, v159
  v_mfma_f32_16x16x32_bf16 v[164:167], v[100:103], a[244:247], v[164:167]
  v_cvt_pk_bf16_f32 v154, v156, v157
  v_cvt_pk_bf16_f32 v155, v158, v159
  v_mfma_f32_16x16x32_bf16 v[164:167], v[104:107], a[248:251], v[164:167]
  v_cvt_f32_i32 v193, v196
  v_cvt_f32_i32 v192, v192
  s_waitcnt lgkmcnt(0)
  v_mfma_f32_16x16x32_bf16 v[164:167], v[108:111], a[252:255], v[164:167]
  v_cvt_pk_bf16_f32 v198, 0, v198
  v_cvt_pk_bf16_f32 v199, 0, v199
  v_mfma_f32_16x16x32_bf16 a[0:3], v[112:115], v[136:139], a[0:3]
  v_exp_f32 v160, v160
  v_mfma_f32_16x16x32_bf16 a[4:7], v[112:115], v[144:147], a[4:7]
  v_exp_f32 v161, v161
  v_mfma_f32_16x16x32_bf16 a[8:11], v[112:115], v[152:155], a[8:11]
  v_exp_f32 v162, v162
  v_mfma_f32_16x16x32_bf16 a[16:19], v[116:119], v[136:139], a[16:19]
  v_exp_f32 v163, v163
  v_mfma_f32_16x16x32_bf16 a[20:23], v[116:119], v[144:147], a[20:23]
  v_cvt_pk_bf16_f32 v160, v160, v161
  v_cvt_pk_bf16_f32 v161, v162, v163
  v_mfma_f32_16x16x32_bf16 a[24:27], v[116:119], v[152:155], a[24:27]
  v_exp_f32 v164, v164
  v_mfma_f32_16x16x32_bf16 a[32:35], v[120:123], v[136:139], a[32:35]
  v_exp_f32 v165, v165
  v_mfma_f32_16x16x32_bf16 a[36:39], v[120:123], v[144:147], a[36:39]
  v_exp_f32 v166, v166
  v_mfma_f32_16x16x32_bf16 a[40:43], v[120:123], v[152:155], a[40:43]
  v_exp_f32 v167, v167
  v_mfma_f32_16x16x32_bf16 a[48:51], v[124:127], v[136:139], a[48:51]
  v_cvt_pk_bf16_f32 v162, v164, v165
  v_cvt_pk_bf16_f32 v163, v166, v167
  v_mfma_f32_16x16x32_bf16 a[52:55], v[124:127], v[144:147], a[52:55]
  s_waitcnt vmcnt(11)
  v_cmp_eq_u64 vcc, s[88:89], v[6:7]
  s_add_u32 m0, s37, 24576
  v_mfma_f32_16x16x32_bf16 a[56:59], v[124:127], v[152:155], a[56:59]
  s_barrier
  v_mfma_f32_16x16x32_bf16 a[192:195], v[12:15], v[136:139], a[192:195]
  s_cbranch_vccz L_slow8
L_ret8:
  buffer_load_dwordx2 v[6:7], v1, s[4:7], s90 offen sc1
  v_mfma_f32_16x16x32_bf16 a[196:199], v[12:15], v[144:147], a[196:199]
  ds_read_b128 v[64:67], v4 offset:0
  v_cvt_pk_bf16_f32 v194, 0, v194
  v_mfma_f32_16x16x32_bf16 a[200:203], v[12:15], v[152:155], a[200:203]
  buffer_load_dwordx4 v8, s[4:7], s48 offen offset:0 sc1 lds
  v_cvt_pk_bf16_f32 v195, 0, v195
  v_mfma_f32_16x16x32_bf16 a[12:15], v[112:115], v[160:163], a[12:15]
  ds_read_b128 v[68:71], v4 offset:1024
  v_cvt_pk_bf16_f32 v192, 0, v192
  v_mfma_f32_16x16x32_bf16 a[28:31], v[116:119], v[160:163], a[28:31]
  ds_read_b128 v[112:115], v5 offset:38400
  v_cvt_pk_bf16_f32 v193, 0, v193
  v_mfma_f32_16x16x32_bf16 a[44:47], v[120:123], v[160:163], a[44:47]
  ds_read_b128 v[116:119], v5 offset:38656
  v_subrev_f32 v198, s60, v198
  v_mfma_f32_16x16x32_bf16 a[60:63], v[124:127], v[160:163], a[60:63]
  ds_read_b128 v[120:123], v5 offset:38912
  v_subrev_f32 v199, s61, v199
  v_mfma_f32_16x16x32_bf16 a[204:207], v[12:15], v[160:163], a[204:207]
  ds_read_b128 v[124:127], v5 offset:39168
  v_mfma_f32_16x16x32_bf16 a[64:67], v[128:131], v[136:139], a[64:67]
  ds_read_b128 v[72:75], v4 offset:2048
  v_subrev_f32 v194, s60, v194
  v_mfma_f32_16x16x32_bf16 a[68:71], v[128:131], v[144:147], a[68:71]
  ds_read_b128 v[76:79], v4 offset:3072
  v_subrev_f32 v195, s61, v195
  v_mfma_f32_16x16x32_bf16 a[72:75], v[128:131], v[152:155], a[72:75]
  buffer_load_dwordx4 v8, s[4:7], s48 offen offset:1024 sc1 lds
  v_subrev_f32 v192, s60, v192
  v_mfma_f32_16x16x32_bf16 a[76:79], v[128:131], v[160:163], a[76:79]
  ds_read_b128 v[80:83], v4 offset:4096
  v_subrev_f32 v193, s61, v193
  v_mfma_f32_16x16x32_bf16 a[80:83], v[132:135], v[136:139], a[80:83]
  ds_read_b128 v[128:131], v5 offset:39424
  v_cvt_pk_bf16_f32 v198, 0, v198
  v_mfma_f32_16x16x32_bf16 a[84:87], v[132:135], v[144:147], a[84:87]
  ds_read_b128 v[84:87], v4 offset:5120
  v_cvt_pk_bf16_f32 v199, 0, v199
  v_mfma_f32_16x16x32_bf16 a[88:91], v[132:135], v[152:155], a[88:91]
  ds_read_b128 v[88:91], v4 offset:6144
  v_cvt_pk_bf16_f32 v194, 0, v194
  v_mfma_f32_16x16x32_bf16 a[92:95], v[132:135], v[160:163], a[92:95]
  ds_read_b128 v[92:95], v4 offset:7168
  v_cvt_pk_bf16_f32 v195, 0, v195
  s_waitcnt lgkmcnt(10)
  v_mfma_f32_16x16x32_bf16 a[96:99], v[112:115], v[136:139], a[96:99]
  ds_read_b128 v[132:135], v5 offset:39680
  v_cvt_pk_bf16_f32 v192, 0, v192
  v_mfma_f32_16x16x32_bf16 a[100:103], v[112:115], v[144:147], a[100:103]
  ds_read_b128 v[96:99], v4 offset:8192
  v_cvt_pk_bf16_f32 v193, 0, v193
  v_mfma_f32_16x16x32_bf16 a[104:107], v[112:115], v[152:155], a[104:107]
  buffer_load_dwordx4 v8, s[4:7], s48 offen offset:2048 sc1 lds
  v_mul_f32 v198, s68, v198
  v_mfma_f32_16x16x32_bf16 a[108:111], v[112:115], v[160:163], a[108:111]
  ds_read_b128 v[100:103], v4 offset:9216
  v_mul_f32 v199, s69, v199
  s_waitcnt lgkmcnt(10)
  v_mfma_f32_16x16x32_bf16 a[112:115], v[116:119], v[136:139], a[112:115]
  s_add_u32 m0, s37, 73728
  v_mul_f32 v194, s68, v194
  v_mfma_f32_16x16x32_bf16 a[116:119], v[116:119], v[144:147], a[116:119]
  ds_read_b128 v[104:107], v4 offset:10240
  v_mul_f32 v195, s69, v195
  v_mfma_f32_16x16x32_bf16 a[120:123], v[116:119], v[152:155], a[120:123]
  v_mul_f32 v192, s68, v192
  v_mul_f32 v193, s69, v193
  v_mfma_f32_16x16x32_bf16 a[124:127], v[116:119], v[160:163], a[124:127]
  ds_read_b128 v[108:111], v4 offset:11264
  v_cvt_pk_bf16_f32 v188, v198, v199
  v_mfma_f32_16x16x32_bf16 a[128:131], v[120:123], v[136:139], a[128:131]
  v_cvt_pk_bf16_f32 v196, v194, v195
  v_cvt_pk_bf16_f32 v192, v192, v193
  v_mfma_f32_16x16x32_bf16 a[132:135], v[120:123], v[144:147], a[132:135]
  v_cvt_f32_i32 v207, v206
  v_cvt_f32_i32 v206, v202
  v_mfma_f32_16x16x32_bf16 a[136:139], v[120:123], v[152:155], a[136:139]
  buffer_load_dwordx4 v9, s[4:7], s48 offen offset:0 sc1 lds
  v_cvt_f32_i32 v202, v201
  v_mfma_f32_16x16x32_bf16 a[140:143], v[120:123], v[160:163], a[140:143]
  v_cvt_f32_i32 v203, v205
  v_cvt_f32_i32 v201, v204
  v_mfma_f32_16x16x32_bf16 a[144:147], v[124:127], v[136:139], a[144:147]
  v_cvt_f32_i32 v200, v200
  v_cvt_pk_bf16_f32 v206, 0, v206
  v_mfma_f32_16x16x32_bf16 a[148:151], v[124:127], v[144:147], a[148:151]
  v_cvt_pk_bf16_f32 v207, 0, v207
  v_cvt_pk_bf16_f32 v202, 0, v202
  v_mfma_f32_16x16x32_bf16 a[152:155], v[124:127], v[152:155], a[152:155]
  v_cvt_pk_bf16_f32 v203, 0, v203
  v_cvt_pk_bf16_f32 v200, 0, v200
  v_mfma_f32_16x16x32_bf16 a[156:159], v[124:127], v[160:163], a[156:159]
  v_cvt_pk_bf16_f32 v201, 0, v201
  s_waitcnt lgkmcnt(4)
  v_mfma_f32_16x16x32_bf16 a[160:163], v[128:131], v[136:139], a[160:163]
  buffer_load_dwordx4 v9, s[4:7], s48 offen offset:1024 sc1 lds
  v_subrev_f32 v206, s62, v206
  v_mfma_f32_16x16x32_bf16 a[164:167], v[128:131], v[144:147], a[164:167]
  v_subrev_f32 v207, s63, v207
  v_subrev_f32 v202, s62, v202
  v_mfma_f32_16x16x32_bf16 a[168:171], v[128:131], v[152:155], a[168:171]
  v_subrev_f32 v203, s63, v203
  v_subrev_f32 v200, s62, v200
  v_mfma_f32_16x16x32_bf16 a[172:175], v[128:131], v[160:163], a[172:175]
  v_subrev_f32 v201, s63, v201
  v_cvt_pk_bf16_f32 v206, 0, v206
  v_mfma_f32_16x16x32_bf16 a[176:179], v[132:135], v[136:139], a[176:179]
  v_cvt_pk_bf16_f32 v207, 0, v207
  v_cvt_pk_bf16_f32 v202, 0, v202
  v_mfma_f32_16x16x32_bf16 a[180:183], v[132:135], v[144:147], a[180:183]
  v_cvt_pk_bf16_f32 v203, 0, v203
  v_cvt_pk_bf16_f32 v200, 0, v200
  v_mfma_f32_16x16x32_bf16 a[184:187], v[132:135], v[152:155], a[184:187]
  buffer_load_dwordx4 v9, s[4:7], s48 offen offset:2048 sc1 lds
  v_cvt_pk_bf16_f32 v201, 0, v201
  v_mfma_f32_16x16x32_bf16 a[188:191], v[132:135], v[160:163], a[188:191]
  s_mul_i32 s48, s90, 48
  v_mul_f32 v206, s70, v206
  v_mfma_f32_16x16x32_bf16 v[136:139], v[64:67], v[16:19], v[168:171]
  v_mul_f32 v207, s71, v207
  v_mul_f32 v202, s70, v202
  v_mfma_f32_16x16x32_bf16 v[136:139], v[68:71], v[20:23], v[136:139]
  ds_read_b128 v[112:115], v5 offset:0
  v_mul_f32 v203, s71, v203
  v_mfma_f32_16x16x32_bf16 v[136:139], v[72:75], v[24:27], v[136:139]
  v_mul_f32 v200, s70, v200
  v_mul_f32 v201, s71, v201
  v_mfma_f32_16x16x32_bf16 v[136:139], v[76:79], v[28:31], v[136:139]
  ds_read_b128 v[116:119], v5 offset:256
  v_cvt_pk_bf16_f32 v189, v206, v207
  s_waitcnt lgkmcnt(2)
  v_mfma_f32_16x16x32_bf16 v[136:139], v[80:83], v[32:35], v[136:139]
  v_cvt_pk_bf16_f32 v197, v202, v203
  v_cvt_pk_bf16_f32 v193, v200, v201
  v_mfma_f32_16x16x32_bf16 v[136:139], v[84:87], v[36:39], v[136:139]
  ds_read_b128 v[120:123], v5 offset:512
  v_cvt_f32_i32 v215, v214
  v_mfma_f32_16x16x32_bf16 v[140:143], v[88:91], v[16:19], v[168:171]
  v_cvt_f32_i32 v214, v210
  v_cvt_f32_i32 v210, v209
  v_mfma_f32_16x16x32_bf16 v[140:143], v[92:95], v[20:23], v[140:143]
  ds_read_b128 v[124:127], v5 offset:768
  v_cvt_f32_i32 v211, v213
  v_mfma_f32_16x16x32_bf16 v[140:143], v[96:99], v[24:27], v[140:143]
  v_cvt_f32_i32 v209, v212
  v_cvt_f32_i32 v208, v208
  v_mfma_f32_16x16x32_bf16 v[140:143], v[100:103], v[28:31], v[140:143]
  ds_read_b128 v[128:131], v5 offset:1024
  v_cvt_pk_bf16_f32 v214, 0, v214
  v_mfma_f32_16x16x32_bf16 v[140:143], v[104:107], v[32:35], v[140:143]
  v_cvt_pk_bf16_f32 v215, 0, v215
  v_mfma_f32_16x16x32_bf16 v[140:143], v[108:111], v[36:39], v[140:143]
  ds_read_b128 v[132:135], v5 offset:1280
  v_cvt_pk_bf16_f32 v210, 0, v210
  v_mfma_f32_16x16x32_bf16 v[144:147], v[64:67], v[40:43], v[172:175]
  v_exp_f32 v136, v136
  v_mfma_f32_16x16x32_bf16 v[144:147], v[68:71], v[44:47], v[144:147]
  v_exp_f32 v137, v137
  v_mfma_f32_16x16x32_bf16 v[144:147], v[72:75], v[48:51], v[144:147]
  v_exp_f32 v138, v138
  v_mfma_f32_16x16x32_bf16 v[144:147], v[76:79], v[52:55], v[144:147]
  v_exp_f32 v139, v139
  v_mfma_f32_16x16x32_bf16 v[144:147], v[80:83], v[56:59], v[144:147]
  v_cvt_pk_bf16_f32 v136, v136, v137
  v_cvt_pk_bf16_f32 v137, v138, v139
  v_mfma_f32_16x16x32_bf16 v[144:147], v[84:87], v[60:63], v[144:147]
  v_exp_f32 v140, v140
  v_mfma_f32_16x16x32_bf16 v[148:151], v[88:91], v[40:43], v[172:175]
  v_exp_f32 v141, v141
  v_mfma_f32_16x16x32_bf16 v[148:151], v[92:95], v[44:47], v[148:151]
  v_exp_f32 v142, v142
  v_mfma_f32_16x16x32_bf16 v[148:151], v[96:99], v[48:51], v[148:151]
  v_exp_f32 v143, v143
  v_mfma_f32_16x16x32_bf16 v[148:151], v[100:103], v[52:55], v[148:151]
  v_cvt_pk_bf16_f32 v138, v140, v141
  v_cvt_pk_bf16_f32 v139, v142, v143
  v_mfma_f32_16x16x32_bf16 v[148:151], v[104:107], v[56:59], v[148:151]
  s_add_u32 s3, s3, 512
  v_cvt_pk_bf16_f32 v211, 0, v211
  v_mfma_f32_16x16x32_bf16 v[148:151], v[108:111], v[60:63], v[148:151]
  s_xor_b32 s90, s3, s76
  v_cvt_pk_bf16_f32 v208, 0, v208
  v_mfma_f32_16x16x32_bf16 v[152:155], v[64:67], a[208:211], v[176:179]
  v_exp_f32 v144, v144
  v_mfma_f32_16x16x32_bf16 v[152:155], v[68:71], a[212:215], v[152:155]
  v_exp_f32 v145, v145
  v_mfma_f32_16x16x32_bf16 v[152:155], v[72:75], a[216:219], v[152:155]
  v_exp_f32 v146, v146
  v_mfma_f32_16x16x32_bf16 v[152:155], v[76:79], a[220:223], v[152:155]
  v_exp_f32 v147, v147
  v_mfma_f32_16x16x32_bf16 v[152:155], v[80:83], a[224:227], v[152:155]
  v_cvt_pk_bf16_f32 v144, v144, v145
  v_cvt_pk_bf16_f32 v145, v146, v147
  v_mfma_f32_16x16x32_bf16 v[152:155], v[84:87], a[228:231], v[152:155]
  v_exp_f32 v148, v148
  v_mfma_f32_16x16x32_bf16 v[156:159], v[88:91], a[208:211], v[176:179]
  v_exp_f32 v149, v149
  v_mfma_f32_16x16x32_bf16 v[156:159], v[92:95], a[212:215], v[156:159]
  v_exp_f32 v150, v150
  v_mfma_f32_16x16x32_bf16 v[156:159], v[96:99], a[216:219], v[156:159]
  v_exp_f32 v151, v151
  v_mfma_f32_16x16x32_bf16 v[156:159], v[100:103], a[220:223], v[156:159]
  v_cvt_pk_bf16_f32 v146, v148, v149
  v_cvt_pk_bf16_f32 v147, v150, v151
  v_mfma_f32_16x16x32_bf16 v[156:159], v[104:107], a[224:227], v[156:159]
  s_and_b32 s90, s90, 0x7e00
  v_cvt_pk_bf16_f32 v209, 0, v209
  v_mfma_f32_16x16x32_bf16 v[156:159], v[108:111], a[228:231], v[156:159]
  v_subrev_f32 v214, s64, v214
  v_subrev_f32 v215, s65, v215
  v_mfma_f32_16x16x32_bf16 v[160:163], v[64:67], a[232:235], v[180:183]
  v_exp_f32 v152, v152
  v_mfma_f32_16x16x32_bf16 v[160:163], v[68:71], a[236:239], v[160:163]
  v_exp_f32 v153, v153
  v_mfma_f32_16x16x32_bf16 v[160:163], v[72:75], a[240:243], v[160:163]
  v_exp_f32 v154, v154
  v_mfma_f32_16x16x32_bf16 v[160:163], v[76:79], a[244:247], v[160:163]
  v_exp_f32 v155, v155
  v_mfma_f32_16x16x32_bf16 v[160:163], v[80:83], a[248:251], v[160:163]
  v_cvt_pk_bf16_f32 v152, v152, v153
  v_cvt_pk_bf16_f32 v153, v154, v155
  v_mfma_f32_16x16x32_bf16 v[160:163], v[84:87], a[252:255], v[160:163]
  v_exp_f32 v156, v156
  v_mfma_f32_16x16x32_bf16 v[164:167], v[88:91], a[232:235], v[180:183]
  v_exp_f32 v157, v157
  v_mfma_f32_16x16x32_bf16 v[164:167], v[92:95], a[236:239], v[164:167]
  v_exp_f32 v158, v158
  v_mfma_f32_16x16x32_bf16 v[164:167], v[96:99], a[240:243], v[164:167]
  v_exp_f32 v159, v159
  v_mfma_f32_16x16x32_bf16 v[164:167], v[100:103], a[244:247], v[164:167]
  v_cvt_pk_bf16_f32 v154, v156, v157
  v_cvt_pk_bf16_f32 v155, v158, v159
  v_mfma_f32_16x16x32_bf16 v[164:167], v[104:107], a[248:251], v[164:167]
  v_subrev_f32 v210, s64, v210
  v_subrev_f32 v211, s65, v211
  s_waitcnt lgkmcnt(0)
  v_mfma_f32_16x16x32_bf16 v[164:167], v[108:111], a[252:255], v[164:167]
  v_subrev_f32 v208, s64, v208
  v_subrev_f32 v209, s65, v209
  v_mfma_f32_16x16x32_bf16 a[0:3], v[112:115], v[136:139], a[0:3]
  v_exp_f32 v160, v160
  v_mfma_f32_16x16x32_bf16 a[4:7], v[112:115], v[144:147], a[4:7]
  v_exp_f32 v161, v161
  v_mfma_f32_16x16x32_bf16 a[8:11], v[112:115], v[152:155], a[8:11]
  v_exp_f32 v162, v162
  v_mfma_f32_16x16x32_bf16 a[16:19], v[116:119], v[136:139], a[16:19]
  v_exp_f32 v163, v163
  v_mfma_f32_16x16x32_bf16 a[20:23], v[116:119], v[144:147], a[20:23]
  v_cvt_pk_bf16_f32 v160, v160, v161
  v_cvt_pk_bf16_f32 v161, v162, v163
  v_mfma_f32_16x16x32_bf16 a[24:27], v[116:119], v[152:155], a[24:27]
  v_exp_f32 v164, v164
  v_mfma_f32_16x16x32_bf16 a[32:35], v[120:123], v[136:139], a[32:35]
  v_exp_f32 v165, v165
  v_mfma_f32_16x16x32_bf16 a[36:39], v[120:123], v[144:147], a[36:39]
  v_exp_f32 v166, v166
  v_mfma_f32_16x16x32_bf16 a[40:43], v[120:123], v[152:155], a[40:43]
  v_exp_f32 v167, v167
  v_mfma_f32_16x16x32_bf16 a[48:51], v[124:127], v[136:139], a[48:51]
  v_cvt_pk_bf16_f32 v162, v164, v165
  v_cvt_pk_bf16_f32 v163, v166, v167
  v_mfma_f32_16x16x32_bf16 a[52:55], v[124:127], v[144:147], a[52:55]
  v_cmp_eq_u64 vcc, s[88:89], v[2:3]
  s_add_u32 m0, s37, 36864
  v_mfma_f32_16x16x32_bf16 a[56:59], v[124:127], v[152:155], a[56:59]
  s_waitcnt vmcnt(12)
  s_barrier
  v_mfma_f32_16x16x32_bf16 a[192:195], v[12:15], v[136:139], a[192:195]
  s_cbranch_vccz L_slow9
L_ret9:
  buffer_load_dwordx2 v[2:3], v1, s[4:7], s90 offen sc1
  v_mfma_f32_16x16x32_bf16 a[196:199], v[12:15], v[144:147], a[196:199]
  ds_read_b128 v[64:67], v4 offset:12288
  v_cvt_pk_bf16_f32 v214, 0, v214
  v_mfma_f32_16x16x32_bf16 a[200:203], v[12:15], v[152:155], a[200:203]
  buffer_load_dwordx4 v8, s[4:7], s40 offen offset:0 sc1 lds
  v_cvt_pk_bf16_f32 v215, 0, v215
  v_mfma_f32_16x16x32_bf16 a[12:15], v[112:115], v[160:163], a[12:15]
  ds_read_b128 v[68:71], v4 offset:13312
  v_cvt_pk_bf16_f32 v210, 0, v210
  v_mfma_f32_16x16x32_bf16 a[28:31], v[116:119], v[160:163], a[28:31]
  ds_read_b128 v[112:115], v5 offset:1536
  v_cvt_pk_bf16_f32 v211, 0, v211
  v_mfma_f32_16x16x32_bf16 a[44:47], v[120:123], v[160:163], a[44:47]
  ds_read_b128 v[116:119], v5 offset:1792
  v_cvt_pk_bf16_f32 v208, 0, v208
  v_mfma_f32_16x16x32_bf16 a[60:63], v[124:127], v[160:163], a[60:63]
  ds_read_b128 v[120:123], v5 offset:2048
  v_cvt_pk_bf16_f32 v209, 0, v209
  v_mfma_f32_16x16x32_bf16 a[204:207], v[12:15], v[160:163], a[204:207]
  ds_read_b128 v[124:127], v5 offset:2304
  v_mul_f32 v214, s72, v214
  v_mfma_f32_16x16x32_bf16 a[64:67], v[128:131], v[136:139], a[64:67]
  ds_read_b128 v[72:75], v4 offset:14336
  v_mul_f32 v215, s73, v215
  v_mfma_f32_16x16x32_bf16 a[68:71], v[128:131], v[144:147], a[68:71]
  ds_read_b128 v[76:79], v4 offset:15360
  v_mul_f32 v210, s72, v210
  v_mfma_f32_16x16x32_bf16 a[72:75], v[128:131], v[152:155], a[72:75]
  buffer_load_dwordx4 v8, s[4:7], s40 offen offset:1024 sc1 lds
  v_mul_f32 v211, s73, v211
  v_mfma_f32_16x16x32_bf16 a[76:79], v[128:131], v[160:163], a[76:79]
  ds_read_b128 v[80:83], v4 offset:16384
  v_mul_f32 v208, s72, v208
  v_mfma_f32_16x16x32_bf16 a[80:83], v[132:135], v[136:139], a[80:83]
  ds_read_b128 v[128:131], v5 offset:2560
  v_mul_f32 v209, s73, v209
  v_mfma_f32_16x16x32_bf16 a[84:87], v[132:135], v[144:147], a[84:87]
  ds_read_b128 v[84:87], v4 offset:17408
  v_cvt_pk_bf16_f32 v190, v214, v215
  v_mfma_f32_16x16x32_bf16 a[88:91], v[132:135], v[152:155], a[88:91]
  ds_read_b128 v[88:91], v4 offset:18432
  v_cvt_pk_bf16_f32 v198, v210, v211
  v_mfma_f32_16x16x32_bf16 a[92:95], v[132:135], v[160:163], a[92:95]
  ds_read_b128 v[92:95], v4 offset:19456
  v_cvt_pk_bf16_f32 v194, v208, v209
  s_waitcnt lgkmcnt(10)
  v_mfma_f32_16x16x32_bf16 a[96:99], v[112:115], v[136:139], a[96:99]
  ds_read_b128 v[132:135], v5 offset:2816
  v_cvt_f32_i32 v223, v222
  v_mfma_f32_16x16x32_bf16 a[100:103], v[112:115], v[144:147], a[100:103]
  ds_read_b128 v[96:99], v4 offset:20480
  v_cvt_f32_i32 v222, v218
  v_mfma_f32_16x16x32_bf16 a[104:107], v[112:115], v[152:155], a[104:107]
  buffer_load_dwordx4 v8, s[4:7], s40 offen offset:2048 sc1 lds
  v_cvt_f32_i32 v218, v217
  v_mfma_f32_16x16x32_bf16 a[108:111], v[112:115], v[160:163], a[108:111]
  ds_read_b128 v[100:103], v4 offset:21504
  v_cvt_f32_i32 v219, v221
  s_waitcnt lgkmcnt(10)
  v_mfma_f32_16x16x32_bf16 a[112:115], v[116:119], v[136:139], a[112:115]
  s_add_u32 m0, s37, 86016
  v_mfma_f32_16x16x32_bf16 a[116:119], v[116:119], v[144:147], a[116:119]
  ds_read_b128 v[104:107], v4 offset:22528
  v_cvt_f32_i32 v217, v220
  v_mfma_f32_16x16x32_bf16 a[120:123], v[116:119], v[152:155], a[120:123]
  v_cvt_f32_i32 v216, v216
  v_cvt_pk_bf16_f32 v222, 0, v222
  v_mfma_f32_16x16x32_bf16 a[124:127], v[116:119], v[160:163], a[124:127]
  ds_read_b128 v[108:111], v4 offset:23552
  v_cvt_pk_bf16_f32 v223, 0, v223
  v_mfma_f32_16x16x32_bf16 a[128:131], v[120:123], v[136:139], a[128:131]
  v_cvt_pk_bf16_f32 v218, 0, v218
  v_cvt_pk_bf16_f32 v219, 0, v219
  v_mfma_f32_16x16x32_bf16 a[132:135], v[120:123], v[144:147], a[132:135]
  v_cvt_pk_bf16_f32 v216, 0, v216
  v_cvt_pk_bf16_f32 v217, 0, v217
  v_mfma_f32_16x16x32_bf16 a[136:139], v[120:123], v[152:155], a[136:139]
  buffer_load_dwordx4 v9, s[4:7], s40 offen offset:0 sc1 lds
  v_subrev_f32 v222, s66, v222
  v_mfma_f32_16x16x32_bf16 a[140:143], v[120:123], v[160:163], a[140:143]
  v_subrev_f32 v223, s67, v223
  v_subrev_f32 v218, s66, v218
  v_mfma_f32_16x16x32_bf16 a[144:147], v[124:127], v[136:139], a[144:147]
  v_subrev_f32 v219, s67, v219
  v_subrev_f32 v216, s66, v216
  v_mfma_f32_16x16x32_bf16 a[148:151], v[124:127], v[144:147], a[148:151]
  v_subrev_f32 v217, s67, v217
  v_cvt_pk_bf16_f32 v222, 0, v222
  v_mfma_f32_16x16x32_bf16 a[152:155], v[124:127], v[152:155], a[152:155]
  v_cvt_pk_bf16_f32 v223, 0, v223
  v_cvt_pk_bf16_f32 v218, 0, v218
  v_mfma_f32_16x16x32_bf16 a[156:159], v[124:127], v[160:163], a[156:159]
  v_cvt_pk_bf16_f32 v219, 0, v219
  v_cvt_pk_bf16_f32 v216, 0, v216
  s_waitcnt lgkmcnt(4)
  v_mfma_f32_16x16x32_bf16 a[160:163], v[128:131], v[136:139], a[160:163]
  buffer_load_dwordx4 v9, s[4:7], s40 offen offset:1024 sc1 lds
  v_cvt_pk_bf16_f32 v217, 0, v217
  v_mfma_f32_16x16x32_bf16 a[164:167], v[128:131], v[144:147], a[164:167]
  v_mul_f32 v222, s74, v222
  v_mul_f32 v223, s75, v223
  v_mfma_f32_16x16x32_bf16 a[168:171], v[128:131], v[152:155], a[168:171]
  v_mul_f32 v218, s74, v218
  v_mul_f32 v219, s75, v219
  v_mfma_f32_16x16x32_bf16 a[172:175], v[128:131], v[160:163], a[172:175]
  v_mul_f32 v216, s74, v216
  v_mul_f32 v217, s75, v217
  v_mfma_f32_16x16x32_bf16 a[176:179], v[132:135], v[136:139], a[176:179]
  v_cvt_pk_bf16_f32 v191, v222, v223
  v_cvt_pk_bf16_f32 v199, v218, v219
  v_mfma_f32_16x16x32_bf16 a[180:183], v[132:135], v[144:147], a[180:183]
  v_cvt_pk_bf16_f32 v195, v216, v217
  v_mfma_f32_16x16x32_bf16 a[184:187], v[132:135], v[152:155], a[184:187]
  buffer_load_dwordx4 v9, s[4:7], s40 offen offset:2048 sc1 lds
  v_mfma_f32_16x16x32_bf16 a[188:191], v[132:135], v[160:163], a[188:191]
  s_mul_i32 s40, s90, 48
  v_mfma_f32_16x16x32_bf16 v[136:139], v[64:67], v[16:19], v[168:171]
  buffer_store_dwordx4 v[188:191], v9, s[4:7], s77 offen offset:2048 sc1
  v_mfma_f32_16x16x32_bf16 v[136:139], v[68:71], v[20:23], v[136:139]
  ds_read_b128 v[112:115], v5 offset:12288
  s_waitcnt vmcnt(18)
  v_cvt_f32_i32 v224, v224
  v_mfma_f32_16x16x32_bf16 v[136:139], v[72:75], v[24:27], v[136:139]
  v_cvt_f32_i32 v225, v225
  s_waitcnt vmcnt(16)
  v_lshlrev_b32 v188, 16, v232
  v_mfma_f32_16x16x32_bf16 v[136:139], v[76:79], v[28:31], v[136:139]
  ds_read_b128 v[116:119], v5 offset:12544
  v_and_b32 v189, s44, v232
  s_waitcnt lgkmcnt(2)
  v_mfma_f32_16x16x32_bf16 v[136:139], v[80:83], v[32:35], v[136:139]
  buffer_store_dwordx4 v[192:195], v9, s[4:7], s77 offen offset:0 sc1
  v_cvt_pk_bf16_f32 v224, 0, v224
  v_mfma_f32_16x16x32_bf16 v[136:139], v[84:87], v[36:39], v[136:139]
  ds_read_b128 v[120:123], v5 offset:12800
  v_cvt_pk_bf16_f32 v225, 0, v225
  v_mfma_f32_16x16x32_bf16 v[140:143], v[88:91], v[16:19], v[168:171]
  s_waitcnt vmcnt(16)
  v_lshlrev_b32 v190, 16, v236
  v_and_b32 v191, s44, v236
  v_mfma_f32_16x16x32_bf16 v[140:143], v[92:95], v[20:23], v[140:143]
  ds_read_b128 v[124:127], v5 offset:13056
  v_subrev_f32 v224, v188, v224
  v_mfma_f32_16x16x32_bf16 v[140:143], v[96:99], v[24:27], v[140:143]
  buffer_store_dwordx4 v[196:199], v9, s[4:7], s77 offen offset:1024 sc1
  v_subrev_f32 v225, v189, v225
  v_mfma_f32_16x16x32_bf16 v[140:143], v[100:103], v[28:31], v[140:143]
  ds_read_b128 v[128:131], v5 offset:13312
  v_mul_f32 v190, s42, v190
  v_mfma_f32_16x16x32_bf16 v[140:143], v[104:107], v[32:35], v[140:143]
  v_mul_f32 v191, s43, v191
  v_cvt_pk_bf16_f32 v224, 0, v224
  v_mfma_f32_16x16x32_bf16 v[140:143], v[108:111], v[36:39], v[140:143]
  ds_read_b128 v[132:135], v5 offset:13568
  v_cvt_pk_bf16_f32 v225, 0, v225
  v_mfma_f32_16x16x32_bf16 v[144:147], v[64:67], v[40:43], v[172:175]
  v_exp_f32 v136, v136
  v_mfma_f32_16x16x32_bf16 v[144:147], v[68:71], v[44:47], v[144:147]
  v_exp_f32 v137, v137
  v_mfma_f32_16x16x32_bf16 v[144:147], v[72:75], v[48:51], v[144:147]
  v_exp_f32 v138, v138
  v_mfma_f32_16x16x32_bf16 v[144:147], v[76:79], v[52:55], v[144:147]
  v_exp_f32 v139, v139
  v_mfma_f32_16x16x32_bf16 v[144:147], v[80:83], v[56:59], v[144:147]
  v_cvt_pk_bf16_f32 v136, v136, v137
  v_cvt_pk_bf16_f32 v137, v138, v139
  v_mfma_f32_16x16x32_bf16 v[144:147], v[84:87], v[60:63], v[144:147]
  v_exp_f32 v140, v140
  v_mfma_f32_16x16x32_bf16 v[148:151], v[88:91], v[40:43], v[172:175]
  v_exp_f32 v141, v141
  v_mfma_f32_16x16x32_bf16 v[148:151], v[92:95], v[44:47], v[148:151]
  v_exp_f32 v142, v142
  v_mfma_f32_16x16x32_bf16 v[148:151], v[96:99], v[48:51], v[148:151]
  v_exp_f32 v143, v143
  v_mfma_f32_16x16x32_bf16 v[148:151], v[100:103], v[52:55], v[148:151]
  v_cvt_pk_bf16_f32 v138, v140, v141
  v_cvt_pk_bf16_f32 v139, v142, v143
  v_mfma_f32_16x16x32_bf16 v[148:151], v[104:107], v[56:59], v[148:151]
  s_add_u32 s3, s3, 512
  v_mfma_f32_16x16x32_bf16 v[148:151], v[108:111], v[60:63], v[148:151]
  s_xor_b32 s90, s3, s76
  v_mul_f32 v224, v190, v224
  v_mfma_f32_16x16x32_bf16 v[152:155], v[64:67], a[208:211], v[176:179]
  v_exp_f32 v144, v144
  v_mfma_f32_16x16x32_bf16 v[152:155], v[68:71], a[212:215], v[152:155]
  v_exp_f32 v145, v145
  v_mfma_f32_16x16x32_bf16 v[152:155], v[72:75], a[216:219], v[152:155]
  v_exp_f32 v146, v146
  v_mfma_f32_16x16x32_bf16 v[152:155], v[76:79], a[220:223], v[152:155]
  v_exp_f32 v147, v147
  v_mfma_f32_16x16x32_bf16 v[152:155], v[80:83], a[224:227], v[152:155]
  v_cvt_pk_bf16_f32 v144, v144, v145
  v_cvt_pk_bf16_f32 v145, v146, v147
  v_mfma_f32_16x16x32_bf16 v[152:155], v[84:87], a[228:231], v[152:155]
  v_exp_f32 v148, v148
  v_mfma_f32_16x16x32_bf16 v[156:159], v[88:91], a[208:211], v[176:179]
  v_exp_f32 v149, v149
  v_mfma_f32_16x16x32_bf16 v[156:159], v[92:95], a[212:215], v[156:159]
  v_exp_f32 v150, v150
  v_mfma_f32_16x16x32_bf16 v[156:159], v[96:99], a[216:219], v[156:159]
  v_exp_f32 v151, v151
  v_mfma_f32_16x16x32_bf16 v[156:159], v[100:103], a[220:223], v[156:159]
  v_cvt_pk_bf16_f32 v146, v148, v149
  v_cvt_pk_bf16_f32 v147, v150, v151
  v_mfma_f32_16x16x32_bf16 v[156:159], v[104:107], a[224:227], v[156:159]
  s_and_b32 s90, s90, 0x7e00
  v_mul_f32 v225, v191, v225
  v_mfma_f32_16x16x32_bf16 v[156:159], v[108:111], a[228:231], v[156:159]
  v_cvt_pk_bf16_f32 v232, v224, v225
  v_cvt_f32_i32 v226, v226
  v_mfma_f32_16x16x32_bf16 v[160:163], v[64:67], a[232:235], v[180:183]
  v_exp_f32 v152, v152
  v_mfma_f32_16x16x32_bf16 v[160:163], v[68:71], a[236:239], v[160:163]
  v_exp_f32 v153, v153
  v_mfma_f32_16x16x32_bf16 v[160:163], v[72:75], a[240:243], v[160:163]
  v_exp_f32 v154, v154
  v_mfma_f32_16x16x32_bf16 v[160:163], v[76:79], a[244:247], v[160:163]
  v_exp_f32 v155, v155
  v_mfma_f32_16x16x32_bf16 v[160:163], v[80:83], a[248:251], v[160:163]
  v_cvt_pk_bf16_f32 v152, v152, v153
  v_cvt_pk_bf16_f32 v153, v154, v155
  v_mfma_f32_16x16x32_bf16 v[160:163], v[84:87], a[252:255], v[160:163]
  v_exp_f32 v156, v156
  v_mfma_f32_16x16x32_bf16 v[164:167], v[88:91], a[232:235], v[180:183]
  v_exp_f32 v157, v157
  v_mfma_f32_16x16x32_bf16 v[164:167], v[92:95], a[236:239], v[164:167]
  v_exp_f32 v158, v158
  v_mfma_f32_16x16x32_bf16 v[164:167], v[96:99], a[240:243], v[164:167]
  v_exp_f32 v159, v159
  v_mfma_f32_16x16x32_bf16 v[164:167], v[100:103], a[244:247], v[164:167]
  v_cvt_pk_bf16_f32 v154, v156, v157
  v_cvt_pk_bf16_f32 v155, v158, v159
  v_mfma_f32_16x16x32_bf16 v[164:167], v[104:107], a[248:251], v[164:167]
  v_cvt_f32_i32 v227, v227
  v_lshlrev_b32 v188, 16, v233
  s_waitcnt lgkmcnt(0)
  v_mfma_f32_16x16x32_bf16 v[164:167], v[108:111], a[252:255], v[164:167]
  v_and_b32 v189, s44, v233
  v_cvt_pk_bf16_f32 v226, 0, v226
  v_mfma_f32_16x16x32_bf16 a[0:3], v[112:115], v[136:139], a[0:3]
  v_exp_f32 v160, v160
  v_mfma_f32_16x16x32_bf16 a[4:7], v[112:115], v[144:147], a[4:7]
  v_exp_f32 v161, v161
  v_mfma_f32_16x16x32_bf16 a[8:11], v[112:115], v[152:155], a[8:11]
  v_exp_f32 v162, v162
  v_mfma_f32_16x16x32_bf16 a[16:19], v[116:119], v[136:139], a[16:19]
  v_exp_f32 v163, v163
  v_mfma_f32_16x16x32_bf16 a[20:23], v[116:119], v[144:147], a[20:23]
  v_cvt_pk_bf16_f32 v160, v160, v161
  v_cvt_pk_bf16_f32 v161, v162, v163
  v_mfma_f32_16x16x32_bf16 a[24:27], v[116:119], v[152:155], a[24:27]
  v_exp_f32 v164, v164
  v_mfma_f32_16x16x32_bf16 a[32:35], v[120:123], v[136:139], a[32:35]
  v_exp_f32 v165, v165
  v_mfma_f32_16x16x32_bf16 a[36:39], v[120:123], v[144:147], a[36:39]
  v_exp_f32 v166, v166
  v_mfma_f32_16x16x32_bf16 a[40:43], v[120:123], v[152:155], a[40:43]
  v_exp_f32 v167, v167
  v_mfma_f32_16x16x32_bf16 a[48:51], v[124:127], v[136:139], a[48:51]
  v_cvt_pk_bf16_f32 v162, v164, v165
  v_cvt_pk_bf16_f32 v163, v166, v167
  v_mfma_f32_16x16x32_bf16 a[52:55], v[124:127], v[144:147], a[52:55]
  s_waitcnt vmcnt(16)
  v_cmp_eq_u64 vcc, s[88:89], v[6:7]
  s_add_u32 m0, s37, 0
  v_mfma_f32_16x16x32_bf16 a[56:59], v[124:127], v[152:155], a[56:59]
  s_waitcnt vmcnt(10)
  s_barrier
  v_mfma_f32_16x16x32_bf16 a[192:195], v[12:15], v[136:139], a[192:195]
  s_cbranch_vccz L_slow10
L_ret10:
  buffer_load_dwordx2 v[6:7], v1, s[4:7], s90 offen sc1
  v_mfma_f32_16x16x32_bf16 a[196:199], v[12:15], v[144:147], a[196:199]
  ds_read_b128 v[64:67], v4 offset:24576
  v_cvt_pk_bf16_f32 v227, 0, v227
  v_mfma_f32_16x16x32_bf16 a[200:203], v[12:15], v[152:155], a[200:203]
  buffer_load_dwordx4 v8, s[4:7], s48 offen offset:0 sc1 lds
  v_lshlrev_b32 v190, 16, v237
  v_mfma_f32_16x16x32_bf16 a[12:15], v[112:115], v[160:163], a[12:15]
  ds_read_b128 v[68:71], v4 offset:25600
  v_and_b32 v191, s44, v237
  v_mfma_f32_16x16x32_bf16 a[28:31], v[116:119], v[160:163], a[28:31]
  ds_read_b128 v[112:115], v5 offset:13824
  v_subrev_f32 v226, v188, v226
  v_mfma_f32_16x16x32_bf16 a[44:47], v[120:123], v[160:163], a[44:47]
  ds_read_b128 v[116:119], v5 offset:14080
  v_subrev_f32 v227, v189, v227
  v_mfma_f32_16x16x32_bf16 a[60:63], v[124:127], v[160:163], a[60:63]
  ds_read_b128 v[120:123], v5 offset:14336
  v_mul_f32 v190, s42, v190
  v_mfma_f32_16x16x32_bf16 a[204:207], v[12:15], v[160:163], a[204:207]
  ds_read_b128 v[124:127], v5 offset:14592
  v_mfma_f32_16x16x32_bf16 a[64:67], v[128:131], v[136:139], a[64:67]
  ds_read_b128 v[72:75], v4 offset:26624
  v_mul_f32 v191, s43, v191
  v_mfma_f32_16x16x32_bf16 a[68:71], v[128:131], v[144:147], a[68:71]
  ds_read_b128 v[76:79], v4 offset:27648
  v_cvt_pk_bf16_f32 v226, 0, v226
  v_mfma_f32_16x16x32_bf16 a[72:75], v[128:131], v[152:155], a[72:75]
  buffer_load_dwordx4 v8, s[4:7], s48 offen offset:1024 sc1 lds
  v_cvt_pk_bf16_f32 v227, 0, v227
  v_mfma_f32_16x16x32_bf16 a[76:79], v[128:131], v[160:163], a[76:79]
  ds_read_b128 v[80:83], v4 offset:28672
  v_mul_f32 v226, v190, v226
  v_mfma_f32_16x16x32_bf16 a[80:83], v[132:135], v[136:139], a[80:83]
  ds_read_b128 v[128:131], v5 offset:14848
  v_mul_f32 v227, v191, v227
  v_mfma_f32_16x16x32_bf16 a[84:87], v[132:135], v[144:147], a[84:87]
  ds_read_b128 v[84:87], v4 offset:29696
  v_cvt_pk_bf16_f32 v233, v226, v227
  v_mfma_f32_16x16x32_bf16 a[88:91], v[132:135], v[152:155], a[88:91]
  ds_read_b128 v[88:91], v4 offset:30720
  v_cvt_f32_i32 v228, v228
  v_mfma_f32_16x16x32_bf16 a[92:95], v[132:135], v[160:163], a[92:95]
  ds_read_b128 v[92:95], v4 offset:31744
  v_cvt_f32_i32 v229, v229
  s_waitcnt lgkmcnt(10)
  v_mfma_f32_16x16x32_bf16 a[96:99], v[112:115], v[136:139], a[96:99]
  ds_read_b128 v[132:135], v5 offset:15104
  v_lshlrev_b32 v188, 16, v234
  v_mfma_f32_16x16x32_bf16 a[100:103], v[112:115], v[144:147], a[100:103]
  ds_read_b128 v[96:99], v4 offset:32768
  v_and_b32 v189, s44, v234
  v_mfma_f32_16x16x32_bf16 a[104:107], v[112:115], v[152:155], a[104:107]
  buffer_load_dwordx4 v8, s[4:7], s48 offen offset:2048 sc1 lds
  v_cvt_pk_bf16_f32 v228, 0, v228
  v_mfma_f32_16x16x32_bf16 a[108:111], v[112:115], v[160:163], a[108:111]
  ds_read_b128 v[100:103], v4 offset:33792
  v_cvt_pk_bf16_f32 v229, 0, v229
  s_waitcnt lgkmcnt(10)
  v_mfma_f32_16x16x32_bf16 a[112:115], v[116:119], v[136:139], a[112:115]
  s_add_u32 m0, s37, 49152
  v_lshlrev_b32 v190, 16, v238
  v_mfma_f32_16x16x32_bf16 a[116:119], v[116:119], v[144:147], a[116:119]
  ds_read_b128 v[104:107], v4 offset:34816
  v_mfma_f32_16x16x32_bf16 a[120:123], v[116:119], v[152:155], a[120:123]
  v_and_b32 v191, s44, v238
  v_subrev_f32 v228, v188, v228
  v_mfma_f32_16x16x32_bf16 a[124:127], v[116:119], v[160:163], a[124:127]
  ds_read_b128 v[108:111], v4 offset:35840
  v_subrev_f32 v229, v189, v229
  v_mfma_f32_16x16x32_bf16 a[128:131], v[120:123], v[136:139], a[128:131]
  v_mul_f32 v190, s42, v190
  v_mul_f32 v191, s43, v191
  v_mfma_f32_16x16x32_bf16 a[132:135], v[120:123], v[144:147], a[132:135]
  v_cvt_pk_bf16_f32 v228, 0, v228
  v_cvt_pk_bf16_f32 v229, 0, v229
  v_mfma_f32_16x16x32_bf16 a[136:139], v[120:123], v[152:155], a[136:139]
  buffer_load_dwordx4 v9, s[4:7], s48 offen offset:0 sc1 lds
  v_mul_f32 v228, v190, v228
  v_mfma_f32_16x16x32_bf16 a[140:143], v[120:123], v[160:163], a[140:143]
  v_mul_f32 v229, v191, v229
  v_cvt_pk_bf16_f32 v234, v228, v229
  v_mfma_f32_16x16x32_bf16 a[144:147], v[124:127], v[136:139], a[144:147]
  v_cvt_f32_i32 v230, v230
  v_cvt_f32_i32 v231, v231
  v_mfma_f32_16x16x32_bf16 a[148:151], v[124:127], v[144:147], a[148:151]
  v_lshlrev_b32 v188, 16, v235
  v_and_b32 v189, s44, v235
  v_mfma_f32_16x16x32_bf16 a[152:155], v[124:127], v[152:155], a[152:155]
  v_cvt_pk_bf16_f32 v230, 0, v230
  v_mfma_f32_16x16x32_bf16 a[156:159], v[124:127], v[160:163], a[156:159]
  v_cvt_pk_bf16_f32 v231, 0, v231
  v_lshlrev_b32 v190, 16, v239
  s_waitcnt lgkmcnt(4)
  v_mfma_f32_16x16x32_bf16 a[160:163], v[128:131], v[136:139], a[160:163]
  buffer_load_dwordx4 v9, s[4:7], s48 offen offset:1024 sc1 lds
  v_and_b32 v191, s44, v239
  v_mfma_f32_16x16x32_bf16 a[164:167], v[128:131], v[144:147], a[164:167]
  v_subrev_f32 v230, v188, v230
  v_subrev_f32 v231, v189, v231
  v_mfma_f32_16x16x32_bf16 a[168:171], v[128:131], v[152:155], a[168:171]
  v_mul_f32 v190, s42, v190
  v_mul_f32 v191, s43, v191
  v_mfma_f32_16x16x32_bf16 a[172:175], v[128:131], v[160:163], a[172:175]
  v_cvt_pk_bf16_f32 v230, 0, v230
  v_cvt_pk_bf16_f32 v231, 0, v231
  v_mfma_f32_16x16x32_bf16 a[176:179], v[132:135], v[136:139], a[176:179]
  v_mul_f32 v230, v190, v230
  v_mul_f32 v231, v191, v231
  v_mfma_f32_16x16x32_bf16 a[180:183], v[132:135], v[144:147], a[180:183]
  v_cvt_pk_bf16_f32 v235, v230, v231
  v_mfma_f32_16x16x32_bf16 a[184:187], v[132:135], v[152:155], a[184:187]
  buffer_load_dwordx4 v9, s[4:7], s48 offen offset:2048 sc1 lds
  v_mfma_f32_16x16x32_bf16 a[188:191], v[132:135], v[160:163], a[188:191]
  s_mul_i32 s48, s90, 48
  v_mfma_f32_16x16x32_bf16 v[136:139], v[64:67], v[16:19], v[168:171]
  buffer_store_dwordx4 v[232:235], v8, s[4:7], s77 offen offset:2048 sc1
  v_mfma_f32_16x16x32_bf16 v[136:139], v[68:71], v[20:23], v[136:139]
  ds_read_b128 v[112:115], v5 offset:24576
  v_mfma_f32_16x16x32_bf16 v[136:139], v[72:75], v[24:27], v[136:139]
  v_mfma_f32_16x16x32_bf16 v[136:139], v[76:79], v[28:31], v[136:139]
  ds_read_b128 v[116:119], v5 offset:24832
  s_waitcnt lgkmcnt(2)
  v_mfma_f32_16x16x32_bf16 v[136:139], v[80:83], v[32:35], v[136:139]
  buffer_load_dwordx4 v[224:227], v184, s[12:15], s45 offen offset:0 sc0 sc1 nt
  v_mfma_f32_16x16x32_bf16 v[136:139], v[84:87], v[36:39], v[136:139]
  ds_read_b128 v[120:123], v5 offset:25088
  v_mfma_f32_16x16x32_bf16 v[140:143], v[88:91], v[16:19], v[168:171]
  v_mfma_f32_16x16x32_bf16 v[140:143], v[92:95], v[20:23], v[140:143]
  ds_read_b128 v[124:127], v5 offset:25344
  v_mfma_f32_16x16x32_bf16 v[140:143], v[96:99], v[24:27], v[140:143]
  buffer_load_dwordx4 v[228:231], v184, s[12:15], s45 offen offset:16 sc0 sc1 nt
  v_mfma_f32_16x16x32_bf16 v[140:143], v[100:103], v[28:31], v[140:143]
  ds_read_b128 v[128:131], v5 offset:25600
  v_mfma_f32_16x16x32_bf16 v[140:143], v[104:107], v[32:35], v[140:143]
  v_mfma_f32_16x16x32_bf16 v[140:143], v[108:111], v[36:39], v[140:143]
  ds_read_b128 v[132:135], v5 offset:25856
  v_mfma_f32_16x16x32_bf16 v[144:147], v[64:67], v[40:43], v[172:175]
  v_exp_f32 v136, v136
  v_mfma_f32_16x16x32_bf16 v[144:147], v[68:71], v[44:47], v[144:147]
  v_exp_f32 v137, v137
  buffer_load_dwordx4 v[232:235], v185, s[24:27], s46 offen offset:0
  v_mfma_f32_16x16x32_bf16 v[144:147], v[72:75], v[48:51], v[144:147]
  v_exp_f32 v138, v138
  v_mfma_f32_16x16x32_bf16 v[144:147], v[76:79], v[52:55], v[144:147]
  v_exp_f32 v139, v139
  v_mfma_f32_16x16x32_bf16 v[144:147], v[80:83], v[56:59], v[144:147]
  v_cvt_pk_bf16_f32 v136, v136, v137
  v_cvt_pk_bf16_f32 v137, v138, v139
  v_mfma_f32_16x16x32_bf16 v[144:147], v[84:87], v[60:63], v[144:147]
  v_exp_f32 v140, v140
  v_mfma_f32_16x16x32_bf16 v[148:151], v[88:91], v[40:43], v[172:175]
  v_exp_f32 v141, v141
  buffer_load_dwordx4 v[236:239], v185, s[20:23], s46 offen offset:0
  v_mfma_f32_16x16x32_bf16 v[148:151], v[92:95], v[44:47], v[148:151]
  v_exp_f32 v142, v142
  v_mfma_f32_16x16x32_bf16 v[148:151], v[96:99], v[48:51], v[148:151]
  v_exp_f32 v143, v143
  v_mfma_f32_16x16x32_bf16 v[148:151], v[100:103], v[52:55], v[148:151]
  v_cvt_pk_bf16_f32 v138, v140, v141
  v_cvt_pk_bf16_f32 v139, v142, v143
  v_mfma_f32_16x16x32_bf16 v[148:151], v[104:107], v[56:59], v[148:151]
  s_add_u32 s3, s3, 512
  v_mfma_f32_16x16x32_bf16 v[148:151], v[108:111], v[60:63], v[148:151]
  s_xor_b32 s90, s3, s76
  buffer_load_short_d16_hi v10, v187, s[32:35], s47 offen
  v_mfma_f32_16x16x32_bf16 v[152:155], v[64:67], a[208:211], v[176:179]
  v_exp_f32 v144, v144
  v_mfma_f32_16x16x32_bf16 v[152:155], v[68:71], a[212:215], v[152:155]
  v_exp_f32 v145, v145
  v_mfma_f32_16x16x32_bf16 v[152:155], v[72:75], a[216:219], v[152:155]
  v_exp_f32 v146, v146
  v_mfma_f32_16x16x32_bf16 v[152:155], v[76:79], a[220:223], v[152:155]
  v_exp_f32 v147, v147
  buffer_load_short_d16_hi v11, v187, s[28:31], s47 offen
  v_mfma_f32_16x16x32_bf16 v[152:155], v[80:83], a[224:227], v[152:155]
  v_cvt_pk_bf16_f32 v144, v144, v145
  v_cvt_pk_bf16_f32 v145, v146, v147
  v_mfma_f32_16x16x32_bf16 v[152:155], v[84:87], a[228:231], v[152:155]
  v_exp_f32 v148, v148
  v_mfma_f32_16x16x32_bf16 v[156:159], v[88:91], a[208:211], v[176:179]
  v_exp_f32 v149, v149
  v_mfma_f32_16x16x32_bf16 v[156:159], v[92:95], a[212:215], v[156:159]
  v_exp_f32 v150, v150
  v_mfma_f32_16x16x32_bf16 v[156:159], v[96:99], a[216:219], v[156:159]
  v_exp_f32 v151, v151
  v_mfma_f32_16x16x32_bf16 v[156:159], v[100:103], a[220:223], v[156:159]
  v_cvt_pk_bf16_f32 v146, v148, v149
  v_cvt_pk_bf16_f32 v147, v150, v151
  v_mfma_f32_16x16x32_bf16 v[156:159], v[104:107], a[224:227], v[156:159]
  s_and_b32 s90, s90, 0x7e00
  v_mfma_f32_16x16x32_bf16 v[156:159], v[108:111], a[228:231], v[156:159]
  v_mfma_f32_16x16x32_bf16 v[160:163], v[64:67], a[232:235], v[180:183]
  v_exp_f32 v152, v152
  v_mfma_f32_16x16x32_bf16 v[160:163], v[68:71], a[236:239], v[160:163]
  v_exp_f32 v153, v153
  v_mfma_f32_16x16x32_bf16 v[160:163], v[72:75], a[240:243], v[160:163]
  v_exp_f32 v154, v154
  v_mfma_f32_16x16x32_bf16 v[160:163], v[76:79], a[244:247], v[160:163]
  v_exp_f32 v155, v155
  v_mfma_f32_16x16x32_bf16 v[160:163], v[80:83], a[248:251], v[160:163]
  v_cvt_pk_bf16_f32 v152, v152, v153
  v_cvt_pk_bf16_f32 v153, v154, v155
  v_mfma_f32_16x16x32_bf16 v[160:163], v[84:87], a[252:255], v[160:163]
  v_exp_f32 v156, v156
  v_mfma_f32_16x16x32_bf16 v[164:167], v[88:91], a[232:235], v[180:183]
  v_exp_f32 v157, v157
  v_mfma_f32_16x16x32_bf16 v[164:167], v[92:95], a[236:239], v[164:167]
  v_exp_f32 v158, v158
  v_mfma_f32_16x16x32_bf16 v[164:167], v[96:99], a[240:243], v[164:167]
  v_exp_f32 v159, v159
  v_mfma_f32_16x16x32_bf16 v[164:167], v[100:103], a[244:247], v[164:167]
  v_cvt_pk_bf16_f32 v154, v156, v157
  v_cvt_pk_bf16_f32 v155, v158, v159
  v_mfma_f32_16x16x32_bf16 v[164:167], v[104:107], a[248:251], v[164:167]
  s_waitcnt lgkmcnt(0)
  v_mfma_f32_16x16x32_bf16 v[164:167], v[108:111], a[252:255], v[164:167]
  v_mfma_f32_16x16x32_bf16 a[0:3], v[112:115], v[136:139], a[0:3]
  v_exp_f32 v160, v160
  v_mfma_f32_16x16x32_bf16 a[4:7], v[112:115], v[144:147], a[4:7]
  v_exp_f32 v161, v161
  v_mfma_f32_16x16x32_bf16 a[8:11], v[112:115], v[152:155], a[8:11]
  v_exp_f32 v162, v162
  v_mfma_f32_16x16x32_bf16 a[16:19], v[116:119], v[136:139], a[16:19]
  v_exp_f32 v163, v163
  v_mfma_f32_16x16x32_bf16 a[20:23], v[116:119], v[144:147], a[20:23]
  v_cvt_pk_bf16_f32 v160, v160, v161
  v_cvt_pk_bf16_f32 v161, v162, v163
  v_mfma_f32_16x16x32_bf16 a[24:27], v[116:119], v[152:155], a[24:27]
  v_exp_f32 v164, v164
  v_mfma_f32_16x16x32_bf16 a[32:35], v[120:123], v[136:139], a[32:35]
  v_exp_f32 v165, v165
  v_mfma_f32_16x16x32_bf16 a[36:39], v[120:123], v[144:147], a[36:39]
  v_exp_f32 v166, v166
  v_mfma_f32_16x16x32_bf16 a[40:43], v[120:123], v[152:155], a[40:43]
  v_exp_f32 v167, v167
  v_mfma_f32_16x16x32_bf16 a[48:51], v[124:127], v[136:139], a[48:51]
  v_cvt_pk_bf16_f32 v162, v164, v165
  v_cvt_pk_bf16_f32 v163, v166, v167
  v_mfma_f32_16x16x32_bf16 a[52:55], v[124:127], v[144:147], a[52:55]
  s_waitcnt vmcnt(23)
  v_cmp_eq_u64 vcc, s[88:89], v[2:3]
  s_add_u32 m0, s37, 12288
  v_mfma_f32_16x16x32_bf16 a[56:59], v[124:127], v[152:155], a[56:59]
  s_waitcnt vmcnt(17)
  s_barrier
  v_mfma_f32_16x16x32_bf16 a[192:195], v[12:15], v[136:139], a[192:195]
  s_cbranch_vccz L_slow11
L_ret11:
  buffer_load_dwordx2 v[2:3], v1, s[4:7], s90 offen sc1
  v_mfma_f32_16x16x32_bf16 a[196:199], v[12:15], v[144:147], a[196:199]
  ds_read_b128 v[64:67], v4 offset:36864
  v_mfma_f32_16x16x32_bf16 a[200:203], v[12:15], v[152:155], a[200:203]
  buffer_load_dwordx4 v8, s[4:7], s40 offen offset:0 sc1 lds
  v_mfma_f32_16x16x32_bf16 a[12:15], v[112:115], v[160:163], a[12:15]
  ds_read_b128 v[68:71], v4 offset:37888
  v_mfma_f32_16x16x32_bf16 a[28:31], v[116:119], v[160:163], a[28:31]
  ds_read_b128 v[112:115], v5 offset:26112
  v_mfma_f32_16x16x32_bf16 a[44:47], v[120:123], v[160:163], a[44:47]
  ds_read_b128 v[116:119], v5 offset:26368
  v_mfma_f32_16x16x32_bf16 a[60:63], v[124:127], v[160:163], a[60:63]
  ds_read_b128 v[120:123], v5 offset:26624
  v_mfma_f32_16x16x32_bf16 a[204:207], v[12:15], v[160:163], a[204:207]
  ds_read_b128 v[124:127], v5 offset:26880
  v_mfma_f32_16x16x32_bf16 a[64:67], v[128:131], v[136:139], a[64:67]
  ds_read_b128 v[72:75], v4 offset:38912
  v_mfma_f32_16x16x32_bf16 a[68:71], v[128:131], v[144:147], a[68:71]
  ds_read_b128 v[76:79], v4 offset:39936
  v_mfma_f32_16x16x32_bf16 a[72:75], v[128:131], v[152:155], a[72:75]
  buffer_load_dwordx4 v8, s[4:7], s40 offen offset:1024 sc1 lds
  v_mfma_f32_16x16x32_bf16 a[76:79], v[128:131], v[160:163], a[76:79]
  ds_read_b128 v[80:83], v4 offset:40960
  v_mfma_f32_16x16x32_bf16 a[80:83], v[132:135], v[136:139], a[80:83]
  ds_read_b128 v[128:131], v5 offset:27136
  v_mfma_f32_16x16x32_bf16 a[84:87], v[132:135], v[144:147], a[84:87]
  ds_read_b128 v[84:87], v4 offset:41984
  v_mfma_f32_16x16x32_bf16 a[88:91], v[132:135], v[152:155], a[88:91]
  ds_read_b128 v[88:91], v4 offset:43008
  v_mfma_f32_16x16x32_bf16 a[92:95], v[132:135], v[160:163], a[92:95]
  ds_read_b128 v[92:95], v4 offset:44032
  s_waitcnt lgkmcnt(10)
  v_mfma_f32_16x16x32_bf16 a[96:99], v[112:115], v[136:139], a[96:99]
  ds_read_b128 v[132:135], v5 offset:27392
  v_mfma_f32_16x16x32_bf16 a[100:103], v[112:115], v[144:147], a[100:103]
  ds_read_b128 v[96:99], v4 offset:45056
  v_mfma_f32_16x16x32_bf16 a[104:107], v[112:115], v[152:155], a[104:107]
  buffer_load_dwordx4 v8, s[4:7], s40 offen offset:2048 sc1 lds
  v_mfma_f32_16x16x32_bf16 a[108:111], v[112:115], v[160:163], a[108:111]
  ds_read_b128 v[100:103], v4 offset:46080
  s_waitcnt lgkmcnt(10)
  v_mfma_f32_16x16x32_bf16 a[112:115], v[116:119], v[136:139], a[112:115]
  s_add_u32 m0, s37, 61440
  v_mfma_f32_16x16x32_bf16 a[116:119], v[116:119], v[144:147], a[116:119]
  ds_read_b128 v[104:107], v4 offset:47104
  v_mfma_f32_16x16x32_bf16 a[120:123], v[116:119], v[152:155], a[120:123]
  v_mfma_f32_16x16x32_bf16 a[124:127], v[116:119], v[160:163], a[124:127]
  ds_read_b128 v[108:111], v4 offset:48128
  v_mfma_f32_16x16x32_bf16 a[128:131], v[120:123], v[136:139], a[128:131]
  v_mfma_f32_16x16x32_bf16 a[132:135], v[120:123], v[144:147], a[132:135]
  v_mfma_f32_16x16x32_bf16 a[136:139], v[120:123], v[152:155], a[136:139]
  buffer_load_dwordx4 v9, s[4:7], s40 offen offset:0 sc1 lds
  v_mfma_f32_16x16x32_bf16 a[140:143], v[120:123], v[160:163], a[140:143]
  v_mfma_f32_16x16x32_bf16 a[144:147], v[124:127], v[136:139], a[144:147]
  v_mfma_f32_16x16x32_bf16 a[148:151], v[124:127], v[144:147], a[148:151]
  v_mfma_f32_16x16x32_bf16 a[152:155], v[124:127], v[152:155], a[152:155]
  v_mfma_f32_16x16x32_bf16 a[156:159], v[124:127], v[160:163], a[156:159]
  s_waitcnt lgkmcnt(4)
  v_mfma_f32_16x16x32_bf16 a[160:163], v[128:131], v[136:139], a[160:163]
  buffer_load_dwordx4 v9, s[4:7], s40 offen offset:1024 sc1 lds
  v_mfma_f32_16x16x32_bf16 a[164:167], v[128:131], v[144:147], a[164:167]
  v_mfma_f32_16x16x32_bf16 a[168:171], v[128:131], v[152:155], a[168:171]
  v_mfma_f32_16x16x32_bf16 a[172:175], v[128:131], v[160:163], a[172:175]
  v_mfma_f32_16x16x32_bf16 a[176:179], v[132:135], v[136:139], a[176:179]
  v_mfma_f32_16x16x32_bf16 a[180:183], v[132:135], v[144:147], a[180:183]
  v_mfma_f32_16x16x32_bf16 a[184:187], v[132:135], v[152:155], a[184:187]
  buffer_load_dwordx4 v9, s[4:7], s40 offen offset:2048 sc1 lds
  v_mfma_f32_16x16x32_bf16 a[188:191], v[132:135], v[160:163], a[188:191]
  s_mul_i32 s40, s90, 48
  v_mfma_f32_16x16x32_bf16 v[136:139], v[64:67], v[16:19], v[168:171]
  buffer_load_dwordx3 v[192:194], v186, s[16:19], s45 offen offset:0 sc0 sc1 nt
  v_mfma_f32_16x16x32_bf16 v[136:139], v[68:71], v[20:23], v[136:139]
  ds_read_b128 v[112:115], v5 offset:36864
  v_mfma_f32_16x16x32_bf16 v[136:139], v[72:75], v[24:27], v[136:139]
  v_mfma_f32_16x16x32_bf16 v[136:139], v[76:79], v[28:31], v[136:139]
  ds_read_b128 v[116:119], v5 offset:37120
  s_waitcnt lgkmcnt(2)
  v_mfma_f32_16x16x32_bf16 v[136:139], v[80:83], v[32:35], v[136:139]
  buffer_load_dwordx3 v[196:198], v186, s[16:19], s45 offen offset:768 sc0 sc1 nt
  v_mfma_f32_16x16x32_bf16 v[136:139], v[84:87], v[36:39], v[136:139]
  ds_read_b128 v[120:123], v5 offset:37376
  v_mfma_f32_16x16x32_bf16 v[140:143], v[88:91], v[16:19], v[168:171]
  v_mfma_f32_16x16x32_bf16 v[140:143], v[92:95], v[20:23], v[140:143]
  ds_read_b128 v[124:127], v5 offset:37632
  v_mfma_f32_16x16x32_bf16 v[140:143], v[96:99], v[24:27], v[140:143]
  buffer_load_dwordx3 v[200:202], v186, s[16:19], s45 offen offset:1536 sc0 sc1 nt
  v_mfma_f32_16x16x32_bf16 v[140:143], v[100:103], v[28:31], v[140:143]
  ds_read_b128 v[128:131], v5 offset:37888
  v_mfma_f32_16x16x32_bf16 v[140:143], v[104:107], v[32:35], v[140:143]
  v_mfma_f32_16x16x32_bf16 v[140:143], v[108:111], v[36:39], v[140:143]
  ds_read_b128 v[132:135], v5 offset:38144
  v_mfma_f32_16x16x32_bf16 v[144:147], v[64:67], v[40:43], v[172:175]
  v_exp_f32 v136, v136
  v_mfma_f32_16x16x32_bf16 v[144:147], v[68:71], v[44:47], v[144:147]
  v_exp_f32 v137, v137
  buffer_load_dwordx3 v[204:206], v186, s[16:19], s45 offen offset:2304 sc0 sc1 nt
  v_mfma_f32_16x16x32_bf16 v[144:147], v[72:75], v[48:51], v[144:147]
  v_exp_f32 v138, v138
  v_mfma_f32_16x16x32_bf16 v[144:147], v[76:79], v[52:55], v[144:147]
  v_exp_f32 v139, v139
  v_mfma_f32_16x16x32_bf16 v[144:147], v[80:83], v[56:59], v[144:147]
  v_cvt_pk_bf16_f32 v136, v136, v137
  v_cvt_pk_bf16_f32 v137, v138, v139
  v_mfma_f32_16x16x32_bf16 v[144:147], v[84:87], v[60:63], v[144:147]
  v_exp_f32 v140, v140
  v_mfma_f32_16x16x32_bf16 v[148:151], v[88:91], v[40:43], v[172:175]
  v_exp_f32 v141, v141
  buffer_load_dwordx3 v[208:210], v186, s[16:19], s49 offen offset:0 sc0 sc1 nt
  v_mfma_f32_16x16x32_bf16 v[148:151], v[92:95], v[44:47], v[148:151]
  v_exp_f32 v142, v142
  v_mfma_f32_16x16x32_bf16 v[148:151], v[96:99], v[48:51], v[148:151]
  v_exp_f32 v143, v143
  v_mfma_f32_16x16x32_bf16 v[148:151], v[100:103], v[52:55], v[148:151]
  v_cvt_pk_bf16_f32 v138, v140, v141
  v_cvt_pk_bf16_f32 v139, v142, v143
  v_mfma_f32_16x16x32_bf16 v[148:151], v[104:107], v[56:59], v[148:151]
  s_add_u32 s3, s3, 512
  v_mfma_f32_16x16x32_bf16 v[148:151], v[108:111], v[60:63], v[148:151]
  s_xor_b32 s90, s3, s76
  buffer_load_dwordx3 v[212:214], v186, s[16:19], s49 offen offset:768 sc0 sc1 nt
  v_mfma_f32_16x16x32_bf16 v[152:155], v[64:67], a[208:211], v[176:179]
  v_exp_f32 v144, v144
  v_mfma_f32_16x16x32_bf16 v[152:155], v[68:71], a[212:215], v[152:155]
  v_exp_f32 v145, v145
  v_mfma_f32_16x16x32_bf16 v[152:155], v[72:75], a[216:219], v[152:155]
  v_exp_f32 v146, v146
  v_mfma_f32_16x16x32_bf16 v[152:155], v[76:79], a[220:223], v[152:155]
  v_exp_f32 v147, v147
  buffer_load_dwordx3 v[216:218], v186, s[16:19], s49 offen offset:1536 sc0 sc1 nt
  v_mfma_f32_16x16x32_bf16 v[152:155], v[80:83], a[224:227], v[152:155]
  v_cvt_pk_bf16_f32 v144, v144, v145
  v_cvt_pk_bf16_f32 v145, v146, v147
  v_mfma_f32_16x16x32_bf16 v[152:155], v[84:87], a[228:231], v[152:155]
  v_exp_f32 v148, v148
  v_mfma_f32_16x16x32_bf16 v[156:159], v[88:91], a[208:211], v[176:179]
  v_exp_f32 v149, v149
  buffer_load_dwordx3 v[220:222], v186, s[16:19], s49 offen offset:2304 sc0 sc1 nt
  v_mfma_f32_16x16x32_bf16 v[156:159], v[92:95], a[212:215], v[156:159]
  v_exp_f32 v150, v150
  v_mfma_f32_16x16x32_bf16 v[156:159], v[96:99], a[216:219], v[156:159]
  v_exp_f32 v151, v151
  v_mfma_f32_16x16x32_bf16 v[156:159], v[100:103], a[220:223], v[156:159]
  v_cvt_pk_bf16_f32 v146, v148, v149
  v_cvt_pk_bf16_f32 v147, v150, v151
  v_mfma_f32_16x16x32_bf16 v[156:159], v[104:107], a[224:227], v[156:159]
  s_and_b32 s90, s90, 0x7e00
  v_mfma_f32_16x16x32_bf16 v[156:159], v[108:111], a[228:231], v[156:159]
  v_mfma_f32_16x16x32_bf16 v[160:163], v[64:67], a[232:235], v[180:183]
  v_exp_f32 v152, v152
  v_mfma_f32_16x16x32_bf16 v[160:163], v[68:71], a[236:239], v[160:163]
  v_exp_f32 v153, v153
  v_mfma_f32_16x16x32_bf16 v[160:163], v[72:75], a[240:243], v[160:163]
  v_exp_f32 v154, v154
  v_mfma_f32_16x16x32_bf16 v[160:163], v[76:79], a[244:247], v[160:163]
  v_exp_f32 v155, v155
  v_mfma_f32_16x16x32_bf16 v[160:163], v[80:83], a[248:251], v[160:163]
  v_cvt_pk_bf16_f32 v152, v152, v153
  v_cvt_pk_bf16_f32 v153, v154, v155
  v_mfma_f32_16x16x32_bf16 v[160:163], v[84:87], a[252:255], v[160:163]
  v_exp_f32 v156, v156
  v_mfma_f32_16x16x32_bf16 v[164:167], v[88:91], a[232:235], v[180:183]
  v_exp_f32 v157, v157
  v_mfma_f32_16x16x32_bf16 v[164:167], v[92:95], a[236:239], v[164:167]
  v_exp_f32 v158, v158
  v_mfma_f32_16x16x32_bf16 v[164:167], v[96:99], a[240:243], v[164:167]
  v_exp_f32 v159, v159
  v_mfma_f32_16x16x32_bf16 v[164:167], v[100:103], a[244:247], v[164:167]
  v_cvt_pk_bf16_f32 v154, v156, v157
  v_cvt_pk_bf16_f32 v155, v158, v159
  v_mfma_f32_16x16x32_bf16 v[164:167], v[104:107], a[248:251], v[164:167]
  s_waitcnt lgkmcnt(0)
  v_mfma_f32_16x16x32_bf16 v[164:167], v[108:111], a[252:255], v[164:167]
  v_mfma_f32_16x16x32_bf16 a[0:3], v[112:115], v[136:139], a[0:3]
  v_exp_f32 v160, v160
  v_mfma_f32_16x16x32_bf16 a[4:7], v[112:115], v[144:147], a[4:7]
  v_exp_f32 v161, v161
  v_mfma_f32_16x16x32_bf16 a[8:11], v[112:115], v[152:155], a[8:11]
  v_exp_f32 v162, v162
  v_mfma_f32_16x16x32_bf16 a[16:19], v[116:119], v[136:139], a[16:19]
  v_exp_f32 v163, v163
  v_mfma_f32_16x16x32_bf16 a[20:23], v[116:119], v[144:147], a[20:23]
  v_cvt_pk_bf16_f32 v160, v160, v161
  v_cvt_pk_bf16_f32 v161, v162, v163
  v_mfma_f32_16x16x32_bf16 a[24:27], v[116:119], v[152:155], a[24:27]
  v_exp_f32 v164, v164
  v_mfma_f32_16x16x32_bf16 a[32:35], v[120:123], v[136:139], a[32:35]
  v_exp_f32 v165, v165
  v_mfma_f32_16x16x32_bf16 a[36:39], v[120:123], v[144:147], a[36:39]
  v_exp_f32 v166, v166
  v_mfma_f32_16x16x32_bf16 a[40:43], v[120:123], v[152:155], a[40:43]
  v_exp_f32 v167, v167
  v_mfma_f32_16x16x32_bf16 a[48:51], v[124:127], v[136:139], a[48:51]
  v_cvt_pk_bf16_f32 v162, v164, v165
  v_cvt_pk_bf16_f32 v163, v166, v167
  v_mfma_f32_16x16x32_bf16 a[52:55], v[124:127], v[144:147], a[52:55]
  s_waitcnt vmcnt(28)
  v_cmp_eq_u64 vcc, s[88:89], v[6:7]
  s_add_u32 m0, s37, 24576
  v_mfma_f32_16x16x32_bf16 a[56:59], v[124:127], v[152:155], a[56:59]
  s_waitcnt vmcnt(21)
  s_barrier
  v_mfma_f32_16x16x32_bf16 a[192:195], v[12:15], v[136:139], a[192:195]
  s_cbranch_vccz L_slow12
L_ret12:
  v_mov_b32 v188, s88
  v_mov_b32 v189, s89
  buffer_store_dwordx2 v[188:189], v1, s[4:7], s91 offen sc1
  s_add_u32 s91, s91, 4096
  v_mfma_f32_16x16x32_bf16 a[196:199], v[12:15], v[144:147], a[196:199]
  ds_read_b128 v[64:67], v4 offset:0
  s_mov_b32 s77, s45
  v_mfma_f32_16x16x32_bf16 a[200:203], v[12:15], v[152:155], a[200:203]
  buffer_load_dwordx4 v8, s[4:7], s48 offen offset:0 sc1 lds
  v_mfma_f32_16x16x32_bf16 a[12:15], v[112:115], v[160:163], a[12:15]
  ds_read_b128 v[68:71], v4 offset:1024
  v_mfma_f32_16x16x32_bf16 a[28:31], v[116:119], v[160:163], a[28:31]
  ds_read_b128 v[112:115], v5 offset:38400
  v_mfma_f32_16x16x32_bf16 a[44:47], v[120:123], v[160:163], a[44:47]
  ds_read_b128 v[116:119], v5 offset:38656
  v_mfma_f32_16x16x32_bf16 a[60:63], v[124:127], v[160:163], a[60:63]
  ds_read_b128 v[120:123], v5 offset:38912
  v_mfma_f32_16x16x32_bf16 a[204:207], v[12:15], v[160:163], a[204:207]
  ds_read_b128 v[124:127], v5 offset:39168
  v_mfma_f32_16x16x32_bf16 a[64:67], v[128:131], v[136:139], a[64:67]
  ds_read_b128 v[72:75], v4 offset:2048
  s_mov_b32 s78, s46
  v_mfma_f32_16x16x32_bf16 a[68:71], v[128:131], v[144:147], a[68:71]
  ds_read_b128 v[76:79], v4 offset:3072
  v_mfma_f32_16x16x32_bf16 a[72:75], v[128:131], v[152:155], a[72:75]
  buffer_load_dwordx4 v8, s[4:7], s48 offen offset:1024 sc1 lds
  v_mfma_f32_16x16x32_bf16 a[76:79], v[128:131], v[160:163], a[76:79]
  ds_read_b128 v[80:83], v4 offset:4096
  v_mfma_f32_16x16x32_bf16 a[80:83], v[132:135], v[136:139], a[80:83]
  ds_read_b128 v[128:131], v5 offset:39424
  v_mfma_f32_16x16x32_bf16 a[84:87], v[132:135], v[144:147], a[84:87]
  ds_read_b128 v[84:87], v4 offset:5120
  v_mfma_f32_16x16x32_bf16 a[88:91], v[132:135], v[152:155], a[88:91]
  ds_read_b128 v[88:91], v4 offset:6144
  v_mfma_f32_16x16x32_bf16 a[92:95], v[132:135], v[160:163], a[92:95]
  ds_read_b128 v[92:95], v4 offset:7168
  s_waitcnt lgkmcnt(10)
  v_mfma_f32_16x16x32_bf16 a[96:99], v[112:115], v[136:139], a[96:99]
  ds_read_b128 v[132:135], v5 offset:39680
  s_add_u32 s45, s45, 196608
  v_mfma_f32_16x16x32_bf16 a[100:103], v[112:115], v[144:147], a[100:103]
  ds_read_b128 v[96:99], v4 offset:8192
  v_mfma_f32_16x16x32_bf16 a[104:107], v[112:115], v[152:155], a[104:107]
  buffer_load_dwordx4 v8, s[4:7], s48 offen offset:2048 sc1 lds
  v_mfma_f32_16x16x32_bf16 a[108:111], v[112:115], v[160:163], a[108:111]
  ds_read_b128 v[100:103], v4 offset:9216
  s_waitcnt lgkmcnt(10)
  v_mfma_f32_16x16x32_bf16 a[112:115], v[116:119], v[136:139], a[112:115]
  s_add_u32 m0, s37, 73728
  v_mfma_f32_16x16x32_bf16 a[116:119], v[116:119], v[144:147], a[116:119]
  ds_read_b128 v[104:107], v4 offset:10240
  v_mfma_f32_16x16x32_bf16 a[120:123], v[116:119], v[152:155], a[120:123]
  v_mfma_f32_16x16x32_bf16 a[124:127], v[116:119], v[160:163], a[124:127]
  ds_read_b128 v[108:111], v4 offset:11264
  s_add_u32 s49, s49, 196608
  v_mfma_f32_16x16x32_bf16 a[128:131], v[120:123], v[136:139], a[128:131]
  v_mfma_f32_16x16x32_bf16 a[132:135], v[120:123], v[144:147], a[132:135]
  v_mfma_f32_16x16x32_bf16 a[136:139], v[120:123], v[152:155], a[136:139]
  buffer_load_dwordx4 v9, s[4:7], s48 offen offset:0 sc1 lds
  v_mfma_f32_16x16x32_bf16 a[140:143], v[120:123], v[160:163], a[140:143]
  s_add_u32 s46, s46, 3072
  v_mfma_f32_16x16x32_bf16 a[144:147], v[124:127], v[136:139], a[144:147]
  v_mfma_f32_16x16x32_bf16 a[148:151], v[124:127], v[144:147], a[148:151]
  v_mfma_f32_16x16x32_bf16 a[152:155], v[124:127], v[152:155], a[152:155]
  v_mfma_f32_16x16x32_bf16 a[156:159], v[124:127], v[160:163], a[156:159]
  s_add_u32 s47, s47, 512
  s_waitcnt lgkmcnt(4)
  v_mfma_f32_16x16x32_bf16 a[160:163], v[128:131], v[136:139], a[160:163]
  buffer_load_dwordx4 v9, s[4:7], s48 offen offset:1024 sc1 lds
  v_mfma_f32_16x16x32_bf16 a[164:167], v[128:131], v[144:147], a[164:167]
  v_mfma_f32_16x16x32_bf16 a[168:171], v[128:131], v[152:155], a[168:171]
  v_mfma_f32_16x16x32_bf16 a[172:175], v[128:131], v[160:163], a[172:175]
  v_mfma_f32_16x16x32_bf16 a[176:179], v[132:135], v[136:139], a[176:179]
  v_mfma_f32_16x16x32_bf16 a[180:183], v[132:135], v[144:147], a[180:183]
  v_mfma_f32_16x16x32_bf16 a[184:187], v[132:135], v[152:155], a[184:187]
  buffer_load_dwordx4 v9, s[4:7], s48 offen offset:2048 sc1 lds
  v_mfma_f32_16x16x32_bf16 a[188:191], v[132:135], v[160:163], a[188:191]
  s_mul_i32 s48, s90, 48
  s_mov_b32 s41, 5
.p2align 6
L_loopB:
  v_mfma_f32_16x16x32_bf16 v[136:139], v[64:67], v[16:19], v[168:171]
  v_cvt_f32_i32 v240, v240
  v_cvt_f32_i32 v241, v241
  v_mfma_f32_16x16x32_bf16 v[136:139], v[68:71], v[20:23], v[136:139]
  ds_read_b128 v[112:115], v5 offset:0
  v_lshlrev_b32 v188, 16, v248
  v_mfma_f32_16x16x32_bf16 v[136:139], v[72:75], v[24:27], v[136:139]
  v_and_b32 v189, s44, v248
  v_cvt_pk_bf16_f32 v240, 0, v240
  v_mfma_f32_16x16x32_bf16 v[136:139], v[76:79], v[28:31], v[136:139]
  ds_read_b128 v[116:119], v5 offset:256
  v_cvt_pk_bf16_f32 v241, 0, v241
  s_waitcnt lgkmcnt(2)
  v_mfma_f32_16x16x32_bf16 v[136:139], v[80:83], v[32:35], v[136:139]
  v_lshlrev_b32 v190, 16, v252
  v_and_b32 v191, s44, v252
  v_mfma_f32_16x16x32_bf16 v[136:139], v[84:87], v[36:39], v[136:139]
  ds_read_b128 v[120:123], v5 offset:512
  v_mfma_f32_16x16x32_bf16 v[140:143], v[88:91], v[16:19], v[168:171]
  v_subrev_f32 v240, v188, v240
  v_subrev_f32 v241, v189, v241
  v_mfma_f32_16x16x32_bf16 v[140:143], v[92:95], v[20:23], v[140:143]
  ds_read_b128 v[124:127], v5 offset:768
  v_mul_f32 v190, s42, v190
  v_mfma_f32_16x16x32_bf16 v[140:143], v[96:99], v[24:27], v[140:143]
  v_mul_f32 v191, s43, v191
  v_cvt_pk_bf16_f32 v240, 0, v240
  v_mfma_f32_16x16x32_bf16 v[140:143], v[100:103], v[28:31], v[140:143]
  ds_read_b128 v[128:131], v5 offset:1024
  v_cvt_pk_bf16_f32 v241, 0, v241
  v_mfma_f32_16x16x32_bf16 v[140:143], v[104:107], v[32:35], v[140:143]
  v_mul_f32 v240, v190, v240
  v_mul_f32 v241, v191, v241
  v_mfma_f32_16x16x32_bf16 v[140:143], v[108:111], v[36:39], v[140:143]
  ds_read_b128 v[132:135], v5 offset:1280
  v_mfma_f32_16x16x32_bf16 v[144:147], v[64:67], v[40:43], v[172:175]
  v_exp_f32 v136, v136
  v_mfma_f32_16x16x32_bf16 v[144:147], v[68:71], v[44:47], v[144:147]
  v_exp_f32 v137, v137
  v_mfma_f32_16x16x32_bf16 v[144:147], v[72:75], v[48:51], v[144:147]
  v_exp_f32 v138, v138
  v_mfma_f32_16x16x32_bf16 v[144:147], v[76:79], v[52:55], v[144:147]
  v_exp_f32 v139, v139
  v_mfma_f32_16x16x32_bf16 v[144:147], v[80:83], v[56:59], v[144:147]
  v_cvt_pk_bf16_f32 v136, v136, v137
  v_cvt_pk_bf16_f32 v137, v138, v139
  v_mfma_f32_16x16x32_bf16 v[144:147], v[84:87], v[60:63], v[144:147]
  v_exp_f32 v140, v140
  v_mfma_f32_16x16x32_bf16 v[148:151], v[88:91], v[40:43], v[172:175]
  v_exp_f32 v141, v141
  v_mfma_f32_16x16x32_bf16 v[148:151], v[92:95], v[44:47], v[148:151]
  v_exp_f32 v142, v142
  v_mfma_f32_16x16x32_bf16 v[148:151], v[96:99], v[48:51], v[148:151]
  v_exp_f32 v143, v143
  v_mfma_f32_16x16x32_bf16 v[148:151], v[100:103], v[52:55], v[148:151]
  v_cvt_pk_bf16_f32 v138, v140, v141
  v_cvt_pk_bf16_f32 v139, v142, v143
  v_mfma_f32_16x16x32_bf16 v[148:151], v[104:107], v[56:59], v[148:151]
  s_add_u32 s3, s3, 512
  v_cvt_pk_bf16_f32 v248, v240, v241
  v_mfma_f32_16x16x32_bf16 v[148:151], v[108:111], v[60:63], v[148:151]
  s_xor_b32 s90, s3, s76
  v_cvt_f32_i32 v242, v242
  v_mfma_f32_16x16x32_bf16 v[152:155], v[64:67], a[208:211], v[176:179]
  v_exp_f32 v144, v144
  v_mfma_f32_16x16x32_bf16 v[152:155], v[68:71], a[212:215], v[152:155]
  v_exp_f32 v145, v145
  v_mfma_f32_16x16x32_bf16 v[152:155], v[72:75], a[216:219], v[152:155]
  v_exp_f32 v146, v146
  v_mfma_f32_16x16x32_bf16 v[152:155], v[76:79], a[220:223], v[152:155]
  v_exp_f32 v147, v147
  v_mfma_f32_16x16x32_bf16 v[152:155], v[80:83], a[224:227], v[152:155]
  v_cvt_pk_bf16_f32 v144, v144, v145
  v_cvt_pk_bf16_f32 v145, v146, v147
  v_mfma_f32_16x16x32_bf16 v[152:155], v[84:87], a[228:231], v[152:155]
  v_exp_f32 v148, v148
  v_mfma_f32_16x16x32_bf16 v[156:159], v[88:91], a[208:211], v[176:179]
  v_exp_f32 v149, v149
  v_mfma_f32_16x16x32_bf16 v[156:159], v[92:95], a[212:215], v[156:159]
  v_exp_f32 v150, v150
  v_mfma_f32_16x16x32_bf16 v[156:159], v[96:99], a[216:219], v[156:159]
  v_exp_f32 v151, v151
  v_mfma_f32_16x16x32_bf16 v[156:159], v[100:103], a[220:223], v[156:159]
  v_cvt_pk_bf16_f32 v146, v148, v149
  v_cvt_pk_bf16_f32 v147, v150, v151
  v_mfma_f32_16x16x32_bf16 v[156:159], v[104:107], a[224:227], v[156:159]
  s_and_b32 s90, s90, 0x7e00
  v_cvt_f32_i32 v243, v243
  v_mfma_f32_16x16x32_bf16 v[156:159], v[108:111], a[228:231], v[156:159]
  v_lshlrev_b32 v188, 16, v249
  v_and_b32 v189, s44, v249
  v_mfma_f32_16x16x32_bf16 v[160:163], v[64:67], a[232:235], v[180:183]
  v_exp_f32 v152, v152
  v_mfma_f32_16x16x32_bf16 v[160:163], v[68:71], a[236:239], v[160:163]
  v_exp_f32 v153, v153
  v_mfma_f32_16x16x32_bf16 v[160:163], v[72:75], a[240:243], v[160:163]
  v_exp_f32 v154, v154
  v_mfma_f32_16x16x32_bf16 v[160:163], v[76:79], a[244:247], v[160:163]
  v_exp_f32 v155, v155
  v_mfma_f32_16x16x32_bf16 v[160:163], v[80:83], a[248:251], v[160:163]
  v_cvt_pk_bf16_f32 v152, v152, v153
  v_cvt_pk_bf16_f32 v153, v154, v155
  v_mfma_f32_16x16x32_bf16 v[160:163], v[84:87], a[252:255], v[160:163]
  v_exp_f32 v156, v156
  v_mfma_f32_16x16x32_bf16 v[164:167], v[88:91], a[232:235], v[180:183]
  v_exp_f32 v157, v157
  v_mfma_f32_16x16x32_bf16 v[164:167], v[92:95], a[236:239], v[164:167]
  v_exp_f32 v158, v158
  v_mfma_f32_16x16x32_bf16 v[164:167], v[96:99], a[240:243], v[164:167]
  v_exp_f32 v159, v159
  v_mfma_f32_16x16x32_bf16 v[164:167], v[100:103], a[244:247], v[164:167]
  v_cvt_pk_bf16_f32 v154, v156, v157
  v_cvt_pk_bf16_f32 v155, v158, v159
  v_mfma_f32_16x16x32_bf16 v[164:167], v[104:107], a[248:251], v[164:167]
  v_cvt_pk_bf16_f32 v242, 0, v242
  v_cvt_pk_bf16_f32 v243, 0, v243
  s_waitcnt lgkmcnt(0)
  v_mfma_f32_16x16x32_bf16 v[164:167], v[108:111], a[252:255], v[164:167]
  v_lshlrev_b32 v190, 16, v253
  v_mfma_f32_16x16x32_bf16 a[0:3], v[112:115], v[136:139], a[0:3]
  v_exp_f32 v160, v160
  v_mfma_f32_16x16x32_bf16 a[4:7], v[112:115], v[144:147], a[4:7]
  v_exp_f32 v161, v161
  v_mfma_f32_16x16x32_bf16 a[8:11], v[112:115], v[152:155], a[8:11]
  v_exp_f32 v162, v162
  v_mfma_f32_16x16x32_bf16 a[16:19], v[116:119], v[136:139], a[16:19]
  v_exp_f32 v163, v163
  v_mfma_f32_16x16x32_bf16 a[20:23], v[116:119], v[144:147], a[20:23]
  v_cvt_pk_bf16_f32 v160, v160, v161
  v_cvt_pk_bf16_f32 v161, v162, v163
  v_mfma_f32_16x16x32_bf16 a[24:27], v[116:119], v[152:155], a[24:27]
  v_exp_f32 v164, v164
  v_mfma_f32_16x16x32_bf16 a[32:35], v[120:123], v[136:139], a[32:35]
  v_exp_f32 v165, v165
  v_mfma_f32_16x16x32_bf16 a[36:39], v[120:123], v[144:147], a[36:39]
  v_exp_f32 v166, v166
  v_mfma_f32_16x16x32_bf16 a[40:43], v[120:123], v[152:155], a[40:43]
  v_exp_f32 v167, v167
  v_mfma_f32_16x16x32_bf16 a[48:51], v[124:127], v[136:139], a[48:51]
  v_cvt_pk_bf16_f32 v162, v164, v165
  v_cvt_pk_bf16_f32 v163, v166, v167
  v_mfma_f32_16x16x32_bf16 a[52:55], v[124:127], v[144:147], a[52:55]
  s_waitcnt vmcnt(13)
  v_cmp_eq_u64 vcc, s[88:89], v[2:3]
  s_add_u32 m0, s37, 36864
  v_mfma_f32_16x16x32_bf16 a[56:59], v[124:127], v[152:155], a[56:59]
  s_waitcnt vmcnt(7)
  s_barrier
  v_mfma_f32_16x16x32_bf16 a[192:195], v[12:15], v[136:139], a[192:195]
  s_cbranch_vccz L_slow13
L_ret13:
  buffer_load_dwordx2 v[2:3], v1, s[4:7], s90 offen sc1
  v_mfma_f32_16x16x32_bf16 a[196:199], v[12:15], v[144:147], a[196:199]
  ds_read_b128 v[64:67], v4 offset:12288
  v_and_b32 v191, s44, v253
  v_mfma_f32_16x16x32_bf16 a[200:203], v[12:15], v[152:155], a[200:203]
  buffer_load_dwordx4 v8, s[4:7], s40 offen offset:0 sc1 lds
  v_subrev_f32 v242, v188, v242
  v_mfma_f32_16x16x32_bf16 a[12:15], v[112:115], v[160:163], a[12:15]
  ds_read_b128 v[68:71], v4 offset:13312
  v_subrev_f32 v243, v189, v243
  v_mfma_f32_16x16x32_bf16 a[28:31], v[116:119], v[160:163], a[28:31]
  ds_read_b128 v[112:115], v5 offset:1536
  v_mul_f32 v190, s42, v190
  v_mfma_f32_16x16x32_bf16 a[44:47], v[120:123], v[160:163], a[44:47]
  ds_read_b128 v[116:119], v5 offset:1792
  v_mul_f32 v191, s43, v191
  v_mfma_f32_16x16x32_bf16 a[60:63], v[124:127], v[160:163], a[60:63]
  ds_read_b128 v[120:123], v5 offset:2048
  v_cvt_pk_bf16_f32 v242, 0, v242
  v_mfma_f32_16x16x32_bf16 a[204:207], v[12:15], v[160:163], a[204:207]
  ds_read_b128 v[124:127], v5 offset:2304
  v_cvt_pk_bf16_f32 v243, 0, v243
  v_mfma_f32_16x16x32_bf16 a[64:67], v[128:131], v[136:139], a[64:67]
  ds_read_b128 v[72:75], v4 offset:14336
  v_mfma_f32_16x16x32_bf16 a[68:71], v[128:131], v[144:147], a[68:71]
  ds_read_b128 v[76:79], v4 offset:15360
  v_mul_f32 v242, v190, v242
  v_mfma_f32_16x16x32_bf16 a[72:75], v[128:131], v[152:155], a[72:75]
  buffer_load_dwordx4 v8, s[4:7], s40 offen offset:1024 sc1 lds
  v_mul_f32 v243, v191, v243
  v_mfma_f32_16x16x32_bf16 a[76:79], v[128:131], v[160:163], a[76:79]
  ds_read_b128 v[80:83], v4 offset:16384
  v_cvt_pk_bf16_f32 v249, v242, v243
  v_mfma_f32_16x16x32_bf16 a[80:83], v[132:135], v[136:139], a[80:83]
  ds_read_b128 v[128:131], v5 offset:2560
  v_cvt_f32_i32 v244, v244
  v_mfma_f32_16x16x32_bf16 a[84:87], v[132:135], v[144:147], a[84:87]
  ds_read_b128 v[84:87], v4 offset:17408
  v_cvt_f32_i32 v245, v245
  v_mfma_f32_16x16x32_bf16 a[88:91], v[132:135], v[152:155], a[88:91]
  ds_read_b128 v[88:91], v4 offset:18432
  v_lshlrev_b32 v188, 16, v250
  v_mfma_f32_16x16x32_bf16 a[92:95], v[132:135], v[160:163], a[92:95]
  ds_read_b128 v[92:95], v4 offset:19456
  v_and_b32 v189, s44, v250
  s_waitcnt lgkmcnt(10)
  v_mfma_f32_16x16x32_bf16 a[96:99], v[112:115], v[136:139], a[96:99]
  ds_read_b128 v[132:135], v5 offset:2816
  v_mfma_f32_16x16x32_bf16 a[100:103], v[112:115], v[144:147], a[100:103]
  ds_read_b128 v[96:99], v4 offset:20480
  v_cvt_pk_bf16_f32 v244, 0, v244
  v_mfma_f32_16x16x32_bf16 a[104:107], v[112:115], v[152:155], a[104:107]
  buffer_load_dwordx4 v8, s[4:7], s40 offen offset:2048 sc1 lds
  v_cvt_pk_bf16_f32 v245, 0, v245
  v_mfma_f32_16x16x32_bf16 a[108:111], v[112:115], v[160:163], a[108:111]
  ds_read_b128 v[100:103], v4 offset:21504
  v_lshlrev_b32 v190, 16, v254
  s_waitcnt lgkmcnt(10)
  v_mfma_f32_16x16x32_bf16 a[112:115], v[116:119], v[136:139], a[112:115]
  s_add_u32 m0, s37, 86016
  v_and_b32 v191, s44, v254
  v_mfma_f32_16x16x32_bf16 a[116:119], v[116:119], v[144:147], a[116:119]
  ds_read_b128 v[104:107], v4 offset:22528
  v_subrev_f32 v244, v188, v244
  v_mfma_f32_16x16x32_bf16 a[120:123], v[116:119], v[152:155], a[120:123]
  v_subrev_f32 v245, v189, v245
  v_mul_f32 v190, s42, v190
  v_mfma_f32_16x16x32_bf16 a[124:127], v[116:119], v[160:163], a[124:127]
  ds_read_b128 v[108:111], v4 offset:23552
  v_mul_f32 v191, s43, v191
  v_mfma_f32_16x16x32_bf16 a[128:131], v[120:123], v[136:139], a[128:131]
  v_cvt_pk_bf16_f32 v244, 0, v244
  v_mfma_f32_16x16x32_bf16 a[132:135], v[120:123], v[144:147], a[132:135]
  v_cvt_pk_bf16_f32 v245, 0, v245
  v_mul_f32 v244, v190, v244
  v_mfma_f32_16x16x32_bf16 a[136:139], v[120:123], v[152:155], a[136:139]
  buffer_load_dwordx4 v9, s[4:7], s40 offen offset:0 sc1 lds
  v_mul_f32 v245, v191, v245
  v_mfma_f32_16x16x32_bf16 a[140:143], v[120:123], v[160:163], a[140:143]
  v_cvt_pk_bf16_f32 v250, v244, v245
  v_cvt_f32_i32 v246, v246
  v_mfma_f32_16x16x32_bf16 a[144:147], v[124:127], v[136:139], a[144:147]
  v_cvt_f32_i32 v247, v247
  v_mfma_f32_16x16x32_bf16 a[148:151], v[124:127], v[144:147], a[148:151]
  v_lshlrev_b32 v188, 16, v251
  v_and_b32 v189, s44, v251
  v_mfma_f32_16x16x32_bf16 a[152:155], v[124:127], v[152:155], a[152:155]
  v_cvt_pk_bf16_f32 v246, 0, v246
  v_cvt_pk_bf16_f32 v247, 0, v247
  v_mfma_f32_16x16x32_bf16 a[156:159], v[124:127], v[160:163], a[156:159]
  v_lshlrev_b32 v190, 16, v255
  v_and_b32 v191, s44, v255
  s_waitcnt lgkmcnt(4)
  v_mfma_f32_16x16x32_bf16 a[160:163], v[128:131], v[136:139], a[160:163]
  buffer_load_dwordx4 v9, s[4:7], s40 offen offset:1024 sc1 lds
  v_subrev_f32 v246, v188, v246
  v_mfma_f32_16x16x32_bf16 a[164:167], v[128:131], v[144:147], a[164:167]
  v_subrev_f32 v247, v189, v247
  v_mfma_f32_16x16x32_bf16 a[168:171], v[128:131], v[152:155], a[168:171]
  v_mul_f32 v190, s42, v190
  v_mul_f32 v191, s43, v191
  v_mfma_f32_16x16x32_bf16 a[172:175], v[128:131], v[160:163], a[172:175]
  v_cvt_pk_bf16_f32 v246, 0, v246
  v_cvt_pk_bf16_f32 v247, 0, v247
  v_mfma_f32_16x16x32_bf16 a[176:179], v[132:135], v[136:139], a[176:179]
  v_mul_f32 v246, v190, v246
  v_mul_f32 v247, v191, v247
  v_mfma_f32_16x16x32_bf16 a[180:183], v[132:135], v[144:147], a[180:183]
  v_cvt_pk_bf16_f32 v251, v246, v247
  v_mfma_f32_16x16x32_bf16 a[184:187], v[132:135], v[152:155], a[184:187]
  buffer_load_dwordx4 v9, s[4:7], s40 offen offset:2048 sc1 lds
  v_mfma_f32_16x16x32_bf16 a[188:191], v[132:135], v[160:163], a[188:191]
  s_mul_i32 s40, s90, 48
  v_mfma_f32_16x16x32_bf16 v[136:139], v[64:67], v[16:19], v[168:171]
  buffer_store_dwordx4 v[248:251], v8, s[4:7], s77 offen offset:1024 sc1
  v_cvt_f32_i32 v224, v224
  v_mfma_f32_16x16x32_bf16 v[136:139], v[68:71], v[20:23], v[136:139]
  ds_read_b128 v[112:115], v5 offset:12288
  v_cvt_f32_i32 v225, v225
  v_mfma_f32_16x16x32_bf16 v[136:139], v[72:75], v[24:27], v[136:139]
  v_lshlrev_b32 v188, 16, v232
  v_and_b32 v189, s44, v232
  v_mfma_f32_16x16x32_bf16 v[136:139], v[76:79], v[28:31], v[136:139]
  ds_read_b128 v[116:119], v5 offset:12544
  v_cvt_pk_bf16_f32 v224, 0, v224
  s_waitcnt lgkmcnt(2)
  v_mfma_f32_16x16x32_bf16 v[136:139], v[80:83], v[32:35], v[136:139]
  buffer_load_dwordx4 v[240:243], v184, s[12:15], s45 offen offset:128 sc0 sc1 nt
  v_cvt_pk_bf16_f32 v225, 0, v225
  v_mfma_f32_16x16x32_bf16 v[136:139], v[84:87], v[36:39], v[136:139]
  ds_read_b128 v[120:123], v5 offset:12800
  v_lshlrev_b32 v190, 16, v236
  v_mfma_f32_16x16x32_bf16 v[140:143], v[88:91], v[16:19], v[168:171]
  v_and_b32 v191, s44, v236
  v_subrev_f32 v224, v188, v224
  v_mfma_f32_16x16x32_bf16 v[140:143], v[92:95], v[20:23], v[140:143]
  ds_read_b128 v[124:127], v5 offset:13056
  v_subrev_f32 v225, v189, v225
  v_mfma_f32_16x16x32_bf16 v[140:143], v[96:99], v[24:27], v[140:143]
  buffer_load_dwordx4 v[244:247], v184, s[12:15], s45 offen offset:144 sc0 sc1 nt
  v_mfma_f32_16x16x32_bf16 v[140:143], v[100:103], v[28:31], v[140:143]
  ds_read_b128 v[128:131], v5 offset:13312
  v_mul_f32 v190, s42, v190
  v_mfma_f32_16x16x32_bf16 v[140:143], v[104:107], v[32:35], v[140:143]
  v_mul_f32 v191, s43, v191
  v_cvt_pk_bf16_f32 v224, 0, v224
  v_mfma_f32_16x16x32_bf16 v[140:143], v[108:111], v[36:39], v[140:143]
  ds_read_b128 v[132:135], v5 offset:13568
  v_cvt_pk_bf16_f32 v225, 0, v225
  v_mfma_f32_16x16x32_bf16 v[144:147], v[64:67], v[40:43], v[172:175]
  v_exp_f32 v136, v136
  v_mfma_f32_16x16x32_bf16 v[144:147], v[68:71], v[44:47], v[144:147]
  v_exp_f32 v137, v137
  buffer_load_dwordx4 v[248:251], v185, s[24:27], s46 offen offset:64
  v_mfma_f32_16x16x32_bf16 v[144:147], v[72:75], v[48:51], v[144:147]
  v_exp_f32 v138, v138
  v_mfma_f32_16x16x32_bf16 v[144:147], v[76:79], v[52:55], v[144:147]
  v_exp_f32 v139, v139
  v_mfma_f32_16x16x32_bf16 v[144:147], v[80:83], v[56:59], v[144:147]
  v_cvt_pk_bf16_f32 v136, v136, v137
  v_cvt_pk_bf16_f32 v137, v138, v139
  v_mfma_f32_16x16x32_bf16 v[144:147], v[84:87], v[60:63], v[144:147]
  v_exp_f32 v140, v140
  v_mfma_f32_16x16x32_bf16 v[148:151], v[88:91], v[40:43], v[172:175]
  v_exp_f32 v141, v141
  buffer_load_dwordx4 v[252:255], v185, s[20:23], s46 offen offset:64
  v_mfma_f32_16x16x32_bf16 v[148:151], v[92:95], v[44:47], v[148:151]
  v_exp_f32 v142, v142
  v_mfma_f32_16x16x32_bf16 v[148:151], v[96:99], v[48:51], v[148:151]
  v_exp_f32 v143, v143
  v_mfma_f32_16x16x32_bf16 v[148:151], v[100:103], v[52:55], v[148:151]
  v_cvt_pk_bf16_f32 v138, v140, v141
  v_cvt_pk_bf16_f32 v139, v142, v143
  v_mfma_f32_16x16x32_bf16 v[148:151], v[104:107], v[56:59], v[148:151]
  s_add_u32 s3, s3, 512
  v_mul_f32 v224, v190, v224
  v_mfma_f32_16x16x32_bf16 v[148:151], v[108:111], v[60:63], v[148:151]
  s_xor_b32 s90, s3, s76
  v_mul_f32 v225, v191, v225
  v_mfma_f32_16x16x32_bf16 v[152:155], v[64:67], a[208:211], v[176:179]
  v_exp_f32 v144, v144
  v_mfma_f32_16x16x32_bf16 v[152:155], v[68:71], a[212:215], v[152:155]
  v_exp_f32 v145, v145
  v_mfma_f32_16x16x32_bf16 v[152:155], v[72:75], a[216:219], v[152:155]
  v_exp_f32 v146, v146
  v_mfma_f32_16x16x32_bf16 v[152:155], v[76:79], a[220:223], v[152:155]
  v_exp_f32 v147, v147
  v_mfma_f32_16x16x32_bf16 v[152:155], v[80:83], a[224:227], v[152:155]
  v_cvt_pk_bf16_f32 v144, v144, v145
  v_cvt_pk_bf16_f32 v145, v146, v147
  v_mfma_f32_16x16x32_bf16 v[152:155], v[84:87], a[228:231], v[152:155]
  v_exp_f32 v148, v148
  v_mfma_f32_16x16x32_bf16 v[156:159], v[88:91], a[208:211], v[176:179]
  v_exp_f32 v149, v149
  v_mfma_f32_16x16x32_bf16 v[156:159], v[92:95], a[212:215], v[156:159]
  v_exp_f32 v150, v150
  v_mfma_f32_16x16x32_bf16 v[156:159], v[96:99], a[216:219], v[156:159]
  v_exp_f32 v151, v151
  v_mfma_f32_16x16x32_bf16 v[156:159], v[100:103], a[220:223], v[156:159]
  v_cvt_pk_bf16_f32 v146, v148, v149
  v_cvt_pk_bf16_f32 v147, v150, v151
  v_mfma_f32_16x16x32_bf16 v[156:159], v[104:107], a[224:227], v[156:159]
  s_and_b32 s90, s90, 0x7e00
  v_cvt_pk_bf16_f32 v232, v224, v225
  v_mfma_f32_16x16x32_bf16 v[156:159], v[108:111], a[228:231], v[156:159]
  v_cvt_f32_i32 v226, v226
  v_cvt_f32_i32 v227, v227
  v_mfma_f32_16x16x32_bf16 v[160:163], v[64:67], a[232:235], v[180:183]
  v_exp_f32 v152, v152
  v_mfma_f32_16x16x32_bf16 v[160:163], v[68:71], a[236:239], v[160:163]
  v_exp_f32 v153, v153
  v_mfma_f32_16x16x32_bf16 v[160:163], v[72:75], a[240:243], v[160:163]
  v_exp_f32 v154, v154
  v_mfma_f32_16x16x32_bf16 v[160:163], v[76:79], a[244:247], v[160:163]
  v_exp_f32 v155, v155
  v_mfma_f32_16x16x32_bf16 v[160:163], v[80:83], a[248:251], v[160:163]
  v_cvt_pk_bf16_f32 v152, v152, v153
  v_cvt_pk_bf16_f32 v153, v154, v155
  v_mfma_f32_16x16x32_bf16 v[160:163], v[84:87], a[252:255], v[160:163]
  v_exp_f32 v156, v156
  v_mfma_f32_16x16x32_bf16 v[164:167], v[88:91], a[232:235], v[180:183]
  v_exp_f32 v157, v157
  v_mfma_f32_16x16x32_bf16 v[164:167], v[92:95], a[236:239], v[164:167]
  v_exp_f32 v158, v158
  v_mfma_f32_16x16x32_bf16 v[164:167], v[96:99], a[240:243], v[164:167]
  v_exp_f32 v159, v159
  v_mfma_f32_16x16x32_bf16 v[164:167], v[100:103], a[244:247], v[164:167]
  v_cvt_pk_bf16_f32 v154, v156, v157
  v_cvt_pk_bf16_f32 v155, v158, v159
  v_mfma_f32_16x16x32_bf16 v[164:167], v[104:107], a[248:251], v[164:167]
  v_lshlrev_b32 v188, 16, v233
  s_waitcnt lgkmcnt(0)
  v_mfma_f32_16x16x32_bf16 v[164:167], v[108:111], a[252:255], v[164:167]
  v_and_b32 v189, s44, v233
  v_cvt_pk_bf16_f32 v226, 0, v226
  v_mfma_f32_16x16x32_bf16 a[0:3], v[112:115], v[136:139], a[0:3]
  v_exp_f32 v160, v160
  v_mfma_f32_16x16x32_bf16 a[4:7], v[112:115], v[144:147], a[4:7]
  v_exp_f32 v161, v161
  v_mfma_f32_16x16x32_bf16 a[8:11], v[112:115], v[152:155], a[8:11]
  v_exp_f32 v162, v162
  v_mfma_f32_16x16x32_bf16 a[16:19], v[116:119], v[136:139], a[16:19]
  v_exp_f32 v163, v163
  v_mfma_f32_16x16x32_bf16 a[20:23], v[116:119], v[144:147], a[20:23]
  v_cvt_pk_bf16_f32 v160, v160, v161
  v_cvt_pk_bf16_f32 v161, v162, v163
  v_mfma_f32_16x16x32_bf16 a[24:27], v[116:119], v[152:155], a[24:27]
  v_exp_f32 v164, v164
  v_mfma_f32_16x16x32_bf16 a[32:35], v[120:123], v[136:139], a[32:35]
  v_exp_f32 v165, v165
  v_mfma_f32_16x16x32_bf16 a[36:39], v[120:123], v[144:147], a[36:39]
  v_exp_f32 v166, v166
  v_mfma_f32_16x16x32_bf16 a[40:43], v[120:123], v[152:155], a[40:43]
  v_exp_f32 v167, v167
  v_mfma_f32_16x16x32_bf16 a[48:51], v[124:127], v[136:139], a[48:51]
  v_cvt_pk_bf16_f32 v162, v164, v165
  v_cvt_pk_bf16_f32 v163, v166, v167
  v_mfma_f32_16x16x32_bf16 a[52:55], v[124:127], v[144:147], a[52:55]
  s_add_u32 m0, s37, 0
  v_cvt_pk_bf16_f32 v227, 0, v227
  v_mfma_f32_16x16x32_bf16 a[56:59], v[124:127], v[152:155], a[56:59]
  s_waitcnt vmcnt(12)
  s_barrier
  v_mfma_f32_16x16x32_bf16 a[192:195], v[12:15], v[136:139], a[192:195]
  buffer_load_dwordx2 v[6:7], v1, s[4:7], s90 offen sc1
  v_mfma_f32_16x16x32_bf16 a[196:199], v[12:15], v[144:147], a[196:199]
  ds_read_b128 v[64:67], v4 offset:24576
  v_lshlrev_b32 v190, 16, v237
  v_mfma_f32_16x16x32_bf16 a[200:203], v[12:15], v[152:155], a[200:203]
  buffer_load_dwordx4 v8, s[4:7], s48 offen offset:0 sc1 lds
  v_and_b32 v191, s44, v237
  v_mfma_f32_16x16x32_bf16 a[12:15], v[112:115], v[160:163], a[12:15]
  ds_read_b128 v[68:71], v4 offset:25600
  v_subrev_f32 v226, v188, v226
  v_mfma_f32_16x16x32_bf16 a[28:31], v[116:119], v[160:163], a[28:31]
  ds_read_b128 v[112:115], v5 offset:13824
  v_subrev_f32 v227, v189, v227
  v_mfma_f32_16x16x32_bf16 a[44:47], v[120:123], v[160:163], a[44:47]
  ds_read_b128 v[116:119], v5 offset:14080
  v_mul_f32 v190, s42, v190
  v_mfma_f32_16x16x32_bf16 a[60:63], v[124:127], v[160:163], a[60:63]
  ds_read_b128 v[120:123], v5 offset:14336
  v_mul_f32 v191, s43, v191
  v_mfma_f32_16x16x32_bf16 a[204:207], v[12:15], v[160:163], a[204:207]
  ds_read_b128 v[124:127], v5 offset:14592
  v_cvt_pk_bf16_f32 v226, 0, v226
  v_mfma_f32_16x16x32_bf16 a[64:67], v[128:131], v[136:139], a[64:67]
  ds_read_b128 v[72:75], v4 offset:26624
  v_mfma_f32_16x16x32_bf16 a[68:71], v[128:131], v[144:147], a[68:71]
  ds_read_b128 v[76:79], v4 offset:27648
  v_cvt_pk_bf16_f32 v227, 0, v227
  v_mfma_f32_16x16x32_bf16 a[72:75], v[128:131], v[152:155], a[72:75]
  buffer_load_dwordx4 v8, s[4:7], s48 offen offset:1024 sc1 lds
  v_mul_f32 v226, v190, v226
  v_mfma_f32_16x16x32_bf16 a[76:79], v[128:131], v[160:163], a[76:79]
  ds_read_b128 v[80:83], v4 offset:28672
  v_mul_f32 v227, v191, v227
  v_mfma_f32_16x16x32_bf16 a[80:83], v[132:135], v[136:139], a[80:83]
  ds_read_b128 v[128:131], v5 offset:14848
  v_cvt_pk_bf16_f32 v233, v226, v227
  v_mfma_f32_16x16x32_bf16 a[84:87], v[132:135], v[144:147], a[84:87]
  ds_read_b128 v[84:87], v4 offset:29696
  v_cvt_f32_i32 v228, v228
  v_mfma_f32_16x16x32_bf16 a[88:91], v[132:135], v[152:155], a[88:91]
  ds_read_b128 v[88:91], v4 offset:30720
  v_cvt_f32_i32 v229, v229
  v_mfma_f32_16x16x32_bf16 a[92:95], v[132:135], v[160:163], a[92:95]
  ds_read_b128 v[92:95], v4 offset:31744
  v_lshlrev_b32 v188, 16, v234
  s_waitcnt lgkmcnt(10)
  v_mfma_f32_16x16x32_bf16 a[96:99], v[112:115], v[136:139], a[96:99]
  ds_read_b128 v[132:135], v5 offset:15104
  v_and_b32 v189, s44, v234
  v_mfma_f32_16x16x32_bf16 a[100:103], v[112:115], v[144:147], a[100:103]
  ds_read_b128 v[96:99], v4 offset:32768
  v_cvt_pk_bf16_f32 v228, 0, v228
  v_mfma_f32_16x16x32_bf16 a[104:107], v[112:115], v[152:155], a[104:107]
  buffer_load_dwordx4 v8, s[4:7], s48 offen offset:2048 sc1 lds
  v_mfma_f32_16x16x32_bf16 a[108:111], v[112:115], v[160:163], a[108:111]
  ds_read_b128 v[100:103], v4 offset:33792
  v_cvt_pk_bf16_f32 v229, 0, v229
  s_waitcnt lgkmcnt(10)
  v_mfma_f32_16x16x32_bf16 a[112:115], v[116:119], v[136:139], a[112:115]
  s_add_u32 m0, s37, 49152
  v_lshlrev_b32 v190, 16, v238
  v_mfma_f32_16x16x32_bf16 a[116:119], v[116:119], v[144:147], a[116:119]
  ds_read_b128 v[104:107], v4 offset:34816
  v_and_b32 v191, s44, v238
  v_mfma_f32_16x16x32_bf16 a[120:123], v[116:119], v[152:155], a[120:123]
  v_subrev_f32 v228, v188, v228
  v_subrev_f32 v229, v189, v229
  v_mfma_f32_16x16x32_bf16 a[124:127], v[116:119], v[160:163], a[124:127]
  ds_read_b128 v[108:111], v4 offset:35840
  v_mul_f32 v190, s42, v190
  v_mfma_f32_16x16x32_bf16 a[128:131], v[120:123], v[136:139], a[128:131]
  v_mul_f32 v191, s43, v191
  v_cvt_pk_bf16_f32 v228, 0, v228
  v_mfma_f32_16x16x32_bf16 a[132:135], v[120:123], v[144:147], a[132:135]
  v_cvt_pk_bf16_f32 v229, 0, v229
  v_mul_f32 v228, v190, v228
  v_mfma_f32_16x16x32_bf16 a[136:139], v[120:123], v[152:155], a[136:139]
  buffer_load_dwordx4 v9, s[4:7], s48 offen offset:0 sc1 lds
  v_mfma_f32_16x16x32_bf16 a[140:143], v[120:123], v[160:163], a[140:143]
  v_mul_f32 v229, v191, v229
  v_cvt_pk_bf16_f32 v234, v228, v229
  v_mfma_f32_16x16x32_bf16 a[144:147], v[124:127], v[136:139], a[144:147]
  v_cvt_f32_i32 v230, v230
  v_cvt_f32_i32 v231, v231
  v_mfma_f32_16x16x32_bf16 a[148:151], v[124:127], v[144:147], a[148:151]
  v_lshlrev_b32 v188, 16, v235
  v_and_b32 v189, s44, v235
  v_mfma_f32_16x16x32_bf16 a[152:155], v[124:127], v[152:155], a[152:155]
  v_cvt_pk_bf16_f32 v230, 0, v230
  v_cvt_pk_bf16_f32 v231, 0, v231
  v_mfma_f32_16x16x32_bf16 a[156:159], v[124:127], v[160:163], a[156:159]
  v_lshlrev_b32 v190, 16, v239
  v_and_b32 v191, s44, v239
  s_waitcnt lgkmcnt(4)
  v_mfma_f32_16x16x32_bf16 a[160:163], v[128:131], v[136:139], a[160:163]
  buffer_load_dwordx4 v9, s[4:7], s48 offen offset:1024 sc1 lds
  v_mfma_f32_16x16x32_bf16 a[164:167], v[128:131], v[144:147], a[164:167]
  v_subrev_f32 v230, v188, v230
  v_subrev_f32 v231, v189, v231
  v_mfma_f32_16x16x32_bf16 a[168:171], v[128:131], v[152:155], a[168:171]
  v_mul_f32 v190, s42, v190
  v_mul_f32 v191, s43, v191
  v_mfma_f32_16x16x32_bf16 a[172:175], v[128:131], v[160:163], a[172:175]
  v_cvt_pk_bf16_f32 v230, 0, v230
  v_cvt_pk_bf16_f32 v231, 0, v231
  v_mfma_f32_16x16x32_bf16 a[176:179], v[132:135], v[136:139], a[176:179]
  v_mul_f32 v230, v190, v230
  v_mul_f32 v231, v191, v231
  v_mfma_f32_16x16x32_bf16 a[180:183], v[132:135], v[144:147], a[180:183]
  v_cvt_pk_bf16_f32 v235, v230, v231
  v_mfma_f32_16x16x32_bf16 a[184:187], v[132:135], v[152:155], a[184:187]
  buffer_load_dwordx4 v9, s[4:7], s48 offen offset:2048 sc1 lds
  v_mfma_f32_16x16x32_bf16 a[188:191], v[132:135], v[160:163], a[188:191]
  s_mul_i32 s48, s90, 48
  v_mfma_f32_16x16x32_bf16 v[136:139], v[64:67], v[16:19], v[168:171]
  buffer_store_dwordx4 v[232:235], v8, s[4:7], s77 offen offset:0 sc1
  v_readlane_b32 s60, v10, 0
  v_mfma_f32_16x16x32_bf16 v[136:139], v[68:71], v[20:23], v[136:139]
  ds_read_b128 v[112:115], v5 offset:24576
  v_readlane_b32 s61, v10, 1
  v_mfma_f32_16x16x32_bf16 v[136:139], v[72:75], v[24:27], v[136:139]
  v_readlane_b32 s62, v10, 2
  v_readlane_b32 s63, v10, 3
  v_mfma_f32_16x16x32_bf16 v[136:139], v[76:79], v[28:31], v[136:139]
  ds_read_b128 v[116:119], v5 offset:24832
  v_readlane_b32 s64, v10, 4
  s_waitcnt lgkmcnt(2)
  v_mfma_f32_16x16x32_bf16 v[136:139], v[80:83], v[32:35], v[136:139]
  buffer_load_dwordx4 v[224:227], v184, s[12:15], s77 offen offset:256 sc0 sc1 nt
  v_readlane_b32 s65, v10, 5
  v_mfma_f32_16x16x32_bf16 v[136:139], v[84:87], v[36:39], v[136:139]
  ds_read_b128 v[120:123], v5 offset:25088
  v_readlane_b32 s66, v10, 6
  v_mfma_f32_16x16x32_bf16 v[140:143], v[88:91], v[16:19], v[168:171]
  v_readlane_b32 s67, v10, 7
  v_readlane_b32 s68, v11, 0
  v_mfma_f32_16x16x32_bf16 v[140:143], v[92:95], v[20:23], v[140:143]
  ds_read_b128 v[124:127], v5 offset:25344
  v_readlane_b32 s69, v11, 1
  v_mfma_f32_16x16x32_bf16 v[140:143], v[96:99], v[24:27], v[140:143]
  buffer_load_dwordx4 v[228:231], v184, s[12:15], s77 offen offset:272 sc0 sc1 nt
  v_readlane_b32 s70, v11, 2
  v_mfma_f32_16x16x32_bf16 v[140:143], v[100:103], v[28:31], v[140:143]
  ds_read_b128 v[128:131], v5 offset:25600
  v_readlane_b32 s71, v11, 3
  v_mfma_f32_16x16x32_bf16 v[140:143], v[104:107], v[32:35], v[140:143]
  v_readlane_b32 s72, v11, 4
  v_readlane_b32 s73, v11, 5
  v_mfma_f32_16x16x32_bf16 v[140:143], v[108:111], v[36:39], v[140:143]
  ds_read_b128 v[132:135], v5 offset:25856
  v_readlane_b32 s74, v11, 6
  v_mfma_f32_16x16x32_bf16 v[144:147], v[64:67], v[40:43], v[172:175]
  v_exp_f32 v136, v136
  v_mfma_f32_16x16x32_bf16 v[144:147], v[68:71], v[44:47], v[144:147]
  v_exp_f32 v137, v137
  buffer_load_dwordx4 v[232:235], v185, s[24:27], s78 offen offset:128
  v_mfma_f32_16x16x32_bf16 v[144:147], v[72:75], v[48:51], v[144:147]
  v_exp_f32 v138, v138
  v_mfma_f32_16x16x32_bf16 v[144:147], v[76:79], v[52:55], v[144:147]
  v_exp_f32 v139, v139
  v_mfma_f32_16x16x32_bf16 v[144:147], v[80:83], v[56:59], v[144:147]
  v_cvt_pk_bf16_f32 v136, v136, v137
  v_cvt_pk_bf16_f32 v137, v138, v139
  v_mfma_f32_16x16x32_bf16 v[144:147], v[84:87], v[60:63], v[144:147]
  v_exp_f32 v140, v140
  v_mfma_f32_16x16x32_bf16 v[148:151], v[88:91], v[40:43], v[172:175]
  v_exp_f32 v141, v141
  buffer_load_dwordx4 v[236:239], v185, s[20:23], s78 offen offset:128
  v_mfma_f32_16x16x32_bf16 v[148:151], v[92:95], v[44:47], v[148:151]
  v_exp_f32 v142, v142
  v_mfma_f32_16x16x32_bf16 v[148:151], v[96:99], v[48:51], v[148:151]
  v_exp_f32 v143, v143
  v_mfma_f32_16x16x32_bf16 v[148:151], v[100:103], v[52:55], v[148:151]
  v_cvt_pk_bf16_f32 v138, v140, v141
  v_cvt_pk_bf16_f32 v139, v142, v143
  v_mfma_f32_16x16x32_bf16 v[148:151], v[104:107], v[56:59], v[148:151]
  s_add_u32 s3, s3, 512
  v_readlane_b32 s75, v11, 7
  v_mfma_f32_16x16x32_bf16 v[148:151], v[108:111], v[60:63], v[148:151]
  s_xor_b32 s90, s3, s76
  v_cvt_f32_i32 v199, v198
  v_mfma_f32_16x16x32_bf16 v[152:155], v[64:67], a[208:211], v[176:179]
  v_exp_f32 v144, v144
  v_mfma_f32_16x16x32_bf16 v[152:155], v[68:71], a[212:215], v[152:155]
  v_exp_f32 v145, v145
  v_mfma_f32_16x16x32_bf16 v[152:155], v[72:75], a[216:219], v[152:155]
  v_exp_f32 v146, v146
  v_mfma_f32_16x16x32_bf16 v[152:155], v[76:79], a[220:223], v[152:155]
  v_exp_f32 v147, v147
  v_mfma_f32_16x16x32_bf16 v[152:155], v[80:83], a[224:227], v[152:155]
  v_cvt_pk_bf16_f32 v144, v144, v145
  v_cvt_pk_bf16_f32 v145, v146, v147
  v_mfma_f32_16x16x32_bf16 v[152:155], v[84:87], a[228:231], v[152:155]
  v_exp_f32 v148, v148
  v_mfma_f32_16x16x32_bf16 v[156:159], v[88:91], a[208:211], v[176:179]
  v_exp_f32 v149, v149
  v_mfma_f32_16x16x32_bf16 v[156:159], v[92:95], a[212:215], v[156:159]
  v_exp_f32 v150, v150
  v_mfma_f32_16x16x32_bf16 v[156:159], v[96:99], a[216:219], v[156:159]
  v_exp_f32 v151, v151
  v_mfma_f32_16x16x32_bf16 v[156:159], v[100:103], a[220:223], v[156:159]
  v_cvt_pk_bf16_f32 v146, v148, v149
  v_cvt_pk_bf16_f32 v147, v150, v151
  v_mfma_f32_16x16x32_bf16 v[156:159], v[104:107], a[224:227], v[156:159]
  s_and_b32 s90, s90, 0x7e00
  v_cvt_f32_i32 v198, v194
  v_mfma_f32_16x16x32_bf16 v[156:159], v[108:111], a[228:231], v[156:159]
  v_cvt_f32_i32 v194, v193
  v_cvt_f32_i32 v195, v197
  v_mfma_f32_16x16x32_bf16 v[160:163], v[64:67], a[232:235], v[180:183]
  v_exp_f32 v152, v152
  v_mfma_f32_16x16x32_bf16 v[160:163], v[68:71], a[236:239], v[160:163]
  v_exp_f32 v153, v153
  v_mfma_f32_16x16x32_bf16 v[160:163], v[72:75], a[240:243], v[160:163]
  v_exp_f32 v154, v154
  v_mfma_f32_16x16x32_bf16 v[160:163], v[76:79], a[244:247], v[160:163]
  v_exp_f32 v155, v155
  v_mfma_f32_16x16x32_bf16 v[160:163], v[80:83], a[248:251], v[160:163]
  v_cvt_pk_bf16_f32 v152, v152, v153
  v_cvt_pk_bf16_f32 v153, v154, v155
  v_mfma_f32_16x16x32_bf16 v[160:163], v[84:87], a[252:255], v[160:163]
  v_exp_f32 v156, v156
  v_mfma_f32_16x16x32_bf16 v[164:167], v[88:91], a[232:235], v[180:183]
  v_exp_f32 v157, v157
  v_mfma_f32_16x16x32_bf16 v[164:167], v[92:95], a[236:239], v[164:167]
  v_exp_f32 v158, v158
  v_mfma_f32_16x16x32_bf16 v[164:167], v[96:99], a[240:243], v[164:167]
  v_exp_f32 v159, v159
  v_mfma_f32_16x16x32_bf16 v[164:167], v[100:103], a[244:247], v[164:167]
  v_cvt_pk_bf16_f32 v154, v156, v157
  v_cvt_pk_bf16_f32 v155, v158, v159
  v_mfma_f32_16x16x32_bf16 v[164:167], v[104:107], a[248:251], v[164:167]
  v_cvt_f32_i32 v193, v196
  v_cvt_f32_i32 v192, v192
  s_waitcnt lgkmcnt(0)
  v_mfma_f32_16x16x32_bf16 v[164:167], v[108:111], a[252:255], v[164:167]
  v_cvt_pk_bf16_f32 v198, 0, v198
  v_cvt_pk_bf16_f32 v199, 0, v199
  v_mfma_f32_16x16x32_bf16 a[0:3], v[112:115], v[136:139], a[0:3]
  v_exp_f32 v160, v160
  v_mfma_f32_16x16x32_bf16 a[4:7], v[112:115], v[144:147], a[4:7]
  v_exp_f32 v161, v161
  v_mfma_f32_16x16x32_bf16 a[8:11], v[112:115], v[152:155], a[8:11]
  v_exp_f32 v162, v162
  v_mfma_f32_16x16x32_bf16 a[16:19], v[116:119], v[136:139], a[16:19]
  v_exp_f32 v163, v163
  v_mfma_f32_16x16x32_bf16 a[20:23], v[116:119], v[144:147], a[20:23]
  v_cvt_pk_bf16_f32 v160, v160, v161
  v_cvt_pk_bf16_f32 v161, v162, v163
  v_mfma_f32_16x16x32_bf16 a[24:27], v[116:119], v[152:155], a[24:27]
  v_exp_f32 v164, v164
  v_mfma_f32_16x16x32_bf16 a[32:35], v[120:123], v[136:139], a[32:35]
  v_exp_f32 v165, v165
  v_mfma_f32_16x16x32_bf16 a[36:39], v[120:123], v[144:147], a[36:39]
  v_exp_f32 v166, v166
  v_mfma_f32_16x16x32_bf16 a[40:43], v[120:123], v[152:155], a[40:43]
  v_exp_f32 v167, v167
  v_mfma_f32_16x16x32_bf16 a[48:51], v[124:127], v[136:139], a[48:51]
  v_cvt_pk_bf16_f32 v162, v164, v165
  v_cvt_pk_bf16_f32 v163, v166, v167
  v_mfma_f32_16x16x32_bf16 a[52:55], v[124:127], v[144:147], a[52:55]
  s_waitcnt vmcnt(23)
  v_cmp_eq_u64 vcc, s[88:89], v[2:3]
  s_add_u32 m0, s37, 12288
  v_mfma_f32_16x16x32_bf16 a[56:59], v[124:127], v[152:155], a[56:59]
  s_waitcnt vmcnt(17)
  s_barrier
  v_mfma_f32_16x16x32_bf16 a[192:195], v[12:15], v[136:139], a[192:195]
  s_cbranch_vccz L_slow14
L_ret14:
  buffer_load_dwordx2 v[2:3], v1, s[4:7], s90 offen sc1
  v_mfma_f32_16x16x32_bf16 a[196:199], v[12:15], v[144:147], a[196:199]
  ds_read_b128 v[64:67], v4 offset:36864
  v_cvt_pk_bf16_f32 v194, 0, v194
  v_mfma_f32_16x16x32_bf16 a[200:203], v[12:15], v[152:155], a[200:203]
  buffer_load_dwordx4 v8, s[4:7], s40 offen offset:0 sc1 lds
  v_cvt_pk_bf16_f32 v195, 0, v195
  v_mfma_f32_16x16x32_bf16 a[12:15], v[112:115], v[160:163], a[12:15]
  ds_read_b128 v[68:71], v4 offset:37888
  v_cvt_pk_bf16_f32 v192, 0, v192
  v_mfma_f32_16x16x32_bf16 a[28:31], v[116:119], v[160:163], a[28:31]
  ds_read_b128 v[112:115], v5 offset:26112
  v_cvt_pk_bf16_f32 v193, 0, v193
  v_mfma_f32_16x16x32_bf16 a[44:47], v[120:123], v[160:163], a[44:47]
  ds_read_b128 v[116:119], v5 offset:26368
  v_subrev_f32 v198, s60, v198
  v_mfma_f32_16x16x32_bf16 a[60:63], v[124:127], v[160:163], a[60:63]
  ds_read_b128 v[120:123], v5 offset:26624
  v_subrev_f32 v199, s61, v199
  v_mfma_f32_16x16x32_bf16 a[204:207], v[12:15], v[160:163], a[204:207]
  ds_read_b128 v[124:127], v5 offset:26880
  v_mfma_f32_16x16x32_bf16 a[64:67], v[128:131], v[136:139], a[64:67]
  ds_read_b128 v[72:75], v4 offset:38912
  v_subrev_f32 v194, s60, v194
  v_mfma_f32_16x16x32_bf16 a[68:71], v[128:131], v[144:147], a[68:71]
  ds_read_b128 v[76:79], v4 offset:39936
  v_subrev_f32 v195, s61, v195
  v_mfma_f32_16x16x32_bf16 a[72:75], v[128:131], v[152:155], a[72:75]
  buffer_load_dwordx4 v8, s[4:7], s40 offen offset:1024 sc1 lds
  v_subrev_f32 v192, s60, v192
  v_mfma_f32_16x16x32_bf16 a[76:79], v[128:131], v[160:163], a[76:79]
  ds_read_b128 v[80:83], v4 offset:40960
  v_subrev_f32 v193, s61, v193
  v_mfma_f32_16x16x32_bf16 a[80:83], v[132:135], v[136:139], a[80:83]
  ds_read_b128 v[128:131], v5 offset:27136
  v_cvt_pk_bf16_f32 v198, 0, v198
  v_mfma_f32_16x16x32_bf16 a[84:87], v[132:135], v[144:147], a[84:87]
  ds_read_b128 v[84:87], v4 offset:41984
  v_cvt_pk_bf16_f32 v199, 0, v199
  v_mfma_f32_16x16x32_bf16 a[88:91], v[132:135], v[152:155], a[88:91]
  ds_read_b128 v[88:91], v4 offset:43008
  v_cvt_pk_bf16_f32 v194, 0, v194
  v_mfma_f32_16x16x32_bf16 a[92:95], v[132:135], v[160:163], a[92:95]
  ds_read_b128 v[92:95], v4 offset:44032
  v_cvt_pk_bf16_f32 v195, 0, v195
  s_waitcnt lgkmcnt(10)
  v_mfma_f32_16x16x32_bf16 a[96:99], v[112:115], v[136:139], a[96:99]
  ds_read_b128 v[132:135], v5 offset:27392
  v_cvt_pk_bf16_f32 v192, 0, v192
  v_mfma_f32_16x16x32_bf16 a[100:103], v[112:115], v[144:147], a[100:103]
  ds_read_b128 v[96:99], v4 offset:45056
  v_cvt_pk_bf16_f32 v193, 0, v193
  v_mfma_f32_16x16x32_bf16 a[104:107], v[112:115], v[152:155], a[104:107]
  buffer_load_dwordx4 v8, s[4:7], s40 offen offset:2048 sc1 lds
  v_mul_f32 v198, s68, v198
  v_mfma_f32_16x16x32_bf16 a[108:111], v[112:115], v[160:163], a[108:111]
  ds_read_b128 v[100:103], v4 offset:46080
  v_mul_f32 v199, s69, v199
  s_waitcnt lgkmcnt(10)
  v_mfma_f32_16x16x32_bf16 a[112:115], v[116:119], v[136:139], a[112:115]
  s_add_u32 m0, s37, 61440
  v_mul_f32 v194, s68, v194
  v_mfma_f32_16x16x32_bf16 a[116:119], v[116:119], v[144:147], a[116:119]
  ds_read_b128 v[104:107], v4 offset:47104
  v_mul_f32 v195, s69, v195
  v_mfma_f32_16x16x32_bf16 a[120:123], v[116:119], v[152:155], a[120:123]
  v_mul_f32 v192, s68, v192
  v_mul_f32 v193, s69, v193
  v_mfma_f32_16x16x32_bf16 a[124:127], v[116:119], v[160:163], a[124:127]
  ds_read_b128 v[108:111], v4 offset:48128
  v_cvt_pk_bf16_f32 v188, v198, v199
  v_mfma_f32_16x16x32_bf16 a[128:131], v[120:123], v[136:139], a[128:131]
  v_cvt_pk_bf16_f32 v196, v194, v195
  v_cvt_pk_bf16_f32 v192, v192, v193
  v_mfma_f32_16x16x32_bf16 a[132:135], v[120:123], v[144:147], a[132:135]
  v_cvt_f32_i32 v207, v206
  v_cvt_f32_i32 v206, v202
  v_mfma_f32_16x16x32_bf16 a[136:139], v[120:123], v[152:155], a[136:139]
  buffer_load_dwordx4 v9, s[4:7], s40 offen offset:0 sc1 lds
  v_cvt_f32_i32 v202, v201
  v_mfma_f32_16x16x32_bf16 a[140:143], v[120:123], v[160:163], a[140:143]
  v_cvt_f32_i32 v203, v205
  v_cvt_f32_i32 v201, v204
  v_mfma_f32_16x16x32_bf16 a[144:147], v[124:127], v[136:139], a[144:147]
  v_cvt_f32_i32 v200, v200
  v_cvt_pk_bf16_f32 v206, 0, v206
  v_mfma_f32_16x16x32_bf16 a[148:151], v[124:127], v[144:147], a[148:151]
  v_cvt_pk_bf16_f32 v207, 0, v207
  v_cvt_pk_bf16_f32 v202, 0, v202
  v_mfma_f32_16x16x32_bf16 a[152:155], v[124:127], v[152:155], a[152:155]
  v_cvt_pk_bf16_f32 v203, 0, v203
  v_cvt_pk_bf16_f32 v200, 0, v200
  v_mfma_f32_16x16x32_bf16 a[156:159], v[124:127], v[160:163], a[156:159]
  v_cvt_pk_bf16_f32 v201, 0, v201
  s_waitcnt lgkmcnt(4)
  v_mfma_f32_16x16x32_bf16 a[160:163], v[128:131], v[136:139], a[160:163]
  buffer_load_dwordx4 v9, s[4:7], s40 offen offset:1024 sc1 lds
  v_subrev_f32 v206, s62, v206
  v_mfma_f32_16x16x32_bf16 a[164:167], v[128:131], v[144:147], a[164:167]
  v_subrev_f32 v207, s63, v207
  v_subrev_f32 v202, s62, v202
  v_mfma_f32_16x16x32_bf16 a[168:171], v[128:131], v[152:155], a[168:171]
  v_subrev_f32 v203, s63, v203
  v_subrev_f32 v200, s62, v200
  v_mfma_f32_16x16x32_bf16 a[172:175], v[128:131], v[160:163], a[172:175]
  v_subrev_f32 v201, s63, v201
  v_cvt_pk_bf16_f32 v206, 0, v206
  v_mfma_f32_16x16x32_bf16 a[176:179], v[132:135], v[136:139], a[176:179]
  v_cvt_pk_bf16_f32 v207, 0, v207
  v_cvt_pk_bf16_f32 v202, 0, v202
  v_mfma_f32_16x16x32_bf16 a[180:183], v[132:135], v[144:147], a[180:183]
  v_cvt_pk_bf16_f32 v203, 0, v203
  v_cvt_pk_bf16_f32 v200, 0, v200
  v_mfma_f32_16x16x32_bf16 a[184:187], v[132:135], v[152:155], a[184:187]
  buffer_load_dwordx4 v9, s[4:7], s40 offen offset:2048 sc1 lds
  v_cvt_pk_bf16_f32 v201, 0, v201
  v_mfma_f32_16x16x32_bf16 a[188:191], v[132:135], v[160:163], a[188:191]
  s_mul_i32 s40, s90, 48
  v_mul_f32 v206, s70, v206
  v_mfma_f32_16x16x32_bf16 v[136:139], v[64:67], v[16:19], v[168:171]
  v_mul_f32 v207, s71, v207
  v_mul_f32 v202, s70, v202
  v_mfma_f32_16x16x32_bf16 v[136:139], v[68:71], v[20:23], v[136:139]
  ds_read_b128 v[112:115], v5 offset:36864
  v_mul_f32 v203, s71, v203
  v_mfma_f32_16x16x32_bf16 v[136:139], v[72:75], v[24:27], v[136:139]
  v_mul_f32 v200, s70, v200
  v_mul_f32 v201, s71, v201
  v_mfma_f32_16x16x32_bf16 v[136:139], v[76:79], v[28:31], v[136:139]
  ds_read_b128 v[116:119], v5 offset:37120
  v_cvt_pk_bf16_f32 v189, v206, v207
  s_waitcnt lgkmcnt(2)
  v_mfma_f32_16x16x32_bf16 v[136:139], v[80:83], v[32:35], v[136:139]
  v_cvt_pk_bf16_f32 v197, v202, v203
  v_cvt_pk_bf16_f32 v193, v200, v201
  v_mfma_f32_16x16x32_bf16 v[136:139], v[84:87], v[36:39], v[136:139]
  ds_read_b128 v[120:123], v5 offset:37376
  v_cvt_f32_i32 v215, v214
  v_mfma_f32_16x16x32_bf16 v[140:143], v[88:91], v[16:19], v[168:171]
  v_cvt_f32_i32 v214, v210
  v_cvt_f32_i32 v210, v209
  v_mfma_f32_16x16x32_bf16 v[140:143], v[92:95], v[20:23], v[140:143]
  ds_read_b128 v[124:127], v5 offset:37632
  v_cvt_f32_i32 v211, v213
  v_mfma_f32_16x16x32_bf16 v[140:143], v[96:99], v[24:27], v[140:143]
  v_cvt_f32_i32 v209, v212
  v_cvt_f32_i32 v208, v208
  v_mfma_f32_16x16x32_bf16 v[140:143], v[100:103], v[28:31], v[140:143]
  ds_read_b128 v[128:131], v5 offset:37888
  v_cvt_pk_bf16_f32 v214, 0, v214
  v_mfma_f32_16x16x32_bf16 v[140:143], v[104:107], v[32:35], v[140:143]
  v_cvt_pk_bf16_f32 v215, 0, v215
  v_mfma_f32_16x16x32_bf16 v[140:143], v[108:111], v[36:39], v[140:143]
  ds_read_b128 v[132:135], v5 offset:38144
  v_cvt_pk_bf16_f32 v210, 0, v210
  v_mfma_f32_16x16x32_bf16 v[144:147], v[64:67], v[40:43], v[172:175]
  v_exp_f32 v136, v136
  v_mfma_f32_16x16x32_bf16 v[144:147], v[68:71], v[44:47], v[144:147]
  v_exp_f32 v137, v137
  v_mfma_f32_16x16x32_bf16 v[144:147], v[72:75], v[48:51], v[144:147]
  v_exp_f32 v138, v138
  v_mfma_f32_16x16x32_bf16 v[144:147], v[76:79], v[52:55], v[144:147]
  v_exp_f32 v139, v139
  v_mfma_f32_16x16x32_bf16 v[144:147], v[80:83], v[56:59], v[144:147]
  v_cvt_pk_bf16_f32 v136, v136, v137
  v_cvt_pk_bf16_f32 v137, v138, v139
  v_mfma_f32_16x16x32_bf16 v[144:147], v[84:87], v[60:63], v[144:147]
  v_exp_f32 v140, v140
  v_mfma_f32_16x16x32_bf16 v[148:151], v[88:91], v[40:43], v[172:175]
  v_exp_f32 v141, v141
  v_mfma_f32_16x16x32_bf16 v[148:151], v[92:95], v[44:47], v[148:151]
  v_exp_f32 v142, v142
  v_mfma_f32_16x16x32_bf16 v[148:151], v[96:99], v[48:51], v[148:151]
  v_exp_f32 v143, v143
  v_mfma_f32_16x16x32_bf16 v[148:151], v[100:103], v[52:55], v[148:151]
  v_cvt_pk_bf16_f32 v138, v140, v141
  v_cvt_pk_bf16_f32 v139, v142, v143
  v_mfma_f32_16x16x32_bf16 v[148:151], v[104:107], v[56:59], v[148:151]
  s_add_u32 s3, s3, 512
  v_cvt_pk_bf16_f32 v211, 0, v211
  v_mfma_f32_16x16x32_bf16 v[148:151], v[108:111], v[60:63], v[148:151]
  s_xor_b32 s90, s3, s76
  v_cvt_pk_bf16_f32 v208, 0, v208
  v_mfma_f32_16x16x32_bf16 v[152:155], v[64:67], a[208:211], v[176:179]
  v_exp_f32 v144, v144
  v_mfma_f32_16x16x32_bf16 v[152:155], v[68:71], a[212:215], v[152:155]
  v_exp_f32 v145, v145
  v_mfma_f32_16x16x32_bf16 v[152:155], v[72:75], a[216:219], v[152:155]
  v_exp_f32 v146, v146
  v_mfma_f32_16x16x32_bf16 v[152:155], v[76:79], a[220:223], v[152:155]
  v_exp_f32 v147, v147
  v_mfma_f32_16x16x32_bf16 v[152:155], v[80:83], a[224:227], v[152:155]
  v_cvt_pk_bf16_f32 v144, v144, v145
  v_cvt_pk_bf16_f32 v145, v146, v147
  v_mfma_f32_16x16x32_bf16 v[152:155], v[84:87], a[228:231], v[152:155]
  v_exp_f32 v148, v148
  v_mfma_f32_16x16x32_bf16 v[156:159], v[88:91], a[208:211], v[176:179]
  v_exp_f32 v149, v149
  v_mfma_f32_16x16x32_bf16 v[156:159], v[92:95], a[212:215], v[156:159]
  v_exp_f32 v150, v150
  v_mfma_f32_16x16x32_bf16 v[156:159], v[96:99], a[216:219], v[156:159]
  v_exp_f32 v151, v151
  v_mfma_f32_16x16x32_bf16 v[156:159], v[100:103], a[220:223], v[156:159]
  v_cvt_pk_bf16_f32 v146, v148, v149
  v_cvt_pk_bf16_f32 v147, v150, v151
  v_mfma_f32_16x16x32_bf16 v[156:159], v[104:107], a[224:227], v[156:159]
  s_and_b32 s90, s90, 0x7e00
  v_cvt_pk_bf16_f32 v209, 0, v209
  v_mfma_f32_16x16x32_bf16 v[156:159], v[108:111], a[228:231], v[156:159]
  v_subrev_f32 v214, s64, v214
  v_subrev_f32 v215, s65, v215
  v_mfma_f32_16x16x32_bf16 v[160:163], v[64:67], a[232:235], v[180:183]
  v_exp_f32 v152, v152
  v_mfma_f32_16x16x32_bf16 v[160:163], v[68:71], a[236:239], v[160:163]
  v_exp_f32 v153, v153
  v_mfma_f32_16x16x32_bf16 v[160:163], v[72:75], a[240:243], v[160:163]
  v_exp_f32 v154, v154
  v_mfma_f32_16x16x32_bf16 v[160:163], v[76:79], a[244:247], v[160:163]
  v_exp_f32 v155, v155
  v_mfma_f32_16x16x32_bf16 v[160:163], v[80:83], a[248:251], v[160:163]
  v_cvt_pk_bf16_f32 v152, v152, v153
  v_cvt_pk_bf16_f32 v153, v154, v155
  v_mfma_f32_16x16x32_bf16 v[160:163], v[84:87], a[252:255], v[160:163]
  v_exp_f32 v156, v156
  v_mfma_f32_16x16x32_bf16 v[164:167], v[88:91], a[232:235], v[180:183]
  v_exp_f32 v157, v157
  v_mfma_f32_16x16x32_bf16 v[164:167], v[92:95], a[236:239], v[164:167]
  v_exp_f32 v158, v158
  v_mfma_f32_16x16x32_bf16 v[164:167], v[96:99], a[240:243], v[164:167]
  v_exp_f32 v159, v159
  v_mfma_f32_16x16x32_bf16 v[164:167], v[100:103], a[244:247], v[164:167]
  v_cvt_pk_bf16_f32 v154, v156, v157
  v_cvt_pk_bf16_f32 v155, v158, v159
  v_mfma_f32_16x16x32_bf16 v[164:167], v[104:107], a[248:251], v[164:167]
  v_subrev_f32 v210, s64, v210
  v_subrev_f32 v211, s65, v211
  s_waitcnt lgkmcnt(0)
  v_mfma_f32_16x16x32_bf16 v[164:167], v[108:111], a[252:255], v[164:167]
  v_subrev_f32 v208, s64, v208
  v_subrev_f32 v209, s65, v209
  v_mfma_f32_16x16x32_bf16 a[0:3], v[112:115], v[136:139], a[0:3]
  v_exp_f32 v160, v160
  v_mfma_f32_16x16x32_bf16 a[4:7], v[112:115], v[144:147], a[4:7]
  v_exp_f32 v161, v161
  v_mfma_f32_16x16x32_bf16 a[8:11], v[112:115], v[152:155], a[8:11]
  v_exp_f32 v162, v162
  v_mfma_f32_16x16x32_bf16 a[16:19], v[116:119], v[136:139], a[16:19]
  v_exp_f32 v163, v163
  v_mfma_f32_16x16x32_bf16 a[20:23], v[116:119], v[144:147], a[20:23]
  v_cvt_pk_bf16_f32 v160, v160, v161
  v_cvt_pk_bf16_f32 v161, v162, v163
  v_mfma_f32_16x16x32_bf16 a[24:27], v[116:119], v[152:155], a[24:27]
  v_exp_f32 v164, v164
  v_mfma_f32_16x16x32_bf16 a[32:35], v[120:123], v[136:139], a[32:35]
  v_exp_f32 v165, v165
  v_mfma_f32_16x16x32_bf16 a[36:39], v[120:123], v[144:147], a[36:39]
  v_exp_f32 v166, v166
  v_mfma_f32_16x16x32_bf16 a[40:43], v[120:123], v[152:155], a[40:43]
  v_exp_f32 v167, v167
  v_mfma_f32_16x16x32_bf16 a[48:51], v[124:127], v[136:139], a[48:51]
  v_cvt_pk_bf16_f32 v162, v164, v165
  v_cvt_pk_bf16_f32 v163, v166, v167
  v_mfma_f32_16x16x32_bf16 a[52:55], v[124:127], v[144:147], a[52:55]
  s_waitcnt vmcnt(18)
  v_cmp_eq_u64 vcc, s[88:89], v[6:7]
  s_add_u32 m0, s37, 24576
  v_mfma_f32_16x16x32_bf16 a[56:59], v[124:127], v[152:155], a[56:59]
  s_waitcnt vmcnt(12)
  s_barrier
  v_mfma_f32_16x16x32_bf16 a[192:195], v[12:15], v[136:139], a[192:195]
  s_cbranch_vccz L_slow15
L_ret15:
  buffer_load_dwordx2 v[6:7], v1, s[4:7], s90 offen sc1
  v_mfma_f32_16x16x32_bf16 a[196:199], v[12:15], v[144:147], a[196:199]
  ds_read_b128 v[64:67], v4 offset:0
  v_cvt_pk_bf16_f32 v214, 0, v214
  v_mfma_f32_16x16x32_bf16 a[200:203], v[12:15], v[152:155], a[200:203]
  buffer_load_dwordx4 v8, s[4:7], s48 offen offset:0 sc1 lds
  v_cvt_pk_bf16_f32 v215, 0, v215
  v_mfma_f32_16x16x32_bf16 a[12:15], v[112:115], v[160:163], a[12:15]
  ds_read_b128 v[68:71], v4 offset:1024
  v_cvt_pk_bf16_f32 v210, 0, v210
  v_mfma_f32_16x16x32_bf16 a[28:31], v[116:119], v[160:163], a[28:31]
  ds_read_b128 v[112:115], v5 offset:38400
  v_cvt_pk_bf16_f32 v211, 0, v211
  v_mfma_f32_16x16x32_bf16 a[44:47], v[120:123], v[160:163], a[44:47]
  ds_read_b128 v[116:119], v5 offset:38656
  v_cvt_pk_bf16_f32 v208, 0, v208
  v_mfma_f32_16x16x32_bf16 a[60:63], v[124:127], v[160:163], a[60:63]
  ds_read_b128 v[120:123], v5 offset:38912
  v_cvt_pk_bf16_f32 v209, 0, v209
  v_mfma_f32_16x16x32_bf16 a[204:207], v[12:15], v[160:163], a[204:207]
  ds_read_b128 v[124:127], v5 offset:39168
  v_mul_f32 v214, s72, v214
  v_mfma_f32_16x16x32_bf16 a[64:67], v[128:131], v[136:139], a[64:67]
  ds_read_b128 v[72:75], v4 offset:2048
  v_mul_f32 v215, s73, v215
  v_mfma_f32_16x16x32_bf16 a[68:71], v[128:131], v[144:147], a[68:71]
  ds_read_b128 v[76:79], v4 offset:3072
  v_mul_f32 v210, s72, v210
  v_mfma_f32_16x16x32_bf16 a[72:75], v[128:131], v[152:155], a[72:75]
  buffer_load_dwordx4 v8, s[4:7], s48 offen offset:1024 sc1 lds
  v_mul_f32 v211, s73, v211
  v_mfma_f32_16x16x32_bf16 a[76:79], v[128:131], v[160:163], a[76:79]
  ds_read_b128 v[80:83], v4 offset:4096
  v_mul_f32 v208, s72, v208
  v_mfma_f32_16x16x32_bf16 a[80:83], v[132:135], v[136:139], a[80:83]
  ds_read_b128 v[128:131], v5 offset:39424
  v_mul_f32 v209, s73, v209
  v_mfma_f32_16x16x32_bf16 a[84:87], v[132:135], v[144:147], a[84:87]
  ds_read_b128 v[84:87], v4 offset:5120
  v_cvt_pk_bf16_f32 v190, v214, v215
  v_mfma_f32_16x16x32_bf16 a[88:91], v[132:135], v[152:155], a[88:91]
  ds_read_b128 v[88:91], v4 offset:6144
  v_cvt_pk_bf16_f32 v198, v210, v211
  v_mfma_f32_16x16x32_bf16 a[92:95], v[132:135], v[160:163], a[92:95]
  ds_read_b128 v[92:95], v4 offset:7168
  v_cvt_pk_bf16_f32 v194, v208, v209
  s_waitcnt lgkmcnt(10)
  v_mfma_f32_16x16x32_bf16 a[96:99], v[112:115], v[136:139], a[96:99]
  ds_read_b128 v[132:135], v5 offset:39680
  v_cvt_f32_i32 v223, v222
  v_mfma_f32_16x16x32_bf16 a[100:103], v[112:115], v[144:147], a[100:103]
  ds_read_b128 v[96:99], v4 offset:8192
  v_cvt_f32_i32 v222, v218
  v_mfma_f32_16x16x32_bf16 a[104:107], v[112:115], v[152:155], a[104:107]
  buffer_load_dwordx4 v8, s[4:7], s48 offen offset:2048 sc1 lds
  v_cvt_f32_i32 v218, v217
  v_mfma_f32_16x16x32_bf16 a[108:111], v[112:115], v[160:163], a[108:111]
  ds_read_b128 v[100:103], v4 offset:9216
  v_cvt_f32_i32 v219, v221
  s_waitcnt lgkmcnt(10)
  v_mfma_f32_16x16x32_bf16 a[112:115], v[116:119], v[136:139], a[112:115]
  s_add_u32 m0, s37, 73728
  v_mfma_f32_16x16x32_bf16 a[116:119], v[116:119], v[144:147], a[116:119]
  ds_read_b128 v[104:107], v4 offset:10240
  v_cvt_f32_i32 v217, v220
  v_mfma_f32_16x16x32_bf16 a[120:123], v[116:119], v[152:155], a[120:123]
  v_cvt_f32_i32 v216, v216
  v_cvt_pk_bf16_f32 v222, 0, v222
  v_mfma_f32_16x16x32_bf16 a[124:127], v[116:119], v[160:163], a[124:127]
  ds_read_b128 v[108:111], v4 offset:11264
  v_cvt_pk_bf16_f32 v223, 0, v223
  v_mfma_f32_16x16x32_bf16 a[128:131], v[120:123], v[136:139], a[128:131]
  v_cvt_pk_bf16_f32 v218, 0, v218
  v_cvt_pk_bf16_f32 v219, 0, v219
  v_mfma_f32_16x16x32_bf16 a[132:135], v[120:123], v[144:147], a[132:135]
  v_cvt_pk_bf16_f32 v216, 0, v216
  v_cvt_pk_bf16_f32 v217, 0, v217
  v_mfma_f32_16x16x32_bf16 a[136:139], v[120:123], v[152:155], a[136:139]
  buffer_load_dwordx4 v9, s[4:7], s48 offen offset:0 sc1 lds
  v_subrev_f32 v222, s66, v222
  v_mfma_f32_16x16x32_bf16 a[140:143], v[120:123], v[160:163], a[140:143]
  v_subrev_f32 v223, s67, v223
  v_subrev_f32 v218, s66, v218
  v_mfma_f32_16x16x32_bf16 a[144:147], v[124:127], v[136:139], a[144:147]
  v_subrev_f32 v219, s67, v219
  v_subrev_f32 v216, s66, v216
  v_mfma_f32_16x16x32_bf16 a[148:151], v[124:127], v[144:147], a[148:151]
  v_subrev_f32 v217, s67, v217
  v_cvt_pk_bf16_f32 v222, 0, v222
  v_mfma_f32_16x16x32_bf16 a[152:155], v[124:127], v[152:155], a[152:155]
  v_cvt_pk_bf16_f32 v223, 0, v223
  v_cvt_pk_bf16_f32 v218, 0, v218
  v_mfma_f32_16x16x32_bf16 a[156:159], v[124:127], v[160:163], a[156:159]
  v_cvt_pk_bf16_f32 v219, 0, v219
  v_cvt_pk_bf16_f32 v216, 0, v216
  s_waitcnt lgkmcnt(4)
  v_mfma_f32_16x16x32_bf16 a[160:163], v[128:131], v[136:139], a[160:163]
  buffer_load_dwordx4 v9, s[4:7], s48 offen offset:1024 sc1 lds
  v_cvt_pk_bf16_f32 v217, 0, v217
  v_mfma_f32_16x16x32_bf16 a[164:167], v[128:131], v[144:147], a[164:167]
  v_mul_f32 v222, s74, v222
  v_mul_f32 v223, s75, v223
  v_mfma_f32_16x16x32_bf16 a[168:171], v[128:131], v[152:155], a[168:171]
  v_mul_f32 v218, s74, v218
  v_mul_f32 v219, s75, v219
  v_mfma_f32_16x16x32_bf16 a[172:175], v[128:131], v[160:163], a[172:175]
  v_mul_f32 v216, s74, v216
  v_mul_f32 v217, s75, v217
  v_mfma_f32_16x16x32_bf16 a[176:179], v[132:135], v[136:139], a[176:179]
  v_cvt_pk_bf16_f32 v191, v222, v223
  v_cvt_pk_bf16_f32 v199, v218, v219
  v_mfma_f32_16x16x32_bf16 a[180:183], v[132:135], v[144:147], a[180:183]
  v_cvt_pk_bf16_f32 v195, v216, v217
  v_mfma_f32_16x16x32_bf16 a[184:187], v[132:135], v[152:155], a[184:187]
  buffer_load_dwordx4 v9, s[4:7], s48 offen offset:2048 sc1 lds
  v_mfma_f32_16x16x32_bf16 a[188:191], v[132:135], v[160:163], a[188:191]
  s_mul_i32 s48, s90, 48
  v_mfma_f32_16x16x32_bf16 v[136:139], v[64:67], v[16:19], v[168:171]
  buffer_store_dwordx4 v[188:191], v9, s[4:7], s77 offen offset:2048 sc1
  v_mfma_f32_16x16x32_bf16 v[136:139], v[68:71], v[20:23], v[136:139]
  ds_read_b128 v[112:115], v5 offset:0
  s_waitcnt vmcnt(18)
  v_cvt_f32_i32 v224, v224
  v_mfma_f32_16x16x32_bf16 v[136:139], v[72:75], v[24:27], v[136:139]
  v_cvt_f32_i32 v225, v225
  s_waitcnt vmcnt(16)
  v_lshlrev_b32 v188, 16, v232
  v_mfma_f32_16x16x32_bf16 v[136:139], v[76:79], v[28:31], v[136:139]
  ds_read_b128 v[116:119], v5 offset:256
  v_and_b32 v189, s44, v232
  s_waitcnt lgkmcnt(2)
  v_mfma_f32_16x16x32_bf16 v[136:139], v[80:83], v[32:35], v[136:139]
  buffer_store_dwordx4 v[192:195], v9, s[4:7], s77 offen offset:0 sc1
  v_cvt_pk_bf16_f32 v224, 0, v224
  v_mfma_f32_16x16x32_bf16 v[136:139], v[84:87], v[36:39], v[136:139]
  ds_read_b128 v[120:123], v5 offset:512
  v_cvt_pk_bf16_f32 v225, 0, v225
  v_mfma_f32_16x16x32_bf16 v[140:143], v[88:91], v[16:19], v[168:171]
  s_waitcnt vmcnt(16)
  v_lshlrev_b32 v190, 16, v236
  v_and_b32 v191, s44, v236
  v_mfma_f32_16x16x32_bf16 v[140:143], v[92:95], v[20:23], v[140:143]
  ds_read_b128 v[124:127], v5 offset:768
  v_subrev_f32 v224, v188, v224
  v_mfma_f32_16x16x32_bf16 v[140:143], v[96:99], v[24:27], v[140:143]
  buffer_store_dwordx4 v[196:199], v9, s[4:7], s77 offen offset:1024 sc1
  v_subrev_f32 v225, v189, v225
  v_mfma_f32_16x16x32_bf16 v[140:143], v[100:103], v[28:31], v[140:143]
  ds_read_b128 v[128:131], v5 offset:1024
  v_mul_f32 v190, s42, v190
  v_mfma_f32_16x16x32_bf16 v[140:143], v[104:107], v[32:35], v[140:143]
  v_mul_f32 v191, s43, v191
  v_cvt_pk_bf16_f32 v224, 0, v224
  v_mfma_f32_16x16x32_bf16 v[140:143], v[108:111], v[36:39], v[140:143]
  ds_read_b128 v[132:135], v5 offset:1280
  v_cvt_pk_bf16_f32 v225, 0, v225
  v_mfma_f32_16x16x32_bf16 v[144:147], v[64:67], v[40:43], v[172:175]
  v_exp_f32 v136, v136
  v_mfma_f32_16x16x32_bf16 v[144:147], v[68:71], v[44:47], v[144:147]
  v_exp_f32 v137, v137
  v_mfma_f32_16x16x32_bf16 v[144:147], v[72:75], v[48:51], v[144:147]
  v_exp_f32 v138, v138
  v_mfma_f32_16x16x32_bf16 v[144:147], v[76:79], v[52:55], v[144:147]
  v_exp_f32 v139, v139
  v_mfma_f32_16x16x32_bf16 v[144:147], v[80:83], v[56:59], v[144:147]
  v_cvt_pk_bf16_f32 v136, v136, v137
  v_cvt_pk_bf16_f32 v137, v138, v139
  v_mfma_f32_16x16x32_bf16 v[144:147], v[84:87], v[60:63], v[144:147]
  v_exp_f32 v140, v140
  v_mfma_f32_16x16x32_bf16 v[148:151], v[88:91], v[40:43], v[172:175]
  v_exp_f32 v141, v141
  v_mfma_f32_16x16x32_bf16 v[148:151], v[92:95], v[44:47], v[148:151]
  v_exp_f32 v142, v142
  v_mfma_f32_16x16x32_bf16 v[148:151], v[96:99], v[48:51], v[148:151]
  v_exp_f32 v143, v143
  v_mfma_f32_16x16x32_bf16 v[148:151], v[100:103], v[52:55], v[148:151]
  v_cvt_pk_bf16_f32 v138, v140, v141
  v_cvt_pk_bf16_f32 v139, v142, v143
  v_mfma_f32_16x16x32_bf16 v[148:151], v[104:107], v[56:59], v[148:151]
  s_add_u32 s3, s3, 512
  v_mfma_f32_16x16x32_bf16 v[148:151], v[108:111], v[60:63], v[148:151]
  s_xor_b32 s90, s3, s76
  v_mul_f32 v224, v190, v224
  v_mfma_f32_16x16x32_bf16 v[152:155], v[64:67], a[208:211], v[176:179]
  v_exp_f32 v144, v144
  v_mfma_f32_16x16x32_bf16 v[152:155], v[68:71], a[212:215], v[152:155]
  v_exp_f32 v145, v145
  v_mfma_f32_16x16x32_bf16 v[152:155], v[72:75], a[216:219], v[152:155]
  v_exp_f32 v146, v146
  v_mfma_f32_16x16x32_bf16 v[152:155], v[76:79], a[220:223], v[152:155]
  v_exp_f32 v147, v147
  v_mfma_f32_16x16x32_bf16 v[152:155], v[80:83], a[224:227], v[152:155]
  v_cvt_pk_bf16_f32 v144, v144, v145
  v_cvt_pk_bf16_f32 v145, v146, v147
  v_mfma_f32_16x16x32_bf16 v[152:155], v[84:87], a[228:231], v[152:155]
  v_exp_f32 v148, v148
  v_mfma_f32_16x16x32_bf16 v[156:159], v[88:91], a[208:211], v[176:179]
  v_exp_f32 v149, v149
  v_mfma_f32_16x16x32_bf16 v[156:159], v[92:95], a[212:215], v[156:159]
  v_exp_f32 v150, v150
  v_mfma_f32_16x16x32_bf16 v[156:159], v[96:99], a[216:219], v[156:159]
  v_exp_f32 v151, v151
  v_mfma_f32_16x16x32_bf16 v[156:159], v[100:103], a[220:223], v[156:159]
  v_cvt_pk_bf16_f32 v146, v148, v149
  v_cvt_pk_bf16_f32 v147, v150, v151
  v_mfma_f32_16x16x32_bf16 v[156:159], v[104:107], a[224:227], v[156:159]
  s_and_b32 s90, s90, 0x7e00
  v_mul_f32 v225, v191, v225
  v_mfma_f32_16x16x32_bf16 v[156:159], v[108:111], a[228:231], v[156:159]
  v_cvt_pk_bf16_f32 v232, v224, v225
  v_cvt_f32_i32 v226, v226
  v_mfma_f32_16x16x32_bf16 v[160:163], v[64:67], a[232:235], v[180:183]
  v_exp_f32 v152, v152
  v_mfma_f32_16x16x32_bf16 v[160:163], v[68:71], a[236:239], v[160:163]
  v_exp_f32 v153, v153
  v_mfma_f32_16x16x32_bf16 v[160:163], v[72:75], a[240:243], v[160:163]
  v_exp_f32 v154, v154
  v_mfma_f32_16x16x32_bf16 v[160:163], v[76:79], a[244:247], v[160:163]
  v_exp_f32 v155, v155
  v_mfma_f32_16x16x32_bf16 v[160:163], v[80:83], a[248:251], v[160:163]
  v_cvt_pk_bf16_f32 v152, v152, v153
  v_cvt_pk_bf16_f32 v153, v154, v155
  v_mfma_f32_16x16x32_bf16 v[160:163], v[84:87], a[252:255], v[160:163]
  v_exp_f32 v156, v156
  v_mfma_f32_16x16x32_bf16 v[164:167], v[88:91], a[232:235], v[180:183]
  v_exp_f32 v157, v157
  v_mfma_f32_16x16x32_bf16 v[164:167], v[92:95], a[236:239], v[164:167]
  v_exp_f32 v158, v158
  v_mfma_f32_16x16x32_bf16 v[164:167], v[96:99], a[240:243], v[164:167]
  v_exp_f32 v159, v159
  v_mfma_f32_16x16x32_bf16 v[164:167], v[100:103], a[244:247], v[164:167]
  v_cvt_pk_bf16_f32 v154, v156, v157
  v_cvt_pk_bf16_f32 v155, v158, v159
  v_mfma_f32_16x16x32_bf16 v[164:167], v[104:107], a[248:251], v[164:167]
  v_cvt_f32_i32 v227, v227
  v_lshlrev_b32 v188, 16, v233
  s_waitcnt lgkmcnt(0)
  v_mfma_f32_16x16x32_bf16 v[164:167], v[108:111], a[252:255], v[164:167]
  v_and_b32 v189, s44, v233
  v_cvt_pk_bf16_f32 v226, 0, v226
  v_mfma_f32_16x16x32_bf16 a[0:3], v[112:115], v[136:139], a[0:3]
  v_exp_f32 v160, v160
  v_mfma_f32_16x16x32_bf16 a[4:7], v[112:115], v[144:147], a[4:7]
  v_exp_f32 v161, v161
  v_mfma_f32_16x16x32_bf16 a[8:11], v[112:115], v[152:155], a[8:11]
  v_exp_f32 v162, v162
  v_mfma_f32_16x16x32_bf16 a[16:19], v[116:119], v[136:139], a[16:19]
  v_exp_f32 v163, v163
  v_mfma_f32_16x16x32_bf16 a[20:23], v[116:119], v[144:147], a[20:23]
  v_cvt_pk_bf16_f32 v160, v160, v161
  v_cvt_pk_bf16_f32 v161, v162, v163
  v_mfma_f32_16x16x32_bf16 a[24:27], v[116:119], v[152:155], a[24:27]
  v_exp_f32 v164, v164
  v_mfma_f32_16x16x32_bf16 a[32:35], v[120:123], v[136:139], a[32:35]
  v_exp_f32 v165, v165
  v_mfma_f32_16x16x32_bf16 a[36:39], v[120:123], v[144:147], a[36:39]
  v_exp_f32 v166, v166
  v_mfma_f32_16x16x32_bf16 a[40:43], v[120:123], v[152:155], a[40:43]
  v_exp_f32 v167, v167
  v_mfma_f32_16x16x32_bf16 a[48:51], v[124:127], v[136:139], a[48:51]
  v_cvt_pk_bf16_f32 v162, v164, v165
  v_cvt_pk_bf16_f32 v163, v166, v167
  v_mfma_f32_16x16x32_bf16 a[52:55], v[124:127], v[144:147], a[52:55]
  s_waitcnt vmcnt(16)
  v_cmp_eq_u64 vcc, s[88:89], v[2:3]
  s_add_u32 m0, s37, 36864
  v_mfma_f32_16x16x32_bf16 a[56:59], v[124:127], v[152:155], a[56:59]
  s_waitcnt vmcnt(10)
  s_barrier
  v_mfma_f32_16x16x32_bf16 a[192:195], v[12:15], v[136:139], a[192:195]
  s_cbranch_vccz L_slow16
L_ret16:
  buffer_load_dwordx2 v[2:3], v1, s[4:7], s90 offen sc1
  v_mfma_f32_16x16x32_bf16 a[196:199], v[12:15], v[144:147], a[196:199]
  ds_read_b128 v[64:67], v4 offset:12288
  v_cvt_pk_bf16_f32 v227, 0, v227
  v_mfma_f32_16x16x32_bf16 a[200:203], v[12:15], v[152:155], a[200:203]
  buffer_load_dwordx4 v8, s[4:7], s40 offen offset:0 sc1 lds
  v_lshlrev_b32 v190, 16, v237
  v_mfma_f32_16x16x32_bf16 a[12:15], v[112:115], v[160:163], a[12:15]
  ds_read_b128 v[68:71], v4 offset:13312
  v_and_b32 v191, s44, v237
  v_mfma_f32_16x16x32_bf16 a[28:31], v[116:119], v[160:163], a[28:31]
  ds_read_b128 v[112:115], v5 offset:1536
  v_subrev_f32 v226, v188, v226
  v_mfma_f32_16x16x32_bf16 a[44:47], v[120:123], v[160:163], a[44:47]
  ds_read_b128 v[116:119], v5 offset:1792
  v_subrev_f32 v227, v189, v227
  v_mfma_f32_16x16x32_bf16 a[60:63], v[124:127], v[160:163], a[60:63]
  ds_read_b128 v[120:123], v5 offset:2048
  v_mul_f32 v190, s42, v190
  v_mfma_f32_16x16x32_bf16 a[204:207], v[12:15], v[160:163], a[204:207]
  ds_read_b128 v[124:127], v5 offset:2304
  v_mfma_f32_16x16x32_bf16 a[64:67], v[128:131], v[136:139], a[64:67]
  ds_read_b128 v[72:75], v4 offset:14336
  v_mul_f32 v191, s43, v191
  v_mfma_f32_16x16x32_bf16 a[68:71], v[128:131], v[144:147], a[68:71]
  ds_read_b128 v[76:79], v4 offset:15360
  v_cvt_pk_bf16_f32 v226, 0, v226
  v_mfma_f32_16x16x32_bf16 a[72:75], v[128:131], v[152:155], a[72:75]
  buffer_load_dwordx4 v8, s[4:7], s40 offen offset:1024 sc1 lds
  v_cvt_pk_bf16_f32 v227, 0, v227
  v_mfma_f32_16x16x32_bf16 a[76:79], v[128:131], v[160:163], a[76:79]
  ds_read_b128 v[80:83], v4 offset:16384
  v_mul_f32 v226, v190, v226
  v_mfma_f32_16x16x32_bf16 a[80:83], v[132:135], v[136:139], a[80:83]
  ds_read_b128 v[128:131], v5 offset:2560
  v_mul_f32 v227, v191, v227
  v_mfma_f32_16x16x32_bf16 a[84:87], v[132:135], v[144:147], a[84:87]
  ds_read_b128 v[84:87], v4 offset:17408
  v_cvt_pk_bf16_f32 v233, v226, v227
  v_mfma_f32_16x16x32_bf16 a[88:91], v[132:135], v[152:155], a[88:91]
  ds_read_b128 v[88:91], v4 offset:18432
  v_cvt_f32_i32 v228, v228
  v_mfma_f32_16x16x32_bf16 a[92:95], v[132:135], v[160:163], a[92:95]
  ds_read_b128 v[92:95], v4 offset:19456
  v_cvt_f32_i32 v229, v229
  s_waitcnt lgkmcnt(10)
  v_mfma_f32_16x16x32_bf16 a[96:99], v[112:115], v[136:139], a[96:99]
  ds_read_b128 v[132:135], v5 offset:2816
  v_lshlrev_b32 v188, 16, v234
  v_mfma_f32_16x16x32_bf16 a[100:103], v[112:115], v[144:147], a[100:103]
  ds_read_b128 v[96:99], v4 offset:20480
  v_and_b32 v189, s44, v234
  v_mfma_f32_16x16x32_bf16 a[104:107], v[112:115], v[152:155], a[104:107]
  buffer_load_dwordx4 v8, s[4:7], s40 offen offset:2048 sc1 lds
  v_cvt_pk_bf16_f32 v228, 0, v228
  v_mfma_f32_16x16x32_bf16 a[108:111], v[112:115], v[160:163], a[108:111]
  ds_read_b128 v[100:103], v4 offset:21504
  v_cvt_pk_bf16_f32 v229, 0, v229
  s_waitcnt lgkmcnt(10)
  v_mfma_f32_16x16x32_bf16 a[112:115], v[116:119], v[136:139], a[112:115]
  s_add_u32 m0, s37, 86016
  v_lshlrev_b32 v190, 16, v238
  v_mfma_f32_16x16x32_bf16 a[116:119], v[116:119], v[144:147], a[116:119]
  ds_read_b128 v[104:107], v4 offset:22528
  v_mfma_f32_16x16x32_bf16 a[120:123], v[116:119], v[152:155], a[120:123]
  v_and_b32 v191, s44, v238
  v_subrev_f32 v228, v188, v228
  v_mfma_f32_16x16x32_bf16 a[124:127], v[116:119], v[160:163], a[124:127]
  ds_read_b128 v[108:111], v4 offset:23552
  v_subrev_f32 v229, v189, v229
  v_mfma_f32_16x16x32_bf16 a[128:131], v[120:123], v[136:139], a[128:131]
  v_mul_f32 v190, s42, v190
  v_mul_f32 v191, s43, v191
  v_mfma_f32_16x16x32_bf16 a[132:135], v[120:123], v[144:147], a[132:135]
  v_cvt_pk_bf16_f32 v228, 0, v228
  v_cvt_pk_bf16_f32 v229, 0, v229
  v_mfma_f32_16x16x32_bf16 a[136:139], v[120:123], v[152:155], a[136:139]
  buffer_load_dwordx4 v9, s[4:7], s40 offen offset:0 sc1 lds
  v_mul_f32 v228, v190, v228
  v_mfma_f32_16x16x32_bf16 a[140:143], v[120:123], v[160:163], a[140:143]
  v_mul_f32 v229, v191, v229
  v_cvt_pk_bf16_f32 v234, v228, v229
  v_mfma_f32_16x16x32_bf16 a[144:147], v[124:127], v[136:139], a[144:147]
  v_cvt_f32_i32 v230, v230
  v_cvt_f32_i32 v231, v231
  v_mfma_f32_16x16x32_bf16 a[148:151], v[124:127], v[144:147], a[148:151]
  v_lshlrev_b32 v188, 16, v235
  v_and_b32 v189, s44, v235
  v_mfma_f32_16x16x32_bf16 a[152:155], v[124:127], v[152:155], a[152:155]
  v_cvt_pk_bf16_f32 v230, 0, v230
  v_mfma_f32_16x16x32_bf16 a[156:159], v[124:127], v[160:163], a[156:159]
  v_cvt_pk_bf16_f32 v231, 0, v231
  v_lshlrev_b32 v190, 16, v239
  s_waitcnt lgkmcnt(4)
  v_mfma_f32_16x16x32_bf16 a[160:163], v[128:131], v[136:139], a[160:163]
  buffer_load_dwordx4 v9, s[4:7], s40 offen offset:1024 sc1 lds
  v_and_b32 v191, s44, v239
  v_mfma_f32_16x16x32_bf16 a[164:167], v[128:131], v[144:147], a[164:167]
  v_subrev_f32 v230, v188, v230
  v_subrev_f32 v231, v189, v231
  v_mfma_f32_16x16x32_bf16 a[168:171], v[128:131], v[152:155], a[168:171]
  v_mul_f32 v190, s42, v190
  v_mul_f32 v191, s43, v191
  v_mfma_f32_16x16x32_bf16 a[172:175], v[128:131], v[160:163], a[172:175]
  v_cvt_pk_bf16_f32 v230, 0, v230
  v_cvt_pk_bf16_f32 v231, 0, v231
  v_mfma_f32_16x16x32_bf16 a[176:179], v[132:135], v[136:139], a[176:179]
  v_mul_f32 v230, v190, v230
  v_mul_f32 v231, v191, v231
  v_mfma_f32_16x16x32_bf16 a[180:183], v[132:135], v[144:147], a[180:183]
  v_cvt_pk_bf16_f32 v235, v230, v231
  v_mfma_f32_16x16x32_bf16 a[184:187], v[132:135], v[152:155], a[184:187]
  buffer_load_dwordx4 v9, s[4:7], s40 offen offset:2048 sc1 lds
  v_mfma_f32_16x16x32_bf16 a[188:191], v[132:135], v[160:163], a[188:191]
  s_mul_i32 s40, s90, 48
  v_mfma_f32_16x16x32_bf16 v[136:139], v[64:67], v[16:19], v[168:171]
  buffer_store_dwordx4 v[232:235], v8, s[4:7], s77 offen offset:2048 sc1
  v_mfma_f32_16x16x32_bf16 v[136:139], v[68:71], v[20:23], v[136:139]
  ds_read_b128 v[112:115], v5 offset:12288
  v_mfma_f32_16x16x32_bf16 v[136:139], v[72:75], v[24:27], v[136:139]
  v_mfma_f32_16x16x32_bf16 v[136:139], v[76:79], v[28:31], v[136:139]
  ds_read_b128 v[116:119], v5 offset:12544
  s_waitcnt lgkmcnt(2)
  v_mfma_f32_16x16x32_bf16 v[136:139], v[80:83], v[32:35], v[136:139]
  buffer_load_dwordx4 v[224:227], v184, s[12:15], s45 offen offset:0 sc0 sc1 nt
  v_mfma_f32_16x16x32_bf16 v[136:139], v[84:87], v[36:39], v[136:139]
  ds_read_b128 v[120:123], v5 offset:12800
  v_mfma_f32_16x16x32_bf16 v[140:143], v[88:91], v[16:19], v[168:171]
  v_mfma_f32_16x16x32_bf16 v[140:143], v[92:95], v[20:23], v[140:143]
  ds_read_b128 v[124:127], v5 offset:13056
  v_mfma_f32_16x16x32_bf16 v[140:143], v[96:99], v[24:27], v[140:143]
  buffer_load_dwordx4 v[228:231], v184, s[12:15], s45 offen offset:16 sc0 sc1 nt
  v_mfma_f32_16x16x32_bf16 v[140:143], v[100:103], v[28:31], v[140:143]
  ds_read_b128 v[128:131], v5 offset:13312
  v_mfma_f32_16x16x32_bf16 v[140:143], v[104:107], v[32:35], v[140:143]
  v_mfma_f32_16x16x32_bf16 v[140:143], v[108:111], v[36:39], v[140:143]
  ds_read_b128 v[132:135], v5 offset:13568
  v_mfma_f32_16x16x32_bf16 v[144:147], v[64:67], v[40:43], v[172:175]
  v_exp_f32 v136, v136
  v_mfma_f32_16x16x32_bf16 v[144:147], v[68:71], v[44:47], v[144:147]
  v_exp_f32 v137, v137
  buffer_load_dwordx4 v[232:235], v185, s[24:27], s46 offen offset:0
  v_mfma_f32_16x16x32_bf16 v[144:147], v[72:75], v[48:51], v[144:147]
  v_exp_f32 v138, v138
  v_mfma_f32_16x16x32_bf16 v[144:147], v[76:79], v[52:55], v[144:147]
  v_exp_f32 v139, v139
  v_mfma_f32_16x16x32_bf16 v[144:147], v[80:83], v[56:59], v[144:147]
  v_cvt_pk_bf16_f32 v136, v136, v137
  v_cvt_pk_bf16_f32 v137, v138, v139
  v_mfma_f32_16x16x32_bf16 v[144:147], v[84:87], v[60:63], v[144:147]
  v_exp_f32 v140, v140
  v_mfma_f32_16x16x32_bf16 v[148:151], v[88:91], v[40:43], v[172:175]
  v_exp_f32 v141, v141
  buffer_load_dwordx4 v[236:239], v185, s[20:23], s46 offen offset:0
  v_mfma_f32_16x16x32_bf16 v[148:151], v[92:95], v[44:47], v[148:151]
  v_exp_f32 v142, v142
  v_mfma_f32_16x16x32_bf16 v[148:151], v[96:99], v[48:51], v[148:151]
  v_exp_f32 v143, v143
  v_mfma_f32_16x16x32_bf16 v[148:151], v[100:103], v[52:55], v[148:151]
  v_cvt_pk_bf16_f32 v138, v140, v141
  v_cvt_pk_bf16_f32 v139, v142, v143
  v_mfma_f32_16x16x32_bf16 v[148:151], v[104:107], v[56:59], v[148:151]
  s_add_u32 s3, s3, 512
  v_mfma_f32_16x16x32_bf16 v[148:151], v[108:111], v[60:63], v[148:151]
  s_xor_b32 s90, s3, s76
  buffer_load_short_d16_hi v10, v187, s[32:35], s47 offen
  v_mfma_f32_16x16x32_bf16 v[152:155], v[64:67], a[208:211], v[176:179]
  v_exp_f32 v144, v144
  v_mfma_f32_16x16x32_bf16 v[152:155], v[68:71], a[212:215], v[152:155]
  v_exp_f32 v145, v145
  v_mfma_f32_16x16x32_bf16 v[152:155], v[72:75], a[216:219], v[152:155]
  v_exp_f32 v146, v146
  v_mfma_f32_16x16x32_bf16 v[152:155], v[76:79], a[220:223], v[152:155]
  v_exp_f32 v147, v147
  buffer_load_short_d16_hi v11, v187, s[28:31], s47 offen
  v_mfma_f32_16x16x32_bf16 v[152:155], v[80:83], a[224:227], v[152:155]
  v_cvt_pk_bf16_f32 v144, v144, v145
  v_cvt_pk_bf16_f32 v145, v146, v147
  v_mfma_f32_16x16x32_bf16 v[152:155], v[84:87], a[228:231], v[152:155]
  v_exp_f32 v148, v148
  v_mfma_f32_16x16x32_bf16 v[156:159], v[88:91], a[208:211], v[176:179]
  v_exp_f32 v149, v149
  v_mfma_f32_16x16x32_bf16 v[156:159], v[92:95], a[212:215], v[156:159]
  v_exp_f32 v150, v150
  v_mfma_f32_16x16x32_bf16 v[156:159], v[96:99], a[216:219], v[156:159]
  v_exp_f32 v151, v151
  v_mfma_f32_16x16x32_bf16 v[156:159], v[100:103], a[220:223], v[156:159]
  v_cvt_pk_bf16_f32 v146, v148, v149
  v_cvt_pk_bf16_f32 v147, v150, v151
  v_mfma_f32_16x16x32_bf16 v[156:159], v[104:107], a[224:227], v[156:159]
  s_and_b32 s90, s90, 0x7e00
  v_mfma_f32_16x16x32_bf16 v[156:159], v[108:111], a[228:231], v[156:159]
  v_mfma_f32_16x16x32_bf16 v[160:163], v[64:67], a[232:235], v[180:183]
  v_exp_f32 v152, v152
  v_mfma_f32_16x16x32_bf16 v[160:163], v[68:71], a[236:239], v[160:163]
  v_exp_f32 v153, v153
  v_mfma_f32_16x16x32_bf16 v[160:163], v[72:75], a[240:243], v[160:163]
  v_exp_f32 v154, v154
  v_mfma_f32_16x16x32_bf16 v[160:163], v[76:79], a[244:247], v[160:163]
  v_exp_f32 v155, v155
  v_mfma_f32_16x16x32_bf16 v[160:163], v[80:83], a[248:251], v[160:163]
  v_cvt_pk_bf16_f32 v152, v152, v153
  v_cvt_pk_bf16_f32 v153, v154, v155
  v_mfma_f32_16x16x32_bf16 v[160:163], v[84:87], a[252:255], v[160:163]
  v_exp_f32 v156, v156
  v_mfma_f32_16x16x32_bf16 v[164:167], v[88:91], a[232:235], v[180:183]
  v_exp_f32 v157, v157
  v_mfma_f32_16x16x32_bf16 v[164:167], v[92:95], a[236:239], v[164:167]
  v_exp_f32 v158, v158
  v_mfma_f32_16x16x32_bf16 v[164:167], v[96:99], a[240:243], v[164:167]
  v_exp_f32 v159, v159
  v_mfma_f32_16x16x32_bf16 v[164:167], v[100:103], a[244:247], v[164:167]
  v_cvt_pk_bf16_f32 v154, v156, v157
  v_cvt_pk_bf16_f32 v155, v158, v159
  v_mfma_f32_16x16x32_bf16 v[164:167], v[104:107], a[248:251], v[164:167]
  s_waitcnt lgkmcnt(0)
  v_mfma_f32_16x16x32_bf16 v[164:167], v[108:111], a[252:255], v[164:167]
  v_mfma_f32_16x16x32_bf16 a[0:3], v[112:115], v[136:139], a[0:3]
  v_exp_f32 v160, v160
  v_mfma_f32_16x16x32_bf16 a[4:7], v[112:115], v[144:147], a[4:7]
  v_exp_f32 v161, v161
  v_mfma_f32_16x16x32_bf16 a[8:11], v[112:115], v[152:155], a[8:11]
  v_exp_f32 v162, v162
  v_mfma_f32_16x16x32_bf16 a[16:19], v[116:119], v[136:139], a[16:19]
  v_exp_f32 v163, v163
  v_mfma_f32_16x16x32_bf16 a[20:23], v[116:119], v[144:147], a[20:23]
  v_cvt_pk_bf16_f32 v160, v160, v161
  v_cvt_pk_bf16_f32 v161, v162, v163
  v_mfma_f32_16x16x32_bf16 a[24:27], v[116:119], v[152:155], a[24:27]
  v_exp_f32 v164, v164
  v_mfma_f32_16x16x32_bf16 a[32:35], v[120:123], v[136:139], a[32:35]
  v_exp_f32 v165, v165
  v_mfma_f32_16x16x32_bf16 a[36:39], v[120:123], v[144:147], a[36:39]
  v_exp_f32 v166, v166
  v_mfma_f32_16x16x32_bf16 a[40:43], v[120:123], v[152:155], a[40:43]
  v_exp_f32 v167, v167
  v_mfma_f32_16x16x32_bf16 a[48:51], v[124:127], v[136:139], a[48:51]
  v_cvt_pk_bf16_f32 v162, v164, v165
  v_cvt_pk_bf16_f32 v163, v166, v167
  v_mfma_f32_16x16x32_bf16 a[52:55], v[124:127], v[144:147], a[52:55]
  s_waitcnt vmcnt(23)
  v_cmp_eq_u64 vcc, s[88:89], v[6:7]
  s_add_u32 m0, s37, 0
  v_mfma_f32_16x16x32_bf16 a[56:59], v[124:127], v[152:155], a[56:59]
  s_waitcnt vmcnt(17)
  s_barrier
  v_mfma_f32_16x16x32_bf16 a[192:195], v[12:15], v[136:139], a[192:195]
  s_cbranch_vccz L_slow17
L_ret17:
  buffer_load_dwordx2 v[6:7], v1, s[4:7], s90 offen sc1
  v_mfma_f32_16x16x32_bf16 a[196:199], v[12:15], v[144:147], a[196:199]
  ds_read_b128 v[64:67], v4 offset:24576
  v_mfma_f32_16x16x32_bf16 a[200:203], v[12:15], v[152:155], a[200:203]
  buffer_load_dwordx4 v8, s[4:7], s48 offen offset:0 sc1 lds
  v_mfma_f32_16x16x32_bf16 a[12:15], v[112:115], v[160:163], a[12:15]
  ds_read_b128 v[68:71], v4 offset:25600
  v_mfma_f32_16x16x32_bf16 a[28:31], v[116:119], v[160:163], a[28:31]
  ds_read_b128 v[112:115], v5 offset:13824
  v_mfma_f32_16x16x32_bf16 a[44:47], v[120:123], v[160:163], a[44:47]
  ds_read_b128 v[116:119], v5 offset:14080
  v_mfma_f32_16x16x32_bf16 a[60:63], v[124:127], v[160:163], a[60:63]
  ds_read_b128 v[120:123], v5 offset:14336
  v_mfma_f32_16x16x32_bf16 a[204:207], v[12:15], v[160:163], a[204:207]
  ds_read_b128 v[124:127], v5 offset:14592
  v_mfma_f32_16x16x32_bf16 a[64:67], v[128:131], v[136:139], a[64:67]
  ds_read_b128 v[72:75], v4 offset:26624
  v_mfma_f32_16x16x32_bf16 a[68:71], v[128:131], v[144:147], a[68:71]
  ds_read_b128 v[76:79], v4 offset:27648
  v_mfma_f32_16x16x32_bf16 a[72:75], v[128:131], v[152:155], a[72:75]
  buffer_load_dwordx4 v8, s[4:7], s48 offen offset:1024 sc1 lds
  v_mfma_f32_16x16x32_bf16 a[76:79], v[128:131], v[160:163], a[76:79]
  ds_read_b128 v[80:83], v4 offset:28672
  v_mfma_f32_16x16x32_bf16 a[80:83], v[132:135], v[136:139], a[80:83]
  ds_read_b128 v[128:131], v5 offset:14848
  v_mfma_f32_16x16x32_bf16 a[84:87], v[132:135], v[144:147], a[84:87]
  ds_read_b128 v[84:87], v4 offset:29696
  v_mfma_f32_16x16x32_bf16 a[88:91], v[132:135], v[152:155], a[88:91]
  ds_read_b128 v[88:91], v4 offset:30720
  v_mfma_f32_16x16x32_bf16 a[92:95], v[132:135], v[160:163], a[92:95]
  ds_read_b128 v[92:95], v4 offset:31744
  s_waitcnt lgkmcnt(10)
  v_mfma_f32_16x16x32_bf16 a[96:99], v[112:115], v[136:139], a[96:99]
  ds_read_b128 v[132:135], v5 offset:15104
  v_mfma_f32_16x16x32_bf16 a[100:103], v[112:115], v[144:147], a[100:103]
  ds_read_b128 v[96:99], v4 offset:32768
  v_mfma_f32_16x16x32_bf16 a[104:107], v[112:115], v[152:155], a[104:107]
  buffer_load_dwordx4 v8, s[4:7], s48 offen offset:2048 sc1 lds
  v_mfma_f32_16x16x32_bf16 a[108:111], v[112:115], v[160:163], a[108:111]
  ds_read_b128 v[100:103], v4 offset:33792
  s_waitcnt lgkmcnt(10)
  v_mfma_f32_16x16x32_bf16 a[112:115], v[116:119], v[136:139], a[112:115]
  s_add_u32 m0, s37, 49152
  v_mfma_f32_16x16x32_bf16 a[116:119], v[116:119], v[144:147], a[116:119]
  ds_read_b128 v[104:107], v4 offset:34816
  v_mfma_f32_16x16x32_bf16 a[120:123], v[116:119], v[152:155], a[120:123]
  v_mfma_f32_16x16x32_bf16 a[124:127], v[116:119], v[160:163], a[124:127]
  ds_read_b128 v[108:111], v4 offset:35840
  v_mfma_f32_16x16x32_bf16 a[128:131], v[120:123], v[136:139], a[128:131]
  v_mfma_f32_16x16x32_bf16 a[132:135], v[120:123], v[144:147], a[132:135]
  v_mfma_f32_16x16x32_bf16 a[136:139], v[120:123], v[152:155], a[136:139]
  buffer_load_dwordx4 v9, s[4:7], s48 offen offset:0 sc1 lds
  v_mfma_f32_16x16x32_bf16 a[140:143], v[120:123], v[160:163], a[140:143]
  v_mfma_f32_16x16x32_bf16 a[144:147], v[124:127], v[136:139], a[144:147]
  v_mfma_f32_16x16x32_bf16 a[148:151], v[124:127], v[144:147], a[148:151]
  v_mfma_f32_16x16x32_bf16 a[152:155], v[124:127], v[152:155], a[152:155]
  v_mfma_f32_16x16x32_bf16 a[156:159], v[124:127], v[160:163], a[156:159]
  s_waitcnt lgkmcnt(4)
  v_mfma_f32_16x16x32_bf16 a[160:163], v[128:131], v[136:139], a[160:163]
  buffer_load_dwordx4 v9, s[4:7], s48 offen offset:1024 sc1 lds
  v_mfma_f32_16x16x32_bf16 a[164:167], v[128:131], v[144:147], a[164:167]
  v_mfma_f32_16x16x32_bf16 a[168:171], v[128:131], v[152:155], a[168:171]
  v_mfma_f32_16x16x32_bf16 a[172:175], v[128:131], v[160:163], a[172:175]
  v_mfma_f32_16x16x32_bf16 a[176:179], v[132:135], v[136:139], a[176:179]
  v_mfma_f32_16x16x32_bf16 a[180:183], v[132:135], v[144:147], a[180:183]
  v_mfma_f32_16x16x32_bf16 a[184:187], v[132:135], v[152:155], a[184:187]
  buffer_load_dwordx4 v9, s[4:7], s48 offen offset:2048 sc1 lds
  v_mfma_f32_16x16x32_bf16 a[188:191], v[132:135], v[160:163], a[188:191]
  s_mul_i32 s48, s90, 48
  v_mfma_f32_16x16x32_bf16 v[136:139], v[64:67], v[16:19], v[168:171]
  buffer_load_dwordx3 v[192:194], v186, s[16:19], s45 offen offset:0 sc0 sc1 nt
  v_mfma_f32_16x16x32_bf16 v[136:139], v[68:71], v[20:23], v[136:139]
  ds_read_b128 v[112:115], v5 offset:24576
  v_mfma_f32_16x16x32_bf16 v[136:139], v[72:75], v[24:27], v[136:139]
  v_mfma_f32_16x16x32_bf16 v[136:139], v[76:79], v[28:31], v[136:139]
  ds_read_b128 v[116:119], v5 offset:24832
  s_waitcnt lgkmcnt(2)
  v_mfma_f32_16x16x32_bf16 v[136:139], v[80:83], v[32:35], v[136:139]
  buffer_load_dwordx3 v[196:198], v186, s[16:19], s45 offen offset:768 sc0 sc1 nt
  v_mfma_f32_16x16x32_bf16 v[136:139], v[84:87], v[36:39], v[136:139]
  ds_read_b128 v[120:123], v5 offset:25088
  v_mfma_f32_16x16x32_bf16 v[140:143], v[88:91], v[16:19], v[168:171]
  v_mfma_f32_16x16x32_bf16 v[140:143], v[92:95], v[20:23], v[140:143]
  ds_read_b128 v[124:127], v5 offset:25344
  v_mfma_f32_16x16x32_bf16 v[140:143], v[96:99], v[24:27], v[140:143]
  buffer_load_dwordx3 v[200:202], v186, s[16:19], s45 offen offset:1536 sc0 sc1 nt
  v_mfma_f32_16x16x32_bf16 v[140:143], v[100:103], v[28:31], v[140:143]
  ds_read_b128 v[128:131], v5 offset:25600
  v_mfma_f32_16x16x32_bf16 v[140:143], v[104:107], v[32:35], v[140:143]
  v_mfma_f32_16x16x32_bf16 v[140:143], v[108:111], v[36:39], v[140:143]
  ds_read_b128 v[132:135], v5 offset:25856
  v_mfma_f32_16x16x32_bf16 v[144:147], v[64:67], v[40:43], v[172:175]
  v_exp_f32 v136, v136
  v_mfma_f32_16x16x32_bf16 v[144:147], v[68:71], v[44:47], v[144:147]
  v_exp_f32 v137, v137
  buffer_load_dwordx3 v[204:206], v186, s[16:19], s45 offen offset:2304 sc0 sc1 nt
  v_mfma_f32_16x16x32_bf16 v[144:147], v[72:75], v[48:51], v[144:147]
  v_exp_f32 v138, v138
  v_mfma_f32_16x16x32_bf16 v[144:147], v[76:79], v[52:55], v[144:147]
  v_exp_f32 v139, v139
  v_mfma_f32_16x16x32_bf16 v[144:147], v[80:83], v[56:59], v[144:147]
  v_cvt_pk_bf16_f32 v136, v136, v137
  v_cvt_pk_bf16_f32 v137, v138, v139
  v_mfma_f32_16x16x32_bf16 v[144:147], v[84:87], v[60:63], v[144:147]
  v_exp_f32 v140, v140
  v_mfma_f32_16x16x32_bf16 v[148:151], v[88:91], v[40:43], v[172:175]
  v_exp_f32 v141, v141
  buffer_load_dwordx3 v[208:210], v186, s[16:19], s49 offen offset:0 sc0 sc1 nt
  v_mfma_f32_16x16x32_bf16 v[148:151], v[92:95], v[44:47], v[148:151]
  v_exp_f32 v142, v142
  v_mfma_f32_16x16x32_bf16 v[148:151], v[96:99], v[48:51], v[148:151]
  v_exp_f32 v143, v143
  v_mfma_f32_16x16x32_bf16 v[148:151], v[100:103], v[52:55], v[148:151]
  v_cvt_pk_bf16_f32 v138, v140, v141
  v_cvt_pk_bf16_f32 v139, v142, v143
  v_mfma_f32_16x16x32_bf16 v[148:151], v[104:107], v[56:59], v[148:151]
  s_add_u32 s3, s3, 512
  v_mfma_f32_16x16x32_bf16 v[148:151], v[108:111], v[60:63], v[148:151]
  s_xor_b32 s90, s3, s76
  buffer_load_dwordx3 v[212:214], v186, s[16:19], s49 offen offset:768 sc0 sc1 nt
  v_mfma_f32_16x16x32_bf16 v[152:155], v[64:67], a[208:211], v[176:179]
  v_exp_f32 v144, v144
  v_mfma_f32_16x16x32_bf16 v[152:155], v[68:71], a[212:215], v[152:155]
  v_exp_f32 v145, v145
  v_mfma_f32_16x16x32_bf16 v[152:155], v[72:75], a[216:219], v[152:155]
  v_exp_f32 v146, v146
  v_mfma_f32_16x16x32_bf16 v[152:155], v[76:79], a[220:223], v[152:155]
  v_exp_f32 v147, v147
  buffer_load_dwordx3 v[216:218], v186, s[16:19], s49 offen offset:1536 sc0 sc1 nt
  v_mfma_f32_16x16x32_bf16 v[152:155], v[80:83], a[224:227], v[152:155]
  v_cvt_pk_bf16_f32 v144, v144, v145
  v_cvt_pk_bf16_f32 v145, v146, v147
  v_mfma_f32_16x16x32_bf16 v[152:155], v[84:87], a[228:231], v[152:155]
  v_exp_f32 v148, v148
  v_mfma_f32_16x16x32_bf16 v[156:159], v[88:91], a[208:211], v[176:179]
  v_exp_f32 v149, v149
  buffer_load_dwordx3 v[220:222], v186, s[16:19], s49 offen offset:2304 sc0 sc1 nt
  v_mfma_f32_16x16x32_bf16 v[156:159], v[92:95], a[212:215], v[156:159]
  v_exp_f32 v150, v150
  v_mfma_f32_16x16x32_bf16 v[156:159], v[96:99], a[216:219], v[156:159]
  v_exp_f32 v151, v151
  v_mfma_f32_16x16x32_bf16 v[156:159], v[100:103], a[220:223], v[156:159]
  v_cvt_pk_bf16_f32 v146, v148, v149
  v_cvt_pk_bf16_f32 v147, v150, v151
  v_mfma_f32_16x16x32_bf16 v[156:159], v[104:107], a[224:227], v[156:159]
  s_and_b32 s90, s90, 0x7e00
  v_mfma_f32_16x16x32_bf16 v[156:159], v[108:111], a[228:231], v[156:159]
  v_mfma_f32_16x16x32_bf16 v[160:163], v[64:67], a[232:235], v[180:183]
  v_exp_f32 v152, v152
  v_mfma_f32_16x16x32_bf16 v[160:163], v[68:71], a[236:239], v[160:163]
  v_exp_f32 v153, v153
  v_mfma_f32_16x16x32_bf16 v[160:163], v[72:75], a[240:243], v[160:163]
  v_exp_f32 v154, v154
  v_mfma_f32_16x16x32_bf16 v[160:163], v[76:79], a[244:247], v[160:163]
  v_exp_f32 v155, v155
  v_mfma_f32_16x16x32_bf16 v[160:163], v[80:83], a[248:251], v[160:163]
  v_cvt_pk_bf16_f32 v152, v152, v153
  v_cvt_pk_bf16_f32 v153, v154, v155
  v_mfma_f32_16x16x32_bf16 v[160:163], v[84:87], a[252:255], v[160:163]
  v_exp_f32 v156, v156
  v_mfma_f32_16x16x32_bf16 v[164:167], v[88:91], a[232:235], v[180:183]
  v_exp_f32 v157, v157
  v_mfma_f32_16x16x32_bf16 v[164:167], v[92:95], a[236:239], v[164:167]
  v_exp_f32 v158, v158
  v_mfma_f32_16x16x32_bf16 v[164:167], v[96:99], a[240:243], v[164:167]
  v_exp_f32 v159, v159
  v_mfma_f32_16x16x32_bf16 v[164:167], v[100:103], a[244:247], v[164:167]
  v_cvt_pk_bf16_f32 v154, v156, v157
  v_cvt_pk_bf16_f32 v155, v158, v159
  v_mfma_f32_16x16x32_bf16 v[164:167], v[104:107], a[248:251], v[164:167]
  s_waitcnt lgkmcnt(0)
  v_mfma_f32_16x16x32_bf16 v[164:167], v[108:111], a[252:255], v[164:167]
  v_mfma_f32_16x16x32_bf16 a[0:3], v[112:115], v[136:139], a[0:3]
  v_exp_f32 v160, v160
  v_mfma_f32_16x16x32_bf16 a[4:7], v[112:115], v[144:147], a[4:7]
  v_exp_f32 v161, v161
  v_mfma_f32_16x16x32_bf16 a[8:11], v[112:115], v[152:155], a[8:11]
  v_exp_f32 v162, v162
  v_mfma_f32_16x16x32_bf16 a[16:19], v[116:119], v[136:139], a[16:19]
  v_exp_f32 v163, v163
  v_mfma_f32_16x16x32_bf16 a[20:23], v[116:119], v[144:147], a[20:23]
  v_cvt_pk_bf16_f32 v160, v160, v161
  v_cvt_pk_bf16_f32 v161, v162, v163
  v_mfma_f32_16x16x32_bf16 a[24:27], v[116:119], v[152:155], a[24:27]
  v_exp_f32 v164, v164
  v_mfma_f32_16x16x32_bf16 a[32:35], v[120:123], v[136:139], a[32:35]
  v_exp_f32 v165, v165
  v_mfma_f32_16x16x32_bf16 a[36:39], v[120:123], v[144:147], a[36:39]
  v_exp_f32 v166, v166
  v_mfma_f32_16x16x32_bf16 a[40:43], v[120:123], v[152:155], a[40:43]
  v_exp_f32 v167, v167
  v_mfma_f32_16x16x32_bf16 a[48:51], v[124:127], v[136:139], a[48:51]
  v_cvt_pk_bf16_f32 v162, v164, v165
  v_cvt_pk_bf16_f32 v163, v166, v167
  v_mfma_f32_16x16x32_bf16 a[52:55], v[124:127], v[144:147], a[52:55]
  s_waitcnt vmcnt(28)
  v_cmp_eq_u64 vcc, s[88:89], v[2:3]
  s_add_u32 m0, s37, 12288
  v_mfma_f32_16x16x32_bf16 a[56:59], v[124:127], v[152:155], a[56:59]
  s_waitcnt vmcnt(22)
  s_barrier
  v_mfma_f32_16x16x32_bf16 a[192:195], v[12:15], v[136:139], a[192:195]
  s_cbranch_vccz L_slow18
L_ret18:
  buffer_load_dwordx2 v[2:3], v1, s[4:7], s90 offen sc1
  v_mfma_f32_16x16x32_bf16 a[196:199], v[12:15], v[144:147], a[196:199]
  ds_read_b128 v[64:67], v4 offset:36864
  s_mov_b32 s77, s45
  v_mfma_f32_16x16x32_bf16 a[200:203], v[12:15], v[152:155], a[200:203]
  buffer_load_dwordx4 v8, s[4:7], s40 offen offset:0 sc1 lds
  v_mfma_f32_16x16x32_bf16 a[12:15], v[112:115], v[160:163], a[12:15]
  ds_read_b128 v[68:71], v4 offset:37888
  v_mfma_f32_16x16x32_bf16 a[28:31], v[116:119], v[160:163], a[28:31]
  ds_read_b128 v[112:115], v5 offset:26112
  v_mfma_f32_16x16x32_bf16 a[44:47], v[120:123], v[160:163], a[44:47]
  ds_read_b128 v[116:119], v5 offset:26368
  v_mfma_f32_16x16x32_bf16 a[60:63], v[124:127], v[160:163], a[60:63]
  ds_read_b128 v[120:123], v5 offset:26624
  v_mfma_f32_16x16x32_bf16 a[204:207], v[12:15], v[160:163], a[204:207]
  ds_read_b128 v[124:127], v5 offset:26880
  v_mfma_f32_16x16x32_bf16 a[64:67], v[128:131], v[136:139], a[64:67]
  ds_read_b128 v[72:75], v4 offset:38912
  s_mov_b32 s78, s46
  v_mfma_f32_16x16x32_bf16 a[68:71], v[128:131], v[144:147], a[68:71]
  ds_read_b128 v[76:79], v4 offset:39936
  v_mfma_f32_16x16x32_bf16 a[72:75], v[128:131], v[152:155], a[72:75]
  buffer_load_dwordx4 v8, s[4:7], s40 offen offset:1024 sc1 lds
  v_mfma_f32_16x16x32_bf16 a[76:79], v[128:131], v[160:163], a[76:79]
  ds_read_b128 v[80:83], v4 offset:40960
  v_mfma_f32_16x16x32_bf16 a[80:83], v[132:135], v[136:139], a[80:83]
  ds_read_b128 v[128:131], v5 offset:27136
  v_mfma_f32_16x16x32_bf16 a[84:87], v[132:135], v[144:147], a[84:87]
  ds_read_b128 v[84:87], v4 offset:41984
  v_mfma_f32_16x16x32_bf16 a[88:91], v[132:135], v[152:155], a[88:91]
  ds_read_b128 v[88:91], v4 offset:43008
  v_mfma_f32_16x16x32_bf16 a[92:95], v[132:135], v[160:163], a[92:95]
  ds_read_b128 v[92:95], v4 offset:44032
  s_waitcnt lgkmcnt(10)
  v_mfma_f32_16x16x32_bf16 a[96:99], v[112:115], v[136:139], a[96:99]
  ds_read_b128 v[132:135], v5 offset:27392
  s_add_u32 s45, s45, 196608
  v_mfma_f32_16x16x32_bf16 a[100:103], v[112:115], v[144:147], a[100:103]
  ds_read_b128 v[96:99], v4 offset:45056
  v_mfma_f32_16x16x32_bf16 a[104:107], v[112:115], v[152:155], a[104:107]
  buffer_load_dwordx4 v8, s[4:7], s40 offen offset:2048 sc1 lds
  v_mfma_f32_16x16x32_bf16 a[108:111], v[112:115], v[160:163], a[108:111]
  ds_read_b128 v[100:103], v4 offset:46080
  s_waitcnt lgkmcnt(10)
  v_mfma_f32_16x16x32_bf16 a[112:115], v[116:119], v[136:139], a[112:115]
  s_add_u32 m0, s37, 61440
  v_mfma_f32_16x16x32_bf16 a[116:119], v[116:119], v[144:147], a[116:119]
  ds_read_b128 v[104:107], v4 offset:47104
  v_mfma_f32_16x16x32_bf16 a[120:123], v[116:119], v[152:155], a[120:123]
  v_mfma_f32_16x16x32_bf16 a[124:127], v[116:119], v[160:163], a[124:127]
  ds_read_b128 v[108:111], v4 offset:48128
  s_add_u32 s49, s49, 196608
  v_mfma_f32_16x16x32_bf16 a[128:131], v[120:123], v[136:139], a[128:131]
  v_mfma_f32_16x16x32_bf16 a[132:135], v[120:123], v[144:147], a[132:135]
  v_mfma_f32_16x16x32_bf16 a[136:139], v[120:123], v[152:155], a[136:139]
  buffer_load_dwordx4 v9, s[4:7], s40 offen offset:0 sc1 lds
  v_mfma_f32_16x16x32_bf16 a[140:143], v[120:123], v[160:163], a[140:143]
  s_add_u32 s46, s46, 3072
  v_mfma_f32_16x16x32_bf16 a[144:147], v[124:127], v[136:139], a[144:147]
  v_mfma_f32_16x16x32_bf16 a[148:151], v[124:127], v[144:147], a[148:151]
  v_mfma_f32_16x16x32_bf16 a[152:155], v[124:127], v[152:155], a[152:155]
  v_mfma_f32_16x16x32_bf16 a[156:159], v[124:127], v[160:163], a[156:159]
  s_add_u32 s47, s47, 512
  s_waitcnt lgkmcnt(4)
  v_mfma_f32_16x16x32_bf16 a[160:163], v[128:131], v[136:139], a[160:163]
  buffer_load_dwordx4 v9, s[4:7], s40 offen offset:1024 sc1 lds
  v_mfma_f32_16x16x32_bf16 a[164:167], v[128:131], v[144:147], a[164:167]
  v_mfma_f32_16x16x32_bf16 a[168:171], v[128:131], v[152:155], a[168:171]
  v_mfma_f32_16x16x32_bf16 a[172:175], v[128:131], v[160:163], a[172:175]
  v_mfma_f32_16x16x32_bf16 a[176:179], v[132:135], v[136:139], a[176:179]
  v_mfma_f32_16x16x32_bf16 a[180:183], v[132:135], v[144:147], a[180:183]
  v_mfma_f32_16x16x32_bf16 a[184:187], v[132:135], v[152:155], a[184:187]
  buffer_load_dwordx4 v9, s[4:7], s40 offen offset:2048 sc1 lds
  v_mfma_f32_16x16x32_bf16 a[188:191], v[132:135], v[160:163], a[188:191]
  s_mul_i32 s40, s90, 48
  v_mfma_f32_16x16x32_bf16 v[136:139], v[64:67], v[16:19], v[168:171]
  v_mfma_f32_16x16x32_bf16 v[136:139], v[68:71], v[20:23], v[136:139]
  ds_read_b128 v[112:115], v5 offset:36864
  v_mfma_f32_16x16x32_bf16 v[136:139], v[72:75], v[24:27], v[136:139]
  v_mfma_f32_16x16x32_bf16 v[136:139], v[76:79], v[28:31], v[136:139]
  ds_read_b128 v[116:119], v5 offset:37120
  s_waitcnt lgkmcnt(2)
  v_mfma_f32_16x16x32_bf16 v[136:139], v[80:83], v[32:35], v[136:139]
  v_mfma_f32_16x16x32_bf16 v[136:139], v[84:87], v[36:39], v[136:139]
  ds_read_b128 v[120:123], v5 offset:37376
  v_mfma_f32_16x16x32_bf16 v[140:143], v[88:91], v[16:19], v[168:171]
  v_mfma_f32_16x16x32_bf16 v[140:143], v[92:95], v[20:23], v[140:143]
  ds_read_b128 v[124:127], v5 offset:37632
  v_mfma_f32_16x16x32_bf16 v[140:143], v[96:99], v[24:27], v[140:143]
  v_mfma_f32_16x16x32_bf16 v[140:143], v[100:103], v[28:31], v[140:143]
  ds_read_b128 v[128:131], v5 offset:37888
  v_mfma_f32_16x16x32_bf16 v[140:143], v[104:107], v[32:35], v[140:143]
  v_mfma_f32_16x16x32_bf16 v[140:143], v[108:111], v[36:39], v[140:143]
  ds_read_b128 v[132:135], v5 offset:38144
  v_mfma_f32_16x16x32_bf16 v[144:147], v[64:67], v[40:43], v[172:175]
  v_exp_f32 v136, v136
  v_mfma_f32_16x16x32_bf16 v[144:147], v[68:71], v[44:47], v[144:147]
  v_exp_f32 v137, v137
  v_mfma_f32_16x16x32_bf16 v[144:147], v[72:75], v[48:51], v[144:147]
  v_exp_f32 v138, v138
  v_mfma_f32_16x16x32_bf16 v[144:147], v[76:79], v[52:55], v[144:147]
  v_exp_f32 v139, v139
  v_mfma_f32_16x16x32_bf16 v[144:147], v[80:83], v[56:59], v[144:147]
  v_cvt_pk_bf16_f32 v136, v136, v137
  v_cvt_pk_bf16_f32 v137, v138, v139
  v_mfma_f32_16x16x32_bf16 v[144:147], v[84:87], v[60:63], v[144:147]
  v_exp_f32 v140, v140
  v_mfma_f32_16x16x32_bf16 v[148:151], v[88:91], v[40:43], v[172:175]
  v_exp_f32 v141, v141
  v_mfma_f32_16x16x32_bf16 v[148:151], v[92:95], v[44:47], v[148:151]
  v_exp_f32 v142, v142
  v_mfma_f32_16x16x32_bf16 v[148:151], v[96:99], v[48:51], v[148:151]
  v_exp_f32 v143, v143
  v_mfma_f32_16x16x32_bf16 v[148:151], v[100:103], v[52:55], v[148:151]
  v_cvt_pk_bf16_f32 v138, v140, v141
  v_cvt_pk_bf16_f32 v139, v142, v143
  v_mfma_f32_16x16x32_bf16 v[148:151], v[104:107], v[56:59], v[148:151]
  s_add_u32 s3, s3, 512
  v_mfma_f32_16x16x32_bf16 v[148:151], v[108:111], v[60:63], v[148:151]
  s_xor_b32 s90, s3, s76
  v_mfma_f32_16x16x32_bf16 v[152:155], v[64:67], a[208:211], v[176:179]
  v_exp_f32 v144, v144
  v_mfma_f32_16x16x32_bf16 v[152:155], v[68:71], a[212:215], v[152:155]
  v_exp_f32 v145, v145
  v_mfma_f32_16x16x32_bf16 v[152:155], v[72:75], a[216:219], v[152:155]
  v_exp_f32 v146, v146
  v_mfma_f32_16x16x32_bf16 v[152:155], v[76:79], a[220:223], v[152:155]
  v_exp_f32 v147, v147
  v_mfma_f32_16x16x32_bf16 v[152:155], v[80:83], a[224:227], v[152:155]
  v_cvt_pk_bf16_f32 v144, v144, v145
  v_cvt_pk_bf16_f32 v145, v146, v147
  v_mfma_f32_16x16x32_bf16 v[152:155], v[84:87], a[228:231], v[152:155]
  v_exp_f32 v148, v148
  v_mfma_f32_16x16x32_bf16 v[156:159], v[88:91], a[208:211], v[176:179]
  v_exp_f32 v149, v149
  v_mfma_f32_16x16x32_bf16 v[156:159], v[92:95], a[212:215], v[156:159]
  v_exp_f32 v150, v150
  v_mfma_f32_16x16x32_bf16 v[156:159], v[96:99], a[216:219], v[156:159]
  v_exp_f32 v151, v151
  v_mfma_f32_16x16x32_bf16 v[156:159], v[100:103], a[220:223], v[156:159]
  v_cvt_pk_bf16_f32 v146, v148, v149
  v_cvt_pk_bf16_f32 v147, v150, v151
  v_mfma_f32_16x16x32_bf16 v[156:159], v[104:107], a[224:227], v[156:159]
  s_and_b32 s90, s90, 0x7e00
  v_mfma_f32_16x16x32_bf16 v[156:159], v[108:111], a[228:231], v[156:159]
  v_mfma_f32_16x16x32_bf16 v[160:163], v[64:67], a[232:235], v[180:183]
  v_exp_f32 v152, v152
  v_mfma_f32_16x16x32_bf16 v[160:163], v[68:71], a[236:239], v[160:163]
  v_exp_f32 v153, v153
  v_mfma_f32_16x16x32_bf16 v[160:163], v[72:75], a[240:243], v[160:163]
  v_exp_f32 v154, v154
  v_mfma_f32_16x16x32_bf16 v[160:163], v[76:79], a[244:247], v[160:163]
  v_exp_f32 v155, v155
  v_mfma_f32_16x16x32_bf16 v[160:163], v[80:83], a[248:251], v[160:163]
  v_cvt_pk_bf16_f32 v152, v152, v153
  v_cvt_pk_bf16_f32 v153, v154, v155
  v_mfma_f32_16x16x32_bf16 v[160:163], v[84:87], a[252:255], v[160:163]
  v_exp_f32 v156, v156
  v_mfma_f32_16x16x32_bf16 v[164:167], v[88:91], a[232:235], v[180:183]
  v_exp_f32 v157, v157
  v_mfma_f32_16x16x32_bf16 v[164:167], v[92:95], a[236:239], v[164:167]
  v_exp_f32 v158, v158
  v_mfma_f32_16x16x32_bf16 v[164:167], v[96:99], a[240:243], v[164:167]
  v_exp_f32 v159, v159
  v_mfma_f32_16x16x32_bf16 v[164:167], v[100:103], a[244:247], v[164:167]
  v_cvt_pk_bf16_f32 v154, v156, v157
  v_cvt_pk_bf16_f32 v155, v158, v159
  v_mfma_f32_16x16x32_bf16 v[164:167], v[104:107], a[248:251], v[164:167]
  s_waitcnt lgkmcnt(0)
  v_mfma_f32_16x16x32_bf16 v[164:167], v[108:111], a[252:255], v[164:167]
  v_mfma_f32_16x16x32_bf16 a[0:3], v[112:115], v[136:139], a[0:3]
  v_exp_f32 v160, v160
  v_mfma_f32_16x16x32_bf16 a[4:7], v[112:115], v[144:147], a[4:7]
  v_exp_f32 v161, v161
  v_mfma_f32_16x16x32_bf16 a[8:11], v[112:115], v[152:155], a[8:11]
  v_exp_f32 v162, v162
  v_mfma_f32_16x16x32_bf16 a[16:19], v[116:119], v[136:139], a[16:19]
  v_exp_f32 v163, v163
  v_mfma_f32_16x16x32_bf16 a[20:23], v[116:119], v[144:147], a[20:23]
  v_cvt_pk_bf16_f32 v160, v160, v161
  v_cvt_pk_bf16_f32 v161, v162, v163
  v_mfma_f32_16x16x32_bf16 a[24:27], v[116:119], v[152:155], a[24:27]
  v_exp_f32 v164, v164
  v_mfma_f32_16x16x32_bf16 a[32:35], v[120:123], v[136:139], a[32:35]
  v_exp_f32 v165, v165
  v_mfma_f32_16x16x32_bf16 a[36:39], v[120:123], v[144:147], a[36:39]
  v_exp_f32 v166, v166
  v_mfma_f32_16x16x32_bf16 a[40:43], v[120:123], v[152:155], a[40:43]
  v_exp_f32 v167, v167
  v_mfma_f32_16x16x32_bf16 a[48:51], v[124:127], v[136:139], a[48:51]
  v_cvt_pk_bf16_f32 v162, v164, v165
  v_cvt_pk_bf16_f32 v163, v166, v167
  v_mfma_f32_16x16x32_bf16 a[52:55], v[124:127], v[144:147], a[52:55]
  s_waitcnt vmcnt(21)
  v_cmp_eq_u64 vcc, s[88:89], v[6:7]
  s_add_u32 m0, s37, 24576
  v_mfma_f32_16x16x32_bf16 a[56:59], v[124:127], v[152:155], a[56:59]
  s_waitcnt vmcnt(15)
  s_barrier
  v_mfma_f32_16x16x32_bf16 a[192:195], v[12:15], v[136:139], a[192:195]
  s_cbranch_vccz L_slow19
L_ret19:
  v_mov_b32 v188, s88
  v_mov_b32 v189, s89
  buffer_store_dwordx2 v[188:189], v1, s[4:7], s91 offen sc1
  s_add_u32 s91, s91, 4096
  v_mfma_f32_16x16x32_bf16 a[196:199], v[12:15], v[144:147], a[196:199]
  ds_read_b128 v[64:67], v4 offset:0
  v_mfma_f32_16x16x32_bf16 a[200:203], v[12:15], v[152:155], a[200:203]
  buffer_load_dwordx4 v8, s[4:7], s48 offen offset:0 sc1 lds
  v_mfma_f32_16x16x32_bf16 a[12:15], v[112:115], v[160:163], a[12:15]
  ds_read_b128 v[68:71], v4 offset:1024
  v_mfma_f32_16x16x32_bf16 a[28:31], v[116:119], v[160:163], a[28:31]
  ds_read_b128 v[112:115], v5 offset:38400
  v_mfma_f32_16x16x32_bf16 a[44:47], v[120:123], v[160:163], a[44:47]
  ds_read_b128 v[116:119], v5 offset:38656
  v_mfma_f32_16x16x32_bf16 a[60:63], v[124:127], v[160:163], a[60:63]
  ds_read_b128 v[120:123], v5 offset:38912
  v_mfma_f32_16x16x32_bf16 a[204:207], v[12:15], v[160:163], a[204:207]
  ds_read_b128 v[124:127], v5 offset:39168
  v_mfma_f32_16x16x32_bf16 a[64:67], v[128:131], v[136:139], a[64:67]
  ds_read_b128 v[72:75], v4 offset:2048
  v_mfma_f32_16x16x32_bf16 a[68:71], v[128:131], v[144:147], a[68:71]
  ds_read_b128 v[76:79], v4 offset:3072
  v_mfma_f32_16x16x32_bf16 a[72:75], v[128:131], v[152:155], a[72:75]
  buffer_load_dwordx4 v8, s[4:7], s48 offen offset:1024 sc1 lds
  v_mfma_f32_16x16x32_bf16 a[76:79], v[128:131], v[160:163], a[76:79]
  ds_read_b128 v[80:83], v4 offset:4096
  v_mfma_f32_16x16x32_bf16 a[80:83], v[132:135], v[136:139], a[80:83]
  ds_read_b128 v[128:131], v5 offset:39424
  v_mfma_f32_16x16x32_bf16 a[84:87], v[132:135], v[144:147], a[84:87]
  ds_read_b128 v[84:87], v4 offset:5120
  v_mfma_f32_16x16x32_bf16 a[88:91], v[132:135], v[152:155], a[88:91]
  ds_read_b128 v[88:91], v4 offset:6144
  v_mfma_f32_16x16x32_bf16 a[92:95], v[132:135], v[160:163], a[92:95]
  ds_read_b128 v[92:95], v4 offset:7168
  s_waitcnt lgkmcnt(10)
  v_mfma_f32_16x16x32_bf16 a[96:99], v[112:115], v[136:139], a[96:99]
  ds_read_b128 v[132:135], v5 offset:39680
  v_mfma_f32_16x16x32_bf16 a[100:103], v[112:115], v[144:147], a[100:103]
  ds_read_b128 v[96:99], v4 offset:8192
  v_mfma_f32_16x16x32_bf16 a[104:107], v[112:115], v[152:155], a[104:107]
  buffer_load_dwordx4 v8, s[4:7], s48 offen offset:2048 sc1 lds
  v_mfma_f32_16x16x32_bf16 a[108:111], v[112:115], v[160:163], a[108:111]
  ds_read_b128 v[100:103], v4 offset:9216
  s_waitcnt lgkmcnt(10)
  v_mfma_f32_16x16x32_bf16 a[112:115], v[116:119], v[136:139], a[112:115]
  s_add_u32 m0, s37, 73728
  v_mfma_f32_16x16x32_bf16 a[116:119], v[116:119], v[144:147], a[116:119]
  ds_read_b128 v[104:107], v4 offset:10240
  v_mfma_f32_16x16x32_bf16 a[120:123], v[116:119], v[152:155], a[120:123]
  v_mfma_f32_16x16x32_bf16 a[124:127], v[116:119], v[160:163], a[124:127]
  ds_read_b128 v[108:111], v4 offset:11264
  v_mfma_f32_16x16x32_bf16 a[128:131], v[120:123], v[136:139], a[128:131]
  v_mfma_f32_16x16x32_bf16 a[132:135], v[120:123], v[144:147], a[132:135]
  v_mfma_f32_16x16x32_bf16 a[136:139], v[120:123], v[152:155], a[136:139]
  buffer_load_dwordx4 v9, s[4:7], s48 offen offset:0 sc1 lds
  v_mfma_f32_16x16x32_bf16 a[140:143], v[120:123], v[160:163], a[140:143]
  v_mfma_f32_16x16x32_bf16 a[144:147], v[124:127], v[136:139], a[144:147]
  v_mfma_f32_16x16x32_bf16 a[148:151], v[124:127], v[144:147], a[148:151]
  v_mfma_f32_16x16x32_bf16 a[152:155], v[124:127], v[152:155], a[152:155]
  v_mfma_f32_16x16x32_bf16 a[156:159], v[124:127], v[160:163], a[156:159]
  s_waitcnt lgkmcnt(4)
  v_mfma_f32_16x16x32_bf16 a[160:163], v[128:131], v[136:139], a[160:163]
  buffer_load_dwordx4 v9, s[4:7], s48 offen offset:1024 sc1 lds
  v_mfma_f32_16x16x32_bf16 a[164:167], v[128:131], v[144:147], a[164:167]
  v_mfma_f32_16x16x32_bf16 a[168:171], v[128:131], v[152:155], a[168:171]
  v_mfma_f32_16x16x32_bf16 a[172:175], v[128:131], v[160:163], a[172:175]
  v_mfma_f32_16x16x32_bf16 a[176:179], v[132:135], v[136:139], a[176:179]
  v_mfma_f32_16x16x32_bf16 a[180:183], v[132:135], v[144:147], a[180:183]
  v_mfma_f32_16x16x32_bf16 a[184:187], v[132:135], v[152:155], a[184:187]
  buffer_load_dwordx4 v9, s[4:7], s48 offen offset:2048 sc1 lds
  v_mfma_f32_16x16x32_bf16 a[188:191], v[132:135], v[160:163], a[188:191]
  s_mul_i32 s48, s90, 48
  s_sub_u32 s41, s41, 1
  s_cmp_lg_u32 s41, 0
  s_cbranch_scc1 L_loopB
  s_mov_b32 s41, 3
.p2align 6
L_loopC:
  v_mfma_f32_16x16x32_bf16 v[136:139], v[64:67], v[16:19], v[168:171]
  v_mfma_f32_16x16x32_bf16 v[136:139], v[68:71], v[20:23], v[136:139]
  ds_read_b128 v[112:115], v5 offset:0
  v_mfma_f32_16x16x32_bf16 v[136:139], v[72:75], v[24:27], v[136:139]
  v_mfma_f32_16x16x32_bf16 v[136:139], v[76:79], v[28:31], v[136:139]
  ds_read_b128 v[116:119], v5 offset:256
  s_waitcnt lgkmcnt(2)
  v_mfma_f32_16x16x32_bf16 v[136:139], v[80:83], v[32:35], v[136:139]
  v_mfma_f32_16x16x32_bf16 v[136:139], v[84:87], v[36:39], v[136:139]
  ds_read_b128 v[120:123], v5 offset:512
  v_mfma_f32_16x16x32_bf16 v[140:143], v[88:91], v[16:19], v[168:171]
  v_mfma_f32_16x16x32_bf16 v[140:143], v[92:95], v[20:23], v[140:143]
  ds_read_b128 v[124:127], v5 offset:768
  v_mfma_f32_16x16x32_bf16 v[140:143], v[96:99], v[24:27], v[140:143]
  v_mfma_f32_16x16x32_bf16 v[140:143], v[100:103], v[28:31], v[140:143]
  ds_read_b128 v[128:131], v5 offset:1024
  v_mfma_f32_16x16x32_bf16 v[140:143], v[104:107], v[32:35], v[140:143]
  v_mfma_f32_16x16x32_bf16 v[140:143], v[108:111], v[36:39], v[140:143]
  ds_read_b128 v[132:135], v5 offset:1280
  v_mfma_f32_16x16x32_bf16 v[144:147], v[64:67], v[40:43], v[172:175]
  v_exp_f32 v136, v136
  v_mfma_f32_16x16x32_bf16 v[144:147], v[68:71], v[44:47], v[144:147]
  v_exp_f32 v137, v137
  v_mfma_f32_16x16x32_bf16 v[144:147], v[72:75], v[48:51], v[144:147]
  v_exp_f32 v138, v138
  v_mfma_f32_16x16x32_bf16 v[144:147], v[76:79], v[52:55], v[144:147]
  v_exp_f32 v139, v139
  v_mfma_f32_16x16x32_bf16 v[144:147], v[80:83], v[56:59], v[144:147]
  v_cvt_pk_bf16_f32 v136, v136, v137
  v_cvt_pk_bf16_f32 v137, v138, v139
  v_mfma_f32_16x16x32_bf16 v[144:147], v[84:87], v[60:63], v[144:147]
  v_exp_f32 v140, v140
  v_mfma_f32_16x16x32_bf16 v[148:151], v[88:91], v[40:43], v[172:175]
  v_exp_f32 v141, v141
  v_mfma_f32_16x16x32_bf16 v[148:151], v[92:95], v[44:47], v[148:151]
  v_exp_f32 v142, v142
  v_mfma_f32_16x16x32_bf16 v[148:151], v[96:99], v[48:51], v[148:151]
  v_exp_f32 v143, v143
  v_mfma_f32_16x16x32_bf16 v[148:151], v[100:103], v[52:55], v[148:151]
  v_cvt_pk_bf16_f32 v138, v140, v141
  v_cvt_pk_bf16_f32 v139, v142, v143
  v_mfma_f32_16x16x32_bf16 v[148:151], v[104:107], v[56:59], v[148:151]
  s_add_u32 s3, s3, 512
  v_mfma_f32_16x16x32_bf16 v[148:151], v[108:111], v[60:63], v[148:151]
  s_xor_b32 s90, s3, s76
  v_mfma_f32_16x16x32_bf16 v[152:155], v[64:67], a[208:211], v[176:179]
  v_exp_f32 v144, v144
  v_mfma_f32_16x16x32_bf16 v[152:155], v[68:71], a[212:215], v[152:155]
  v_exp_f32 v145, v145
  v_mfma_f32_16x16x32_bf16 v[152:155], v[72:75], a[216:219], v[152:155]
  v_exp_f32 v146, v146
  v_mfma_f32_16x16x32_bf16 v[152:155], v[76:79], a[220:223], v[152:155]
  v_exp_f32 v147, v147
  v_mfma_f32_16x16x32_bf16 v[152:155], v[80:83], a[224:227], v[152:155]
  v_cvt_pk_bf16_f32 v144, v144, v145
  v_cvt_pk_bf16_f32 v145, v146, v147
  v_mfma_f32_16x16x32_bf16 v[152:155], v[84:87], a[228:231], v[152:155]
  v_exp_f32 v148, v148
  v_mfma_f32_16x16x32_bf16 v[156:159], v[88:91], a[208:211], v[176:179]
  v_exp_f32 v149, v149
  v_mfma_f32_16x16x32_bf16 v[156:159], v[92:95], a[212:215], v[156:159]
  v_exp_f32 v150, v150
  v_mfma_f32_16x16x32_bf16 v[156:159], v[96:99], a[216:219], v[156:159]
  v_exp_f32 v151, v151
  v_mfma_f32_16x16x32_bf16 v[156:159], v[100:103], a[220:223], v[156:159]
  v_cvt_pk_bf16_f32 v146, v148, v149
  v_cvt_pk_bf16_f32 v147, v150, v151
  v_mfma_f32_16x16x32_bf16 v[156:159], v[104:107], a[224:227], v[156:159]
  s_and_b32 s90, s90, 0x7e00
  v_mfma_f32_16x16x32_bf16 v[156:159], v[108:111], a[228:231], v[156:159]
  v_mfma_f32_16x16x32_bf16 v[160:163], v[64:67], a[232:235], v[180:183]
  v_exp_f32 v152, v152
  v_mfma_f32_16x16x32_bf16 v[160:163], v[68:71], a[236:239], v[160:163]
  v_exp_f32 v153, v153
  v_mfma_f32_16x16x32_bf16 v[160:163], v[72:75], a[240:243], v[160:163]
  v_exp_f32 v154, v154
  v_mfma_f32_16x16x32_bf16 v[160:163], v[76:79], a[244:247], v[160:163]
  v_exp_f32 v155, v155
  v_mfma_f32_16x16x32_bf16 v[160:163], v[80:83], a[248:251], v[160:163]
  v_cvt_pk_bf16_f32 v152, v152, v153
  v_cvt_pk_bf16_f32 v153, v154, v155
  v_mfma_f32_16x16x32_bf16 v[160:163], v[84:87], a[252:255], v[160:163]
  v_exp_f32 v156, v156
  v_mfma_f32_16x16x32_bf16 v[164:167], v[88:91], a[232:235], v[180:183]
  v_exp_f32 v157, v157
  v_mfma_f32_16x16x32_bf16 v[164:167], v[92:95], a[236:239], v[164:167]
  v_exp_f32 v158, v158
  v_mfma_f32_16x16x32_bf16 v[164:167], v[96:99], a[240:243], v[164:167]
  v_exp_f32 v159, v159
  v_mfma_f32_16x16x32_bf16 v[164:167], v[100:103], a[244:247], v[164:167]
  v_cvt_pk_bf16_f32 v154, v156, v157
  v_cvt_pk_bf16_f32 v155, v158, v159
  v_mfma_f32_16x16x32_bf16 v[164:167], v[104:107], a[248:251], v[164:167]
  s_waitcnt lgkmcnt(0)
  v_mfma_f32_16x16x32_bf16 v[164:167], v[108:111], a[252:255], v[164:167]
  v_mfma_f32_16x16x32_bf16 a[0:3], v[112:115], v[136:139], a[0:3]
  v_exp_f32 v160, v160
  v_mfma_f32_16x16x32_bf16 a[4:7], v[112:115], v[144:147], a[4:7]
  v_exp_f32 v161, v161
  v_mfma_f32_16x16x32_bf16 a[8:11], v[112:115], v[152:155], a[8:11]
  v_exp_f32 v162, v162
  v_mfma_f32_16x16x32_bf16 a[16:19], v[116:119], v[136:139], a[16:19]
  v_exp_f32 v163, v163
  v_mfma_f32_16x16x32_bf16 a[20:23], v[116:119], v[144:147], a[20:23]
  v_cvt_pk_bf16_f32 v160, v160, v161
  v_cvt_pk_bf16_f32 v161, v162, v163
  v_mfma_f32_16x16x32_bf16 a[24:27], v[116:119], v[152:155], a[24:27]
  v_exp_f32 v164, v164
  v_mfma_f32_16x16x32_bf16 a[32:35], v[120:123], v[136:139], a[32:35]
  v_exp_f32 v165, v165
  v_mfma_f32_16x16x32_bf16 a[36:39], v[120:123], v[144:147], a[36:39]
  v_exp_f32 v166, v166
  v_mfma_f32_16x16x32_bf16 a[40:43], v[120:123], v[152:155], a[40:43]
  v_exp_f32 v167, v167
  v_mfma_f32_16x16x32_bf16 a[48:51], v[124:127], v[136:139], a[48:51]
  v_cvt_pk_bf16_f32 v162, v164, v165
  v_cvt_pk_bf16_f32 v163, v166, v167
  v_mfma_f32_16x16x32_bf16 a[52:55], v[124:127], v[144:147], a[52:55]
  s_waitcnt vmcnt(13)
  v_cmp_eq_u64 vcc, s[88:89], v[2:3]
  s_add_u32 m0, s37, 36864
  v_mfma_f32_16x16x32_bf16 a[56:59], v[124:127], v[152:155], a[56:59]
  s_waitcnt vmcnt(7)
  s_barrier
  v_mfma_f32_16x16x32_bf16 a[192:195], v[12:15], v[136:139], a[192:195]
  s_cbranch_vccz L_slow20
L_ret20:
  buffer_load_dwordx2 v[2:3], v1, s[4:7], s90 offen sc1
  v_mfma_f32_16x16x32_bf16 a[196:199], v[12:15], v[144:147], a[196:199]
  ds_read_b128 v[64:67], v4 offset:12288
  v_mfma_f32_16x16x32_bf16 a[200:203], v[12:15], v[152:155], a[200:203]
  buffer_load_dwordx4 v8, s[4:7], s40 offen offset:0 sc1 lds
  v_mfma_f32_16x16x32_bf16 a[12:15], v[112:115], v[160:163], a[12:15]
  ds_read_b128 v[68:71], v4 offset:13312
  v_mfma_f32_16x16x32_bf16 a[28:31], v[116:119], v[160:163], a[28:31]
  ds_read_b128 v[112:115], v5 offset:1536
  v_mfma_f32_16x16x32_bf16 a[44:47], v[120:123], v[160:163], a[44:47]
  ds_read_b128 v[116:119], v5 offset:1792
  v_mfma_f32_16x16x32_bf16 a[60:63], v[124:127], v[160:163], a[60:63]
  ds_read_b128 v[120:123], v5 offset:2048
  v_mfma_f32_16x16x32_bf16 a[204:207], v[12:15], v[160:163], a[204:207]
  ds_read_b128 v[124:127], v5 offset:2304
  v_mfma_f32_16x16x32_bf16 a[64:67], v[128:131], v[136:139], a[64:67]
  ds_read_b128 v[72:75], v4 offset:14336
  v_mfma_f32_16x16x32_bf16 a[68:71], v[128:131], v[144:147], a[68:71]
  ds_read_b128 v[76:79], v4 offset:15360
  v_mfma_f32_16x16x32_bf16 a[72:75], v[128:131], v[152:155], a[72:75]
  buffer_load_dwordx4 v8, s[4:7], s40 offen offset:1024 sc1 lds
  v_mfma_f32_16x16x32_bf16 a[76:79], v[128:131], v[160:163], a[76:79]
  ds_read_b128 v[80:83], v4 offset:16384
  v_mfma_f32_16x16x32_bf16 a[80:83], v[132:135], v[136:139], a[80:83]
  ds_read_b128 v[128:131], v5 offset:2560
  v_mfma_f32_16x16x32_bf16 a[84:87], v[132:135], v[144:147], a[84:87]
  ds_read_b128 v[84:87], v4 offset:17408
  v_mfma_f32_16x16x32_bf16 a[88:91], v[132:135], v[152:155], a[88:91]
  ds_read_b128 v[88:91], v4 offset:18432
  v_mfma_f32_16x16x32_bf16 a[92:95], v[132:135], v[160:163], a[92:95]
  ds_read_b128 v[92:95], v4 offset:19456
  s_waitcnt lgkmcnt(10)
  v_mfma_f32_16x16x32_bf16 a[96:99], v[112:115], v[136:139], a[96:99]
  ds_read_b128 v[132:135], v5 offset:2816
  v_mfma_f32_16x16x32_bf16 a[100:103], v[112:115], v[144:147], a[100:103]
  ds_read_b128 v[96:99], v4 offset:20480
  v_mfma_f32_16x16x32_bf16 a[104:107], v[112:115], v[152:155], a[104:107]
  buffer_load_dwordx4 v8, s[4:7], s40 offen offset:2048 sc1 lds
  v_mfma_f32_16x16x32_bf16 a[108:111], v[112:115], v[160:163], a[108:111]
  ds_read_b128 v[100:103], v4 offset:21504
  s_waitcnt lgkmcnt(10)
  v_mfma_f32_16x16x32_bf16 a[112:115], v[116:119], v[136:139], a[112:115]
  s_add_u32 m0, s37, 86016
  v_mfma_f32_16x16x32_bf16 a[116:119], v[116:119], v[144:147], a[116:119]
  ds_read_b128 v[104:107], v4 offset:22528
  v_mfma_f32_16x16x32_bf16 a[120:123], v[116:119], v[152:155], a[120:123]
  v_mfma_f32_16x16x32_bf16 a[124:127], v[116:119], v[160:163], a[124:127]
  ds_read_b128 v[108:111], v4 offset:23552
  v_mfma_f32_16x16x32_bf16 a[128:131], v[120:123], v[136:139], a[128:131]
  v_mfma_f32_16x16x32_bf16 a[132:135], v[120:123], v[144:147], a[132:135]
  v_mfma_f32_16x16x32_bf16 a[136:139], v[120:123], v[152:155], a[136:139]
  buffer_load_dwordx4 v9, s[4:7], s40 offen offset:0 sc1 lds
  v_mfma_f32_16x16x32_bf16 a[140:143], v[120:123], v[160:163], a[140:143]
  v_mfma_f32_16x16x32_bf16 a[144:147], v[124:127], v[136:139], a[144:147]
  v_mfma_f32_16x16x32_bf16 a[148:151], v[124:127], v[144:147], a[148:151]
  v_mfma_f32_16x16x32_bf16 a[152:155], v[124:127], v[152:155], a[152:155]
  v_mfma_f32_16x16x32_bf16 a[156:159], v[124:127], v[160:163], a[156:159]
  s_waitcnt lgkmcnt(4)
  v_mfma_f32_16x16x32_bf16 a[160:163], v[128:131], v[136:139], a[160:163]
  buffer_load_dwordx4 v9, s[4:7], s40 offen offset:1024 sc1 lds
  v_mfma_f32_16x16x32_bf16 a[164:167], v[128:131], v[144:147], a[164:167]
  v_mfma_f32_16x16x32_bf16 a[168:171], v[128:131], v[152:155], a[168:171]
  v_mfma_f32_16x16x32_bf16 a[172:175], v[128:131], v[160:163], a[172:175]
  v_mfma_f32_16x16x32_bf16 a[176:179], v[132:135], v[136:139], a[176:179]
  v_mfma_f32_16x16x32_bf16 a[180:183], v[132:135], v[144:147], a[180:183]
  v_mfma_f32_16x16x32_bf16 a[184:187], v[132:135], v[152:155], a[184:187]
  buffer_load_dwordx4 v9, s[4:7], s40 offen offset:2048 sc1 lds
  v_mfma_f32_16x16x32_bf16 a[188:191], v[132:135], v[160:163], a[188:191]
  s_mul_i32 s40, s90, 48
  v_mfma_f32_16x16x32_bf16 v[136:139], v[64:67], v[16:19], v[168:171]
  v_mfma_f32_16x16x32_bf16 v[136:139], v[68:71], v[20:23], v[136:139]
  ds_read_b128 v[112:115], v5 offset:12288
  v_mfma_f32_16x16x32_bf16 v[136:139], v[72:75], v[24:27], v[136:139]
  v_mfma_f32_16x16x32_bf16 v[136:139], v[76:79], v[28:31], v[136:139]
  ds_read_b128 v[116:119], v5 offset:12544
  s_waitcnt lgkmcnt(2)
  v_mfma_f32_16x16x32_bf16 v[136:139], v[80:83], v[32:35], v[136:139]
  v_mfma_f32_16x16x32_bf16 v[136:139], v[84:87], v[36:39], v[136:139]
  ds_read_b128 v[120:123], v5 offset:12800
  v_mfma_f32_16x16x32_bf16 v[140:143], v[88:91], v[16:19], v[168:171]
  v_mfma_f32_16x16x32_bf16 v[140:143], v[92:95], v[20:23], v[140:143]
  ds_read_b128 v[124:127], v5 offset:13056
  v_mfma_f32_16x16x32_bf16 v[140:143], v[96:99], v[24:27], v[140:143]
  v_mfma_f32_16x16x32_bf16 v[140:143], v[100:103], v[28:31], v[140:143]
  ds_read_b128 v[128:131], v5 offset:13312
  v_mfma_f32_16x16x32_bf16 v[140:143], v[104:107], v[32:35], v[140:143]
  v_mfma_f32_16x16x32_bf16 v[140:143], v[108:111], v[36:39], v[140:143]
  ds_read_b128 v[132:135], v5 offset:13568
  v_mfma_f32_16x16x32_bf16 v[144:147], v[64:67], v[40:43], v[172:175]
  v_exp_f32 v136, v136
  v_mfma_f32_16x16x32_bf16 v[144:147], v[68:71], v[44:47], v[144:147]
  v_exp_f32 v137, v137
  v_mfma_f32_16x16x32_bf16 v[144:147], v[72:75], v[48:51], v[144:147]
  v_exp_f32 v138, v138
  v_mfma_f32_16x16x32_bf16 v[144:147], v[76:79], v[52:55], v[144:147]
  v_exp_f32 v139, v139
  v_mfma_f32_16x16x32_bf16 v[144:147], v[80:83], v[56:59], v[144:147]
  v_cvt_pk_bf16_f32 v136, v136, v137
  v_cvt_pk_bf16_f32 v137, v138, v139
  v_mfma_f32_16x16x32_bf16 v[144:147], v[84:87], v[60:63], v[144:147]
  v_exp_f32 v140, v140
  v_mfma_f32_16x16x32_bf16 v[148:151], v[88:91], v[40:43], v[172:175]
  v_exp_f32 v141, v141
  v_mfma_f32_16x16x32_bf16 v[148:151], v[92:95], v[44:47], v[148:151]
  v_exp_f32 v142, v142
  v_mfma_f32_16x16x32_bf16 v[148:151], v[96:99], v[48:51], v[148:151]
  v_exp_f32 v143, v143
  v_mfma_f32_16x16x32_bf16 v[148:151], v[100:103], v[52:55], v[148:151]
  v_cvt_pk_bf16_f32 v138, v140, v141
  v_cvt_pk_bf16_f32 v139, v142, v143
  v_mfma_f32_16x16x32_bf16 v[148:151], v[104:107], v[56:59], v[148:151]
  s_add_u32 s3, s3, 512
  v_mfma_f32_16x16x32_bf16 v[148:151], v[108:111], v[60:63], v[148:151]
  s_xor_b32 s90, s3, s76
  v_mfma_f32_16x16x32_bf16 v[152:155], v[64:67], a[208:211], v[176:179]
  v_exp_f32 v144, v144
  v_mfma_f32_16x16x32_bf16 v[152:155], v[68:71], a[212:215], v[152:155]
  v_exp_f32 v145, v145
  v_mfma_f32_16x16x32_bf16 v[152:155], v[72:75], a[216:219], v[152:155]
  v_exp_f32 v146, v146
  v_mfma_f32_16x16x32_bf16 v[152:155], v[76:79], a[220:223], v[152:155]
  v_exp_f32 v147, v147
  v_mfma_f32_16x16x32_bf16 v[152:155], v[80:83], a[224:227], v[152:155]
  v_cvt_pk_bf16_f32 v144, v144, v145
  v_cvt_pk_bf16_f32 v145, v146, v147
  v_mfma_f32_16x16x32_bf16 v[152:155], v[84:87], a[228:231], v[152:155]
  v_exp_f32 v148, v148
  v_mfma_f32_16x16x32_bf16 v[156:159], v[88:91], a[208:211], v[176:179]
  v_exp_f32 v149, v149
  v_mfma_f32_16x16x32_bf16 v[156:159], v[92:95], a[212:215], v[156:159]
  v_exp_f32 v150, v150
  v_mfma_f32_16x16x32_bf16 v[156:159], v[96:99], a[216:219], v[156:159]
  v_exp_f32 v151, v151
  v_mfma_f32_16x16x32_bf16 v[156:159], v[100:103], a[220:223], v[156:159]
  v_cvt_pk_bf16_f32 v146, v148, v149
  v_cvt_pk_bf16_f32 v147, v150, v151
  v_mfma_f32_16x16x32_bf16 v[156:159], v[104:107], a[224:227], v[156:159]
  s_and_b32 s90, s90, 0x7e00
  v_mfma_f32_16x16x32_bf16 v[156:159], v[108:111], a[228:231], v[156:159]
  v_mfma_f32_16x16x32_bf16 v[160:163], v[64:67], a[232:235], v[180:183]
  v_exp_f32 v152, v152
  v_mfma_f32_16x16x32_bf16 v[160:163], v[68:71], a[236:239], v[160:163]
  v_exp_f32 v153, v153
  v_mfma_f32_16x16x32_bf16 v[160:163], v[72:75], a[240:243], v[160:163]
  v_exp_f32 v154, v154
  v_mfma_f32_16x16x32_bf16 v[160:163], v[76:79], a[244:247], v[160:163]
  v_exp_f32 v155, v155
  v_mfma_f32_16x16x32_bf16 v[160:163], v[80:83], a[248:251], v[160:163]
  v_cvt_pk_bf16_f32 v152, v152, v153
  v_cvt_pk_bf16_f32 v153, v154, v155
  v_mfma_f32_16x16x32_bf16 v[160:163], v[84:87], a[252:255], v[160:163]
  v_exp_f32 v156, v156
  v_mfma_f32_16x16x32_bf16 v[164:167], v[88:91], a[232:235], v[180:183]
  v_exp_f32 v157, v157
  v_mfma_f32_16x16x32_bf16 v[164:167], v[92:95], a[236:239], v[164:167]
  v_exp_f32 v158, v158
  v_mfma_f32_16x16x32_bf16 v[164:167], v[96:99], a[240:243], v[164:167]
  v_exp_f32 v159, v159
  v_mfma_f32_16x16x32_bf16 v[164:167], v[100:103], a[244:247], v[164:167]
  v_cvt_pk_bf16_f32 v154, v156, v157
  v_cvt_pk_bf16_f32 v155, v158, v159
  v_mfma_f32_16x16x32_bf16 v[164:167], v[104:107], a[248:251], v[164:167]
  s_waitcnt lgkmcnt(0)
  v_mfma_f32_16x16x32_bf16 v[164:167], v[108:111], a[252:255], v[164:167]
  v_mfma_f32_16x16x32_bf16 a[0:3], v[112:115], v[136:139], a[0:3]
  v_exp_f32 v160, v160
  v_mfma_f32_16x16x32_bf16 a[4:7], v[112:115], v[144:147], a[4:7]
  v_exp_f32 v161, v161
  v_mfma_f32_16x16x32_bf16 a[8:11], v[112:115], v[152:155], a[8:11]
  v_exp_f32 v162, v162
  v_mfma_f32_16x16x32_bf16 a[16:19], v[116:119], v[136:139], a[16:19]
  v_exp_f32 v163, v163
  v_mfma_f32_16x16x32_bf16 a[20:23], v[116:119], v[144:147], a[20:23]
  v_cvt_pk_bf16_f32 v160, v160, v161
  v_cvt_pk_bf16_f32 v161, v162, v163
  v_mfma_f32_16x16x32_bf16 a[24:27], v[116:119], v[152:155], a[24:27]
  v_exp_f32 v164, v164
  v_mfma_f32_16x16x32_bf16 a[32:35], v[120:123], v[136:139], a[32:35]
  v_exp_f32 v165, v165
  v_mfma_f32_16x16x32_bf16 a[36:39], v[120:123], v[144:147], a[36:39]
  v_exp_f32 v166, v166
  v_mfma_f32_16x16x32_bf16 a[40:43], v[120:123], v[152:155], a[40:43]
  v_exp_f32 v167, v167
  v_mfma_f32_16x16x32_bf16 a[48:51], v[124:127], v[136:139], a[48:51]
  v_cvt_pk_bf16_f32 v162, v164, v165
  v_cvt_pk_bf16_f32 v163, v166, v167
  v_mfma_f32_16x16x32_bf16 a[52:55], v[124:127], v[144:147], a[52:55]
  s_waitcnt vmcnt(13)
  v_cmp_eq_u64 vcc, s[88:89], v[6:7]
  s_add_u32 m0, s37, 0
  v_mfma_f32_16x16x32_bf16 a[56:59], v[124:127], v[152:155], a[56:59]
  s_waitcnt vmcnt(7)
  s_barrier
  v_mfma_f32_16x16x32_bf16 a[192:195], v[12:15], v[136:139], a[192:195]
  s_cbranch_vccz L_slow21
L_ret21:
  buffer_load_dwordx2 v[6:7], v1, s[4:7], s90 offen sc1
  v_mfma_f32_16x16x32_bf16 a[196:199], v[12:15], v[144:147], a[196:199]
  ds_read_b128 v[64:67], v4 offset:24576
  v_mfma_f32_16x16x32_bf16 a[200:203], v[12:15], v[152:155], a[200:203]
  buffer_load_dwordx4 v8, s[4:7], s48 offen offset:0 sc1 lds
  v_mfma_f32_16x16x32_bf16 a[12:15], v[112:115], v[160:163], a[12:15]
  ds_read_b128 v[68:71], v4 offset:25600
  v_mfma_f32_16x16x32_bf16 a[28:31], v[116:119], v[160:163], a[28:31]
  ds_read_b128 v[112:115], v5 offset:13824
  v_mfma_f32_16x16x32_bf16 a[44:47], v[120:123], v[160:163], a[44:47]
  ds_read_b128 v[116:119], v5 offset:14080
  v_mfma_f32_16x16x32_bf16 a[60:63], v[124:127], v[160:163], a[60:63]
  ds_read_b128 v[120:123], v5 offset:14336
  v_mfma_f32_16x16x32_bf16 a[204:207], v[12:15], v[160:163], a[204:207]
  ds_read_b128 v[124:127], v5 offset:14592
  v_mfma_f32_16x16x32_bf16 a[64:67], v[128:131], v[136:139], a[64:67]
  ds_read_b128 v[72:75], v4 offset:26624
  v_mfma_f32_16x16x32_bf16 a[68:71], v[128:131], v[144:147], a[68:71]
  ds_read_b128 v[76:79], v4 offset:27648
  v_mfma_f32_16x16x32_bf16 a[72:75], v[128:131], v[152:155], a[72:75]
  buffer_load_dwordx4 v8, s[4:7], s48 offen offset:1024 sc1 lds
  v_mfma_f32_16x16x32_bf16 a[76:79], v[128:131], v[160:163], a[76:79]
  ds_read_b128 v[80:83], v4 offset:28672
  v_mfma_f32_16x16x32_bf16 a[80:83], v[132:135], v[136:139], a[80:83]
  ds_read_b128 v[128:131], v5 offset:14848
  v_mfma_f32_16x16x32_bf16 a[84:87], v[132:135], v[144:147], a[84:87]
  ds_read_b128 v[84:87], v4 offset:29696
  v_mfma_f32_16x16x32_bf16 a[88:91], v[132:135], v[152:155], a[88:91]
  ds_read_b128 v[88:91], v4 offset:30720
  v_mfma_f32_16x16x32_bf16 a[92:95], v[132:135], v[160:163], a[92:95]
  ds_read_b128 v[92:95], v4 offset:31744
  s_waitcnt lgkmcnt(10)
  v_mfma_f32_16x16x32_bf16 a[96:99], v[112:115], v[136:139], a[96:99]
  ds_read_b128 v[132:135], v5 offset:15104
  v_mfma_f32_16x16x32_bf16 a[100:103], v[112:115], v[144:147], a[100:103]
  ds_read_b128 v[96:99], v4 offset:32768
  v_mfma_f32_16x16x32_bf16 a[104:107], v[112:115], v[152:155], a[104:107]
  buffer_load_dwordx4 v8, s[4:7], s48 offen offset:2048 sc1 lds
  v_mfma_f32_16x16x32_bf16 a[108:111], v[112:115], v[160:163], a[108:111]
  ds_read_b128 v[100:103], v4 offset:33792
  s_waitcnt lgkmcnt(10)
  v_mfma_f32_16x16x32_bf16 a[112:115], v[116:119], v[136:139], a[112:115]
  s_add_u32 m0, s37, 49152
  v_mfma_f32_16x16x32_bf16 a[116:119], v[116:119], v[144:147], a[116:119]
  ds_read_b128 v[104:107], v4 offset:34816
  v_mfma_f32_16x16x32_bf16 a[120:123], v[116:119], v[152:155], a[120:123]
  v_mfma_f32_16x16x32_bf16 a[124:127], v[116:119], v[160:163], a[124:127]
  ds_read_b128 v[108:111], v4 offset:35840
  v_mfma_f32_16x16x32_bf16 a[128:131], v[120:123], v[136:139], a[128:131]
  v_mfma_f32_16x16x32_bf16 a[132:135], v[120:123], v[144:147], a[132:135]
  v_mfma_f32_16x16x32_bf16 a[136:139], v[120:123], v[152:155], a[136:139]
  buffer_load_dwordx4 v9, s[4:7], s48 offen offset:0 sc1 lds
  v_mfma_f32_16x16x32_bf16 a[140:143], v[120:123], v[160:163], a[140:143]
  v_mfma_f32_16x16x32_bf16 a[144:147], v[124:127], v[136:139], a[144:147]
  v_mfma_f32_16x16x32_bf16 a[148:151], v[124:127], v[144:147], a[148:151]
  v_mfma_f32_16x16x32_bf16 a[152:155], v[124:127], v[152:155], a[152:155]
  v_mfma_f32_16x16x32_bf16 a[156:159], v[124:127], v[160:163], a[156:159]
  s_waitcnt lgkmcnt(4)
  v_mfma_f32_16x16x32_bf16 a[160:163], v[128:131], v[136:139], a[160:163]
  buffer_load_dwordx4 v9, s[4:7], s48 offen offset:1024 sc1 lds
  v_mfma_f32_16x16x32_bf16 a[164:167], v[128:131], v[144:147], a[164:167]
  v_mfma_f32_16x16x32_bf16 a[168:171], v[128:131], v[152:155], a[168:171]
  v_mfma_f32_16x16x32_bf16 a[172:175], v[128:131], v[160:163], a[172:175]
  v_mfma_f32_16x16x32_bf16 a[176:179], v[132:135], v[136:139], a[176:179]
  v_mfma_f32_16x16x32_bf16 a[180:183], v[132:135], v[144:147], a[180:183]
  v_mfma_f32_16x16x32_bf16 a[184:187], v[132:135], v[152:155], a[184:187]
  buffer_load_dwordx4 v9, s[4:7], s48 offen offset:2048 sc1 lds
  v_mfma_f32_16x16x32_bf16 a[188:191], v[132:135], v[160:163], a[188:191]
  s_mul_i32 s48, s90, 48
  v_mfma_f32_16x16x32_bf16 v[136:139], v[64:67], v[16:19], v[168:171]
  v_mfma_f32_16x16x32_bf16 v[136:139], v[68:71], v[20:23], v[136:139]
  ds_read_b128 v[112:115], v5 offset:24576
  v_mfma_f32_16x16x32_bf16 v[136:139], v[72:75], v[24:27], v[136:139]
  v_mfma_f32_16x16x32_bf16 v[136:139], v[76:79], v[28:31], v[136:139]
  ds_read_b128 v[116:119], v5 offset:24832
  s_waitcnt lgkmcnt(2)
  v_mfma_f32_16x16x32_bf16 v[136:139], v[80:83], v[32:35], v[136:139]
  v_mfma_f32_16x16x32_bf16 v[136:139], v[84:87], v[36:39], v[136:139]
  ds_read_b128 v[120:123], v5 offset:25088
  v_mfma_f32_16x16x32_bf16 v[140:143], v[88:91], v[16:19], v[168:171]
  v_mfma_f32_16x16x32_bf16 v[140:143], v[92:95], v[20:23], v[140:143]
  ds_read_b128 v[124:127], v5 offset:25344
  v_mfma_f32_16x16x32_bf16 v[140:143], v[96:99], v[24:27], v[140:143]
  v_mfma_f32_16x16x32_bf16 v[140:143], v[100:103], v[28:31], v[140:143]
  ds_read_b128 v[128:131], v5 offset:25600
  v_mfma_f32_16x16x32_bf16 v[140:143], v[104:107], v[32:35], v[140:143]
  v_mfma_f32_16x16x32_bf16 v[140:143], v[108:111], v[36:39], v[140:143]
  ds_read_b128 v[132:135], v5 offset:25856
  v_mfma_f32_16x16x32_bf16 v[144:147], v[64:67], v[40:43], v[172:175]
  v_exp_f32 v136, v136
  v_mfma_f32_16x16x32_bf16 v[144:147], v[68:71], v[44:47], v[144:147]
  v_exp_f32 v137, v137
  v_mfma_f32_16x16x32_bf16 v[144:147], v[72:75], v[48:51], v[144:147]
  v_exp_f32 v138, v138
  v_mfma_f32_16x16x32_bf16 v[144:147], v[76:79], v[52:55], v[144:147]
  v_exp_f32 v139, v139
  v_mfma_f32_16x16x32_bf16 v[144:147], v[80:83], v[56:59], v[144:147]
  v_cvt_pk_bf16_f32 v136, v136, v137
  v_cvt_pk_bf16_f32 v137, v138, v139
  v_mfma_f32_16x16x32_bf16 v[144:147], v[84:87], v[60:63], v[144:147]
  v_exp_f32 v140, v140
  v_mfma_f32_16x16x32_bf16 v[148:151], v[88:91], v[40:43], v[172:175]
  v_exp_f32 v141, v141
  v_mfma_f32_16x16x32_bf16 v[148:151], v[92:95], v[44:47], v[148:151]
  v_exp_f32 v142, v142
  v_mfma_f32_16x16x32_bf16 v[148:151], v[96:99], v[48:51], v[148:151]
  v_exp_f32 v143, v143
  v_mfma_f32_16x16x32_bf16 v[148:151], v[100:103], v[52:55], v[148:151]
  v_cvt_pk_bf16_f32 v138, v140, v141
  v_cvt_pk_bf16_f32 v139, v142, v143
  v_mfma_f32_16x16x32_bf16 v[148:151], v[104:107], v[56:59], v[148:151]
  s_add_u32 s3, s3, 512
  v_mfma_f32_16x16x32_bf16 v[148:151], v[108:111], v[60:63], v[148:151]
  s_xor_b32 s90, s3, s76
  v_mfma_f32_16x16x32_bf16 v[152:155], v[64:67], a[208:211], v[176:179]
  v_exp_f32 v144, v144
  v_mfma_f32_16x16x32_bf16 v[152:155], v[68:71], a[212:215], v[152:155]
  v_exp_f32 v145, v145
  v_mfma_f32_16x16x32_bf16 v[152:155], v[72:75], a[216:219], v[152:155]
  v_exp_f32 v146, v146
  v_mfma_f32_16x16x32_bf16 v[152:155], v[76:79], a[220:223], v[152:155]
  v_exp_f32 v147, v147
  v_mfma_f32_16x16x32_bf16 v[152:155], v[80:83], a[224:227], v[152:155]
  v_cvt_pk_bf16_f32 v144, v144, v145
  v_cvt_pk_bf16_f32 v145, v146, v147
  v_mfma_f32_16x16x32_bf16 v[152:155], v[84:87], a[228:231], v[152:155]
  v_exp_f32 v148, v148
  v_mfma_f32_16x16x32_bf16 v[156:159], v[88:91], a[208:211], v[176:179]
  v_exp_f32 v149, v149
  v_mfma_f32_16x16x32_bf16 v[156:159], v[92:95], a[212:215], v[156:159]
  v_exp_f32 v150, v150
  v_mfma_f32_16x16x32_bf16 v[156:159], v[96:99], a[216:219], v[156:159]
  v_exp_f32 v151, v151
  v_mfma_f32_16x16x32_bf16 v[156:159], v[100:103], a[220:223], v[156:159]
  v_cvt_pk_bf16_f32 v146, v148, v149
  v_cvt_pk_bf16_f32 v147, v150, v151
  v_mfma_f32_16x16x32_bf16 v[156:159], v[104:107], a[224:227], v[156:159]
  s_and_b32 s90, s90, 0x7e00
  v_mfma_f32_16x16x32_bf16 v[156:159], v[108:111], a[228:231], v[156:159]
  v_mfma_f32_16x16x32_bf16 v[160:163], v[64:67], a[232:235], v[180:183]
  v_exp_f32 v152, v152
  v_mfma_f32_16x16x32_bf16 v[160:163], v[68:71], a[236:239], v[160:163]
  v_exp_f32 v153, v153
  v_mfma_f32_16x16x32_bf16 v[160:163], v[72:75], a[240:243], v[160:163]
  v_exp_f32 v154, v154
  v_mfma_f32_16x16x32_bf16 v[160:163], v[76:79], a[244:247], v[160:163]
  v_exp_f32 v155, v155
  v_mfma_f32_16x16x32_bf16 v[160:163], v[80:83], a[248:251], v[160:163]
  v_cvt_pk_bf16_f32 v152, v152, v153
  v_cvt_pk_bf16_f32 v153, v154, v155
  v_mfma_f32_16x16x32_bf16 v[160:163], v[84:87], a[252:255], v[160:163]
  v_exp_f32 v156, v156
  v_mfma_f32_16x16x32_bf16 v[164:167], v[88:91], a[232:235], v[180:183]
  v_exp_f32 v157, v157
  v_mfma_f32_16x16x32_bf16 v[164:167], v[92:95], a[236:239], v[164:167]
  v_exp_f32 v158, v158
  v_mfma_f32_16x16x32_bf16 v[164:167], v[96:99], a[240:243], v[164:167]
  v_exp_f32 v159, v159
  v_mfma_f32_16x16x32_bf16 v[164:167], v[100:103], a[244:247], v[164:167]
  v_cvt_pk_bf16_f32 v154, v156, v157
  v_cvt_pk_bf16_f32 v155, v158, v159
  v_mfma_f32_16x16x32_bf16 v[164:167], v[104:107], a[248:251], v[164:167]
  s_waitcnt lgkmcnt(0)
  v_mfma_f32_16x16x32_bf16 v[164:167], v[108:111], a[252:255], v[164:167]
  v_mfma_f32_16x16x32_bf16 a[0:3], v[112:115], v[136:139], a[0:3]
  v_exp_f32 v160, v160
  v_mfma_f32_16x16x32_bf16 a[4:7], v[112:115], v[144:147], a[4:7]
  v_exp_f32 v161, v161
  v_mfma_f32_16x16x32_bf16 a[8:11], v[112:115], v[152:155], a[8:11]
  v_exp_f32 v162, v162
  v_mfma_f32_16x16x32_bf16 a[16:19], v[116:119], v[136:139], a[16:19]
  v_exp_f32 v163, v163
  v_mfma_f32_16x16x32_bf16 a[20:23], v[116:119], v[144:147], a[20:23]
  v_cvt_pk_bf16_f32 v160, v160, v161
  v_cvt_pk_bf16_f32 v161, v162, v163
  v_mfma_f32_16x16x32_bf16 a[24:27], v[116:119], v[152:155], a[24:27]
  v_exp_f32 v164, v164
  v_mfma_f32_16x16x32_bf16 a[32:35], v[120:123], v[136:139], a[32:35]
  v_exp_f32 v165, v165
  v_mfma_f32_16x16x32_bf16 a[36:39], v[120:123], v[144:147], a[36:39]
  v_exp_f32 v166, v166
  v_mfma_f32_16x16x32_bf16 a[40:43], v[120:123], v[152:155], a[40:43]
  v_exp_f32 v167, v167
  v_mfma_f32_16x16x32_bf16 a[48:51], v[124:127], v[136:139], a[48:51]
  v_cvt_pk_bf16_f32 v162, v164, v165
  v_cvt_pk_bf16_f32 v163, v166, v167
  v_mfma_f32_16x16x32_bf16 a[52:55], v[124:127], v[144:147], a[52:55]
  s_waitcnt vmcnt(13)
  v_cmp_eq_u64 vcc, s[88:89], v[2:3]
  s_add_u32 m0, s37, 12288
  v_mfma_f32_16x16x32_bf16 a[56:59], v[124:127], v[152:155], a[56:59]
  s_waitcnt vmcnt(7)
  s_barrier
  v_mfma_f32_16x16x32_bf16 a[192:195], v[12:15], v[136:139], a[192:195]
  s_cbranch_vccz L_slow22
L_ret22:
  buffer_load_dwordx2 v[2:3], v1, s[4:7], s90 offen sc1
  v_mfma_f32_16x16x32_bf16 a[196:199], v[12:15], v[144:147], a[196:199]
  ds_read_b128 v[64:67], v4 offset:36864
  v_mfma_f32_16x16x32_bf16 a[200:203], v[12:15], v[152:155], a[200:203]
  buffer_load_dwordx4 v8, s[4:7], s40 offen offset:0 sc1 lds
  v_mfma_f32_16x16x32_bf16 a[12:15], v[112:115], v[160:163], a[12:15]
  ds_read_b128 v[68:71], v4 offset:37888
  v_mfma_f32_16x16x32_bf16 a[28:31], v[116:119], v[160:163], a[28:31]
  ds_read_b128 v[112:115], v5 offset:26112
  v_mfma_f32_16x16x32_bf16 a[44:47], v[120:123], v[160:163], a[44:47]
  ds_read_b128 v[116:119], v5 offset:26368
  v_mfma_f32_16x16x32_bf16 a[60:63], v[124:127], v[160:163], a[60:63]
  ds_read_b128 v[120:123], v5 offset:26624
  v_mfma_f32_16x16x32_bf16 a[204:207], v[12:15], v[160:163], a[204:207]
  ds_read_b128 v[124:127], v5 offset:26880
  v_mfma_f32_16x16x32_bf16 a[64:67], v[128:131], v[136:139], a[64:67]
  ds_read_b128 v[72:75], v4 offset:38912
  v_mfma_f32_16x16x32_bf16 a[68:71], v[128:131], v[144:147], a[68:71]
  ds_read_b128 v[76:79], v4 offset:39936
  v_mfma_f32_16x16x32_bf16 a[72:75], v[128:131], v[152:155], a[72:75]
  buffer_load_dwordx4 v8, s[4:7], s40 offen offset:1024 sc1 lds
  v_mfma_f32_16x16x32_bf16 a[76:79], v[128:131], v[160:163], a[76:79]
  ds_read_b128 v[80:83], v4 offset:40960
  v_mfma_f32_16x16x32_bf16 a[80:83], v[132:135], v[136:139], a[80:83]
  ds_read_b128 v[128:131], v5 offset:27136
  v_mfma_f32_16x16x32_bf16 a[84:87], v[132:135], v[144:147], a[84:87]
  ds_read_b128 v[84:87], v4 offset:41984
  v_mfma_f32_16x16x32_bf16 a[88:91], v[132:135], v[152:155], a[88:91]
  ds_read_b128 v[88:91], v4 offset:43008
  v_mfma_f32_16x16x32_bf16 a[92:95], v[132:135], v[160:163], a[92:95]
  ds_read_b128 v[92:95], v4 offset:44032
  s_waitcnt lgkmcnt(10)
  v_mfma_f32_16x16x32_bf16 a[96:99], v[112:115], v[136:139], a[96:99]
  ds_read_b128 v[132:135], v5 offset:27392
  v_mfma_f32_16x16x32_bf16 a[100:103], v[112:115], v[144:147], a[100:103]
  ds_read_b128 v[96:99], v4 offset:45056
  v_mfma_f32_16x16x32_bf16 a[104:107], v[112:115], v[152:155], a[104:107]
  buffer_load_dwordx4 v8, s[4:7], s40 offen offset:2048 sc1 lds
  v_mfma_f32_16x16x32_bf16 a[108:111], v[112:115], v[160:163], a[108:111]
  ds_read_b128 v[100:103], v4 offset:46080
  s_waitcnt lgkmcnt(10)
  v_mfma_f32_16x16x32_bf16 a[112:115], v[116:119], v[136:139], a[112:115]
  s_add_u32 m0, s37, 61440
  v_mfma_f32_16x16x32_bf16 a[116:119], v[116:119], v[144:147], a[116:119]
  ds_read_b128 v[104:107], v4 offset:47104
  v_mfma_f32_16x16x32_bf16 a[120:123], v[116:119], v[152:155], a[120:123]
  v_mfma_f32_16x16x32_bf16 a[124:127], v[116:119], v[160:163], a[124:127]
  ds_read_b128 v[108:111], v4 offset:48128
  v_mfma_f32_16x16x32_bf16 a[128:131], v[120:123], v[136:139], a[128:131]
  v_mfma_f32_16x16x32_bf16 a[132:135], v[120:123], v[144:147], a[132:135]
  v_mfma_f32_16x16x32_bf16 a[136:139], v[120:123], v[152:155], a[136:139]
  buffer_load_dwordx4 v9, s[4:7], s40 offen offset:0 sc1 lds
  v_mfma_f32_16x16x32_bf16 a[140:143], v[120:123], v[160:163], a[140:143]
  v_mfma_f32_16x16x32_bf16 a[144:147], v[124:127], v[136:139], a[144:147]
  v_mfma_f32_16x16x32_bf16 a[148:151], v[124:127], v[144:147], a[148:151]
  v_mfma_f32_16x16x32_bf16 a[152:155], v[124:127], v[152:155], a[152:155]
  v_mfma_f32_16x16x32_bf16 a[156:159], v[124:127], v[160:163], a[156:159]
  s_waitcnt lgkmcnt(4)
  v_mfma_f32_16x16x32_bf16 a[160:163], v[128:131], v[136:139], a[160:163]
  buffer_load_dwordx4 v9, s[4:7], s40 offen offset:1024 sc1 lds
  v_mfma_f32_16x16x32_bf16 a[164:167], v[128:131], v[144:147], a[164:167]
  v_mfma_f32_16x16x32_bf16 a[168:171], v[128:131], v[152:155], a[168:171]
  v_mfma_f32_16x16x32_bf16 a[172:175], v[128:131], v[160:163], a[172:175]
  v_mfma_f32_16x16x32_bf16 a[176:179], v[132:135], v[136:139], a[176:179]
  v_mfma_f32_16x16x32_bf16 a[180:183], v[132:135], v[144:147], a[180:183]
  v_mfma_f32_16x16x32_bf16 a[184:187], v[132:135], v[152:155], a[184:187]
  buffer_load_dwordx4 v9, s[4:7], s40 offen offset:2048 sc1 lds
  v_mfma_f32_16x16x32_bf16 a[188:191], v[132:135], v[160:163], a[188:191]
  s_mul_i32 s40, s90, 48
  v_mfma_f32_16x16x32_bf16 v[136:139], v[64:67], v[16:19], v[168:171]
  v_mfma_f32_16x16x32_bf16 v[136:139], v[68:71], v[20:23], v[136:139]
  ds_read_b128 v[112:115], v5 offset:36864
  v_mfma_f32_16x16x32_bf16 v[136:139], v[72:75], v[24:27], v[136:139]
  v_mfma_f32_16x16x32_bf16 v[136:139], v[76:79], v[28:31], v[136:139]
  ds_read_b128 v[116:119], v5 offset:37120
  s_waitcnt lgkmcnt(2)
  v_mfma_f32_16x16x32_bf16 v[136:139], v[80:83], v[32:35], v[136:139]
  v_mfma_f32_16x16x32_bf16 v[136:139], v[84:87], v[36:39], v[136:139]
  ds_read_b128 v[120:123], v5 offset:37376
  v_mfma_f32_16x16x32_bf16 v[140:143], v[88:91], v[16:19], v[168:171]
  v_mfma_f32_16x16x32_bf16 v[140:143], v[92:95], v[20:23], v[140:143]
  ds_read_b128 v[124:127], v5 offset:37632
  v_mfma_f32_16x16x32_bf16 v[140:143], v[96:99], v[24:27], v[140:143]
  v_mfma_f32_16x16x32_bf16 v[140:143], v[100:103], v[28:31], v[140:143]
  ds_read_b128 v[128:131], v5 offset:37888
  v_mfma_f32_16x16x32_bf16 v[140:143], v[104:107], v[32:35], v[140:143]
  v_mfma_f32_16x16x32_bf16 v[140:143], v[108:111], v[36:39], v[140:143]
  ds_read_b128 v[132:135], v5 offset:38144
  v_mfma_f32_16x16x32_bf16 v[144:147], v[64:67], v[40:43], v[172:175]
  v_exp_f32 v136, v136
  v_mfma_f32_16x16x32_bf16 v[144:147], v[68:71], v[44:47], v[144:147]
  v_exp_f32 v137, v137
  v_mfma_f32_16x16x32_bf16 v[144:147], v[72:75], v[48:51], v[144:147]
  v_exp_f32 v138, v138
  v_mfma_f32_16x16x32_bf16 v[144:147], v[76:79], v[52:55], v[144:147]
  v_exp_f32 v139, v139
  v_mfma_f32_16x16x32_bf16 v[144:147], v[80:83], v[56:59], v[144:147]
  v_cvt_pk_bf16_f32 v136, v136, v137
  v_cvt_pk_bf16_f32 v137, v138, v139
  v_mfma_f32_16x16x32_bf16 v[144:147], v[84:87], v[60:63], v[144:147]
  v_exp_f32 v140, v140
  v_mfma_f32_16x16x32_bf16 v[148:151], v[88:91], v[40:43], v[172:175]
  v_exp_f32 v141, v141
  v_mfma_f32_16x16x32_bf16 v[148:151], v[92:95], v[44:47], v[148:151]
  v_exp_f32 v142, v142
  v_mfma_f32_16x16x32_bf16 v[148:151], v[96:99], v[48:51], v[148:151]
  v_exp_f32 v143, v143
  v_mfma_f32_16x16x32_bf16 v[148:151], v[100:103], v[52:55], v[148:151]
  v_cvt_pk_bf16_f32 v138, v140, v141
  v_cvt_pk_bf16_f32 v139, v142, v143
  v_mfma_f32_16x16x32_bf16 v[148:151], v[104:107], v[56:59], v[148:151]
  s_add_u32 s3, s3, 512
  v_mfma_f32_16x16x32_bf16 v[148:151], v[108:111], v[60:63], v[148:151]
  s_xor_b32 s90, s3, s76
  v_mfma_f32_16x16x32_bf16 v[152:155], v[64:67], a[208:211], v[176:179]
  v_exp_f32 v144, v144
  v_mfma_f32_16x16x32_bf16 v[152:155], v[68:71], a[212:215], v[152:155]
  v_exp_f32 v145, v145
  v_mfma_f32_16x16x32_bf16 v[152:155], v[72:75], a[216:219], v[152:155]
  v_exp_f32 v146, v146
  v_mfma_f32_16x16x32_bf16 v[152:155], v[76:79], a[220:223], v[152:155]
  v_exp_f32 v147, v147
  v_mfma_f32_16x16x32_bf16 v[152:155], v[80:83], a[224:227], v[152:155]
  v_cvt_pk_bf16_f32 v144, v144, v145
  v_cvt_pk_bf16_f32 v145, v146, v147
  v_mfma_f32_16x16x32_bf16 v[152:155], v[84:87], a[228:231], v[152:155]
  v_exp_f32 v148, v148
  v_mfma_f32_16x16x32_bf16 v[156:159], v[88:91], a[208:211], v[176:179]
  v_exp_f32 v149, v149
  v_mfma_f32_16x16x32_bf16 v[156:159], v[92:95], a[212:215], v[156:159]
  v_exp_f32 v150, v150
  v_mfma_f32_16x16x32_bf16 v[156:159], v[96:99], a[216:219], v[156:159]
  v_exp_f32 v151, v151
  v_mfma_f32_16x16x32_bf16 v[156:159], v[100:103], a[220:223], v[156:159]
  v_cvt_pk_bf16_f32 v146, v148, v149
  v_cvt_pk_bf16_f32 v147, v150, v151
  v_mfma_f32_16x16x32_bf16 v[156:159], v[104:107], a[224:227], v[156:159]
  s_and_b32 s90, s90, 0x7e00
  v_mfma_f32_16x16x32_bf16 v[156:159], v[108:111], a[228:231], v[156:159]
  v_mfma_f32_16x16x32_bf16 v[160:163], v[64:67], a[232:235], v[180:183]
  v_exp_f32 v152, v152
  v_mfma_f32_16x16x32_bf16 v[160:163], v[68:71], a[236:239], v[160:163]
  v_exp_f32 v153, v153
  v_mfma_f32_16x16x32_bf16 v[160:163], v[72:75], a[240:243], v[160:163]
  v_exp_f32 v154, v154
  v_mfma_f32_16x16x32_bf16 v[160:163], v[76:79], a[244:247], v[160:163]
  v_exp_f32 v155, v155
  v_mfma_f32_16x16x32_bf16 v[160:163], v[80:83], a[248:251], v[160:163]
  v_cvt_pk_bf16_f32 v152, v152, v153
  v_cvt_pk_bf16_f32 v153, v154, v155
  v_mfma_f32_16x16x32_bf16 v[160:163], v[84:87], a[252:255], v[160:163]
  v_exp_f32 v156, v156
  v_mfma_f32_16x16x32_bf16 v[164:167], v[88:91], a[232:235], v[180:183]
  v_exp_f32 v157, v157
  v_mfma_f32_16x16x32_bf16 v[164:167], v[92:95], a[236:239], v[164:167]
  v_exp_f32 v158, v158
  v_mfma_f32_16x16x32_bf16 v[164:167], v[96:99], a[240:243], v[164:167]
  v_exp_f32 v159, v159
  v_mfma_f32_16x16x32_bf16 v[164:167], v[100:103], a[244:247], v[164:167]
  v_cvt_pk_bf16_f32 v154, v156, v157
  v_cvt_pk_bf16_f32 v155, v158, v159
  v_mfma_f32_16x16x32_bf16 v[164:167], v[104:107], a[248:251], v[164:167]
  s_waitcnt lgkmcnt(0)
  v_mfma_f32_16x16x32_bf16 v[164:167], v[108:111], a[252:255], v[164:167]
  v_mfma_f32_16x16x32_bf16 a[0:3], v[112:115], v[136:139], a[0:3]
  v_exp_f32 v160, v160
  v_mfma_f32_16x16x32_bf16 a[4:7], v[112:115], v[144:147], a[4:7]
  v_exp_f32 v161, v161
  v_mfma_f32_16x16x32_bf16 a[8:11], v[112:115], v[152:155], a[8:11]
  v_exp_f32 v162, v162
  v_mfma_f32_16x16x32_bf16 a[16:19], v[116:119], v[136:139], a[16:19]
  v_exp_f32 v163, v163
  v_mfma_f32_16x16x32_bf16 a[20:23], v[116:119], v[144:147], a[20:23]
  v_cvt_pk_bf16_f32 v160, v160, v161
  v_cvt_pk_bf16_f32 v161, v162, v163
  v_mfma_f32_16x16x32_bf16 a[24:27], v[116:119], v[152:155], a[24:27]
  v_exp_f32 v164, v164
  v_mfma_f32_16x16x32_bf16 a[32:35], v[120:123], v[136:139], a[32:35]
  v_exp_f32 v165, v165
  v_mfma_f32_16x16x32_bf16 a[36:39], v[120:123], v[144:147], a[36:39]
  v_exp_f32 v166, v166
  v_mfma_f32_16x16x32_bf16 a[40:43], v[120:123], v[152:155], a[40:43]
  v_exp_f32 v167, v167
  v_mfma_f32_16x16x32_bf16 a[48:51], v[124:127], v[136:139], a[48:51]
  v_cvt_pk_bf16_f32 v162, v164, v165
  v_cvt_pk_bf16_f32 v163, v166, v167
  v_mfma_f32_16x16x32_bf16 a[52:55], v[124:127], v[144:147], a[52:55]
  s_waitcnt vmcnt(13)
  v_cmp_eq_u64 vcc, s[88:89], v[6:7]
  s_add_u32 m0, s37, 24576
  v_mfma_f32_16x16x32_bf16 a[56:59], v[124:127], v[152:155], a[56:59]
  s_waitcnt vmcnt(7)
  s_barrier
  v_mfma_f32_16x16x32_bf16 a[192:195], v[12:15], v[136:139], a[192:195]
  s_cbranch_vccz L_slow23
L_ret23:
  buffer_load_dwordx2 v[6:7], v1, s[4:7], s90 offen sc1
  v_mfma_f32_16x16x32_bf16 a[196:199], v[12:15], v[144:147], a[196:199]
  ds_read_b128 v[64:67], v4 offset:0
  v_mfma_f32_16x16x32_bf16 a[200:203], v[12:15], v[152:155], a[200:203]
  buffer_load_dwordx4 v8, s[4:7], s48 offen offset:0 sc1 lds
  v_mfma_f32_16x16x32_bf16 a[12:15], v[112:115], v[160:163], a[12:15]
  ds_read_b128 v[68:71], v4 offset:1024
  v_mfma_f32_16x16x32_bf16 a[28:31], v[116:119], v[160:163], a[28:31]
  ds_read_b128 v[112:115], v5 offset:38400
  v_mfma_f32_16x16x32_bf16 a[44:47], v[120:123], v[160:163], a[44:47]
  ds_read_b128 v[116:119], v5 offset:38656
  v_mfma_f32_16x16x32_bf16 a[60:63], v[124:127], v[160:163], a[60:63]
  ds_read_b128 v[120:123], v5 offset:38912
  v_mfma_f32_16x16x32_bf16 a[204:207], v[12:15], v[160:163], a[204:207]
  ds_read_b128 v[124:127], v5 offset:39168
  v_mfma_f32_16x16x32_bf16 a[64:67], v[128:131], v[136:139], a[64:67]
  ds_read_b128 v[72:75], v4 offset:2048
  v_mfma_f32_16x16x32_bf16 a[68:71], v[128:131], v[144:147], a[68:71]
  ds_read_b128 v[76:79], v4 offset:3072
  v_mfma_f32_16x16x32_bf16 a[72:75], v[128:131], v[152:155], a[72:75]
  buffer_load_dwordx4 v8, s[4:7], s48 offen offset:1024 sc1 lds
  v_mfma_f32_16x16x32_bf16 a[76:79], v[128:131], v[160:163], a[76:79]
  ds_read_b128 v[80:83], v4 offset:4096
  v_mfma_f32_16x16x32_bf16 a[80:83], v[132:135], v[136:139], a[80:83]
  ds_read_b128 v[128:131], v5 offset:39424
  v_mfma_f32_16x16x32_bf16 a[84:87], v[132:135], v[144:147], a[84:87]
  ds_read_b128 v[84:87], v4 offset:5120
  v_mfma_f32_16x16x32_bf16 a[88:91], v[132:135], v[152:155], a[88:91]
  ds_read_b128 v[88:91], v4 offset:6144
  v_mfma_f32_16x16x32_bf16 a[92:95], v[132:135], v[160:163], a[92:95]
  ds_read_b128 v[92:95], v4 offset:7168
  s_waitcnt lgkmcnt(10)
  v_mfma_f32_16x16x32_bf16 a[96:99], v[112:115], v[136:139], a[96:99]
  ds_read_b128 v[132:135], v5 offset:39680
  v_mfma_f32_16x16x32_bf16 a[100:103], v[112:115], v[144:147], a[100:103]
  ds_read_b128 v[96:99], v4 offset:8192
  v_mfma_f32_16x16x32_bf16 a[104:107], v[112:115], v[152:155], a[104:107]
  buffer_load_dwordx4 v8, s[4:7], s48 offen offset:2048 sc1 lds
  v_mfma_f32_16x16x32_bf16 a[108:111], v[112:115], v[160:163], a[108:111]
  ds_read_b128 v[100:103], v4 offset:9216
  s_waitcnt lgkmcnt(10)
  v_mfma_f32_16x16x32_bf16 a[112:115], v[116:119], v[136:139], a[112:115]
  s_add_u32 m0, s37, 73728
  v_mfma_f32_16x16x32_bf16 a[116:119], v[116:119], v[144:147], a[116:119]
  ds_read_b128 v[104:107], v4 offset:10240
  v_mfma_f32_16x16x32_bf16 a[120:123], v[116:119], v[152:155], a[120:123]
  v_mfma_f32_16x16x32_bf16 a[124:127], v[116:119], v[160:163], a[124:127]
  ds_read_b128 v[108:111], v4 offset:11264
  v_mfma_f32_16x16x32_bf16 a[128:131], v[120:123], v[136:139], a[128:131]
  v_mfma_f32_16x16x32_bf16 a[132:135], v[120:123], v[144:147], a[132:135]
  v_mfma_f32_16x16x32_bf16 a[136:139], v[120:123], v[152:155], a[136:139]
  buffer_load_dwordx4 v9, s[4:7], s48 offen offset:0 sc1 lds
  v_mfma_f32_16x16x32_bf16 a[140:143], v[120:123], v[160:163], a[140:143]
  v_mfma_f32_16x16x32_bf16 a[144:147], v[124:127], v[136:139], a[144:147]
  v_mfma_f32_16x16x32_bf16 a[148:151], v[124:127], v[144:147], a[148:151]
  v_mfma_f32_16x16x32_bf16 a[152:155], v[124:127], v[152:155], a[152:155]
  v_mfma_f32_16x16x32_bf16 a[156:159], v[124:127], v[160:163], a[156:159]
  s_waitcnt lgkmcnt(4)
  v_mfma_f32_16x16x32_bf16 a[160:163], v[128:131], v[136:139], a[160:163]
  buffer_load_dwordx4 v9, s[4:7], s48 offen offset:1024 sc1 lds
  v_mfma_f32_16x16x32_bf16 a[164:167], v[128:131], v[144:147], a[164:167]
  v_mfma_f32_16x16x32_bf16 a[168:171], v[128:131], v[152:155], a[168:171]
  v_mfma_f32_16x16x32_bf16 a[172:175], v[128:131], v[160:163], a[172:175]
  v_mfma_f32_16x16x32_bf16 a[176:179], v[132:135], v[136:139], a[176:179]
  v_mfma_f32_16x16x32_bf16 a[180:183], v[132:135], v[144:147], a[180:183]
  v_mfma_f32_16x16x32_bf16 a[184:187], v[132:135], v[152:155], a[184:187]
  buffer_load_dwordx4 v9, s[4:7], s48 offen offset:2048 sc1 lds
  v_mfma_f32_16x16x32_bf16 a[188:191], v[132:135], v[160:163], a[188:191]
  s_mul_i32 s48, s90, 48
  s_sub_u32 s41, s41, 1
  s_cmp_lg_u32 s41, 0
  s_cbranch_scc1 L_loopC
  v_accvgpr_read_b32 v140, a192
  v_accvgpr_read_b32 v141, a196
  v_accvgpr_read_b32 v142, a200
  v_accvgpr_read_b32 v143, a204
  v_rcp_f32 v136, v140
  v_rcp_f32 v137, v141
  v_rcp_f32 v138, v142
  v_rcp_f32 v139, v143
  s_waitcnt vmcnt(13)
  v_and_b32 v3, 15, v0
  v_lshrrev_b32 v2, 4, v0
  v_mul_u32_u24 v3, 400, v3
  v_mul_u32_u24 v2, 24, v2
  s_mul_i32 s53, s36, 12800
  s_add_u32 s53, s53, 98368
  v_add3_u32 v148, v3, v2, s53
  v_accvgpr_read_b32 v64, a0
  v_accvgpr_read_b32 v65, a64
  v_accvgpr_read_b32 v66, a128
  v_accvgpr_read_b32 v67, a1
  v_accvgpr_read_b32 v68, a65
  v_accvgpr_read_b32 v69, a129
  v_accvgpr_read_b32 v70, a2
  v_accvgpr_read_b32 v71, a66
  v_accvgpr_read_b32 v72, a130
  v_accvgpr_read_b32 v73, a3
  v_accvgpr_read_b32 v74, a67
  v_accvgpr_read_b32 v75, a131
  v_pk_mul_f32 v[64:65], v[64:65], v[136:137] op_sel:[0,0] op_sel_hi:[1,0]
  v_pk_mul_f32 v[66:67], v[66:67], v[136:137] op_sel:[0,0] op_sel_hi:[1,0]
  v_pk_mul_f32 v[68:69], v[68:69], v[136:137] op_sel:[0,0] op_sel_hi:[1,0]
  v_pk_mul_f32 v[70:71], v[70:71], v[136:137] op_sel:[0,0] op_sel_hi:[1,0]
  v_pk_mul_f32 v[72:73], v[72:73], v[136:137] op_sel:[0,0] op_sel_hi:[1,0]
  v_pk_mul_f32 v[74:75], v[74:75], v[136:137] op_sel:[0,0] op_sel_hi:[1,0]
  v_cvt_pk_bf16_f32 v64, v64, v65
  v_cvt_pk_bf16_f32 v65, v66, v67
  v_cvt_pk_bf16_f32 v66, v68, v69
  v_cvt_pk_bf16_f32 v67, v70, v71
  v_cvt_pk_bf16_f32 v68, v72, v73
  v_cvt_pk_bf16_f32 v69, v74, v75
  ds_write_b64 v148, v[64:65] offset:0
  ds_write_b64 v148, v[66:67] offset:8
  ds_write_b64 v148, v[68:69] offset:16
  v_add_u32 v2, 0, v0
  v_mul_u32_u24 v3, 2731, v2
  v_lshrrev_b32 v3, 16, v3
  v_add_u32 v2, v2, v3
  v_lshl_add_u32 v149, v2, 4, s53
  v_add_u32 v2, 64, v0
  v_mul_u32_u24 v3, 2731, v2
  v_lshrrev_b32 v3, 16, v3
  v_add_u32 v2, v2, v3
  v_lshl_add_u32 v150, v2, 4, s53
  v_add_u32 v2, 128, v0
  v_mul_u32_u24 v3, 2731, v2
  v_lshrrev_b32 v3, 16, v3
  v_add_u32 v2, v2, v3
  v_lshl_add_u32 v151, v2, 4, s53
  s_mul_i32 s52, s36, 24576
  s_sub_u32 s52, s52, 4096
  v_accvgpr_read_b32 v80, a16
  v_accvgpr_read_b32 v81, a80
  v_accvgpr_read_b32 v82, a144
  v_accvgpr_read_b32 v83, a17
  v_accvgpr_read_b32 v84, a81
  v_accvgpr_read_b32 v85, a145
  v_accvgpr_read_b32 v86, a18
  v_accvgpr_read_b32 v87, a82
  v_accvgpr_read_b32 v88, a146
  v_accvgpr_read_b32 v89, a19
  v_accvgpr_read_b32 v90, a83
  v_accvgpr_read_b32 v91, a147
  v_pk_mul_f32 v[80:81], v[80:81], v[136:137] op_sel:[0,0] op_sel_hi:[1,0]
  v_pk_mul_f32 v[82:83], v[82:83], v[136:137] op_sel:[0,0] op_sel_hi:[1,0]
  v_pk_mul_f32 v[84:85], v[84:85], v[136:137] op_sel:[0,0] op_sel_hi:[1,0]
  v_pk_mul_f32 v[86:87], v[86:87], v[136:137] op_sel:[0,0] op_sel_hi:[1,0]
  v_pk_mul_f32 v[88:89], v[88:89], v[136:137] op_sel:[0,0] op_sel_hi:[1,0]
  v_pk_mul_f32 v[90:91], v[90:91], v[136:137] op_sel:[0,0] op_sel_hi:[1,0]
  v_cvt_pk_bf16_f32 v80, v80, v81
  v_cvt_pk_bf16_f32 v81, v82, v83
  v_cvt_pk_bf16_f32 v82, v84, v85
  v_cvt_pk_bf16_f32 v83, v86, v87
  v_cvt_pk_bf16_f32 v84, v88, v89
  v_cvt_pk_bf16_f32 v85, v90, v91
  ds_write_b64 v148, v[80:81] offset:96
  ds_write_b64 v148, v[82:83] offset:104
  ds_write_b64 v148, v[84:85] offset:112
  s_waitcnt lgkmcnt(9)
  v_accvgpr_read_b32 v96, a32
  v_accvgpr_read_b32 v97, a96
  v_accvgpr_read_b32 v98, a160
  v_accvgpr_read_b32 v99, a33
  s_waitcnt lgkmcnt(8)
  v_accvgpr_read_b32 v100, a97
  v_accvgpr_read_b32 v101, a161
  v_accvgpr_read_b32 v102, a34
  v_accvgpr_read_b32 v103, a98
  s_waitcnt lgkmcnt(7)
  v_accvgpr_read_b32 v104, a162
  v_accvgpr_read_b32 v105, a35
  v_accvgpr_read_b32 v106, a99
  v_accvgpr_read_b32 v107, a163
  v_pk_mul_f32 v[96:97], v[96:97], v[136:137] op_sel:[0,0] op_sel_hi:[1,0]
  v_pk_mul_f32 v[98:99], v[98:99], v[136:137] op_sel:[0,0] op_sel_hi:[1,0]
  v_pk_mul_f32 v[100:101], v[100:101], v[136:137] op_sel:[0,0] op_sel_hi:[1,0]
  v_pk_mul_f32 v[102:103], v[102:103], v[136:137] op_sel:[0,0] op_sel_hi:[1,0]
  v_pk_mul_f32 v[104:105], v[104:105], v[136:137] op_sel:[0,0] op_sel_hi:[1,0]
  v_pk_mul_f32 v[106:107], v[106:107], v[136:137] op_sel:[0,0] op_sel_hi:[1,0]
  v_cvt_pk_bf16_f32 v96, v96, v97
  v_cvt_pk_bf16_f32 v97, v98, v99
  v_cvt_pk_bf16_f32 v98, v100, v101
  v_cvt_pk_bf16_f32 v99, v102, v103
  v_cvt_pk_bf16_f32 v100, v104, v105
  v_cvt_pk_bf16_f32 v101, v106, v107
  ds_write_b64 v148, v[96:97] offset:192
  ds_write_b64 v148, v[98:99] offset:200
  ds_write_b64 v148, v[100:101] offset:208
  v_accvgpr_read_b32 v64, a48
  v_accvgpr_read_b32 v65, a112
  v_accvgpr_read_b32 v66, a176
  v_accvgpr_read_b32 v67, a49
  v_accvgpr_read_b32 v68, a113
  v_accvgpr_read_b32 v69, a177
  v_accvgpr_read_b32 v70, a50
  v_accvgpr_read_b32 v71, a114
  v_accvgpr_read_b32 v72, a178
  v_accvgpr_read_b32 v73, a51
  v_accvgpr_read_b32 v74, a115
  v_accvgpr_read_b32 v75, a179
  v_pk_mul_f32 v[64:65], v[64:65], v[136:137] op_sel:[0,0] op_sel_hi:[1,0]
  v_pk_mul_f32 v[66:67], v[66:67], v[136:137] op_sel:[0,0] op_sel_hi:[1,0]
  v_pk_mul_f32 v[68:69], v[68:69], v[136:137] op_sel:[0,0] op_sel_hi:[1,0]
  v_pk_mul_f32 v[70:71], v[70:71], v[136:137] op_sel:[0,0] op_sel_hi:[1,0]
  v_pk_mul_f32 v[72:73], v[72:73], v[136:137] op_sel:[0,0] op_sel_hi:[1,0]
  v_pk_mul_f32 v[74:75], v[74:75], v[136:137] op_sel:[0,0] op_sel_hi:[1,0]
  v_cvt_pk_bf16_f32 v64, v64, v65
  v_cvt_pk_bf16_f32 v65, v66, v67
  v_cvt_pk_bf16_f32 v66, v68, v69
  v_cvt_pk_bf16_f32 v67, v70, v71
  v_cvt_pk_bf16_f32 v68, v72, v73
  v_cvt_pk_bf16_f32 v69, v74, v75
  ds_write_b64 v148, v[64:65] offset:288
  ds_write_b64 v148, v[66:67] offset:296
  ds_write_b64 v148, v[68:69] offset:304
  ds_read_b128 v[192:195], v149 offset:0
  ds_read_b128 v[196:199], v150 offset:0
  ds_read_b128 v[200:203], v151 offset:0
  ds_read_b128 v[204:207], v149 offset:3200
  ds_read_b128 v[208:211], v150 offset:3200
  ds_read_b128 v[212:215], v151 offset:3200
  v_accvgpr_read_b32 v80, a4
  v_accvgpr_read_b32 v81, a68
  s_add_u32 s52, s52, 4096
  v_accvgpr_read_b32 v82, a132
  v_accvgpr_read_b32 v83, a5
  s_waitcnt lgkmcnt(5)
  buffer_store_dwordx4 v[192:195], v4, s[80:83], s52 offen offset:0 sc1
  v_accvgpr_read_b32 v84, a69
  v_accvgpr_read_b32 v85, a133
  s_waitcnt lgkmcnt(4)
  buffer_store_dwordx4 v[196:199], v4, s[80:83], s52 offen offset:1024 sc1
  v_accvgpr_read_b32 v86, a6
  v_accvgpr_read_b32 v87, a70
  s_waitcnt lgkmcnt(3)
  buffer_store_dwordx4 v[200:203], v4, s[80:83], s52 offen offset:2048 sc1
  v_accvgpr_read_b32 v88, a134
  v_accvgpr_read_b32 v89, a7
  s_waitcnt lgkmcnt(2)
  buffer_store_dwordx4 v[204:207], v4, s[80:83], s52 offen offset:3072 sc1
  v_accvgpr_read_b32 v90, a71
  v_accvgpr_read_b32 v91, a135
  s_add_u32 s52, s52, 4096
  v_pk_mul_f32 v[80:81], v[80:81], v[136:137] op_sel:[0,1] op_sel_hi:[1,1]
  v_pk_mul_f32 v[82:83], v[82:83], v[136:137] op_sel:[0,1] op_sel_hi:[1,1]
  s_waitcnt lgkmcnt(1)
  buffer_store_dwordx4 v[208:211], v4, s[80:83], s52 offen offset:0 sc1
  v_pk_mul_f32 v[84:85], v[84:85], v[136:137] op_sel:[0,1] op_sel_hi:[1,1]
  v_pk_mul_f32 v[86:87], v[86:87], v[136:137] op_sel:[0,1] op_sel_hi:[1,1]
  s_waitcnt lgkmcnt(0)
  buffer_store_dwordx4 v[212:215], v4, s[80:83], s52 offen offset:1024 sc1
  v_pk_mul_f32 v[88:89], v[88:89], v[136:137] op_sel:[0,1] op_sel_hi:[1,1]
  v_pk_mul_f32 v[90:91], v[90:91], v[136:137] op_sel:[0,1] op_sel_hi:[1,1]
  v_cvt_pk_bf16_f32 v80, v80, v81
  v_cvt_pk_bf16_f32 v81, v82, v83
  v_cvt_pk_bf16_f32 v82, v84, v85
  v_cvt_pk_bf16_f32 v83, v86, v87
  v_cvt_pk_bf16_f32 v84, v88, v89
  v_cvt_pk_bf16_f32 v85, v90, v91
  ds_write_b64 v148, v[80:81] offset:6400
  ds_write_b64 v148, v[82:83] offset:6408
  ds_write_b64 v148, v[84:85] offset:6416
  v_accvgpr_read_b32 v96, a20
  v_accvgpr_read_b32 v97, a84
  v_accvgpr_read_b32 v98, a148
  v_accvgpr_read_b32 v99, a21
  v_accvgpr_read_b32 v100, a85
  v_accvgpr_read_b32 v101, a149
  v_accvgpr_read_b32 v102, a22
  v_accvgpr_read_b32 v103, a86
  v_accvgpr_read_b32 v104, a150
  v_accvgpr_read_b32 v105, a23
  v_accvgpr_read_b32 v106, a87
  v_accvgpr_read_b32 v107, a151
  v_pk_mul_f32 v[96:97], v[96:97], v[136:137] op_sel:[0,1] op_sel_hi:[1,1]
  v_pk_mul_f32 v[98:99], v[98:99], v[136:137] op_sel:[0,1] op_sel_hi:[1,1]
  v_pk_mul_f32 v[100:101], v[100:101], v[136:137] op_sel:[0,1] op_sel_hi:[1,1]
  v_pk_mul_f32 v[102:103], v[102:103], v[136:137] op_sel:[0,1] op_sel_hi:[1,1]
  v_pk_mul_f32 v[104:105], v[104:105], v[136:137] op_sel:[0,1] op_sel_hi:[1,1]
  v_pk_mul_f32 v[106:107], v[106:107], v[136:137] op_sel:[0,1] op_sel_hi:[1,1]
  v_cvt_pk_bf16_f32 v96, v96, v97
  v_cvt_pk_bf16_f32 v97, v98, v99
  v_cvt_pk_bf16_f32 v98, v100, v101
  v_cvt_pk_bf16_f32 v99, v102, v103
  v_cvt_pk_bf16_f32 v100, v104, v105
  v_cvt_pk_bf16_f32 v101, v106, v107
  ds_write_b64 v148, v[96:97] offset:6496
  ds_write_b64 v148, v[98:99] offset:6504
  ds_write_b64 v148, v[100:101] offset:6512
  v_accvgpr_read_b32 v64, a36
  v_accvgpr_read_b32 v65, a100
  v_accvgpr_read_b32 v66, a164
  v_accvgpr_read_b32 v67, a37
  v_accvgpr_read_b32 v68, a101
  v_accvgpr_read_b32 v69, a165
  v_accvgpr_read_b32 v70, a38
  v_accvgpr_read_b32 v71, a102
  v_accvgpr_read_b32 v72, a166
  v_accvgpr_read_b32 v73, a39
  v_accvgpr_read_b32 v74, a103
  v_accvgpr_read_b32 v75, a167
  v_pk_mul_f32 v[64:65], v[64:65], v[136:137] op_sel:[0,1] op_sel_hi:[1,1]
  v_pk_mul_f32 v[66:67], v[66:67], v[136:137] op_sel:[0,1] op_sel_hi:[1,1]
  v_pk_mul_f32 v[68:69], v[68:69], v[136:137] op_sel:[0,1] op_sel_hi:[1,1]
  v_pk_mul_f32 v[70:71], v[70:71], v[136:137] op_sel:[0,1] op_sel_hi:[1,1]
  v_pk_mul_f32 v[72:73], v[72:73], v[136:137] op_sel:[0,1] op_sel_hi:[1,1]
  v_pk_mul_f32 v[74:75], v[74:75], v[136:137] op_sel:[0,1] op_sel_hi:[1,1]
  v_cvt_pk_bf16_f32 v64, v64, v65
  v_cvt_pk_bf16_f32 v65, v66, v67
  v_cvt_pk_bf16_f32 v66, v68, v69
  v_cvt_pk_bf16_f32 v67, v70, v71
  v_cvt_pk_bf16_f32 v68, v72, v73
  v_cvt_pk_bf16_f32 v69, v74, v75
  ds_write_b64 v148, v[64:65] offset:6592
  ds_write_b64 v148, v[66:67] offset:6600
  ds_write_b64 v148, v[68:69] offset:6608
  v_accvgpr_read_b32 v80, a52
  v_accvgpr_read_b32 v81, a116
  v_accvgpr_read_b32 v82, a180
  v_accvgpr_read_b32 v83, a53
  v_accvgpr_read_b32 v84, a117
  v_accvgpr_read_b32 v85, a181
  v_accvgpr_read_b32 v86, a54
  v_accvgpr_read_b32 v87, a118
  v_accvgpr_read_b32 v88, a182
  v_accvgpr_read_b32 v89, a55
  v_accvgpr_read_b32 v90, a119
  v_accvgpr_read_b32 v91, a183
  v_pk_mul_f32 v[80:81], v[80:81], v[136:137] op_sel:[0,1] op_sel_hi:[1,1]
  v_pk_mul_f32 v[82:83], v[82:83], v[136:137] op_sel:[0,1] op_sel_hi:[1,1]
  v_pk_mul_f32 v[84:85], v[84:85], v[136:137] op_sel:[0,1] op_sel_hi:[1,1]
  v_pk_mul_f32 v[86:87], v[86:87], v[136:137] op_sel:[0,1] op_sel_hi:[1,1]
  v_pk_mul_f32 v[88:89], v[88:89], v[136:137] op_sel:[0,1] op_sel_hi:[1,1]
  v_pk_mul_f32 v[90:91], v[90:91], v[136:137] op_sel:[0,1] op_sel_hi:[1,1]
  v_cvt_pk_bf16_f32 v80, v80, v81
  v_cvt_pk_bf16_f32 v81, v82, v83
  v_cvt_pk_bf16_f32 v82, v84, v85
  v_cvt_pk_bf16_f32 v83, v86, v87
  v_cvt_pk_bf16_f32 v84, v88, v89
  v_cvt_pk_bf16_f32 v85, v90, v91
  ds_write_b64 v148, v[80:81] offset:6688
  ds_write_b64 v148, v[82:83] offset:6696
  ds_write_b64 v148, v[84:85] offset:6704
  ds_read_b128 v[216:219], v149 offset:6400
  ds_read_b128 v[220:223], v150 offset:6400
  ds_read_b128 v[224:227], v151 offset:6400
  ds_read_b128 v[228:231], v149 offset:9600
  ds_read_b128 v[232:235], v150 offset:9600
  ds_read_b128 v[236:239], v151 offset:9600
  v_max_f32 v144, v140, v141
  v_max3_f32 v144, v144, v142, v143
  v_add_f32 v145, v140, v141
  v_add_f32 v146, v142, v143
  v_add_f32 v145, v145, v146
  v_cmp_nge_f32 vcc, 1.0, v144
  v_cmp_u_f32 s[50:51], v145, v145
  s_nop 0
  s_or_b64 vcc, vcc, s[50:51]
  s_or_b32 s50, vcc_lo, vcc_hi
  v_mov_b32 v144, s50
  s_lshl_b32 s51, s36, 2
  s_add_u32 s51, s51, 98304
  v_mov_b32 v145, s51
  ds_write_b32 v145, v144
  v_accvgpr_read_b32 v64, a8
  v_accvgpr_read_b32 v65, a72
  s_waitcnt lgkmcnt(6)
  buffer_store_dwordx4 v[216:219], v4, s[80:83], s52 offen offset:2048 sc1
  v_accvgpr_read_b32 v66, a136
  v_accvgpr_read_b32 v67, a9
  s_waitcnt lgkmcnt(5)
  buffer_store_dwordx4 v[220:223], v4, s[80:83], s52 offen offset:3072 sc1
  v_accvgpr_read_b32 v68, a73
  v_accvgpr_read_b32 v69, a137
  s_add_u32 s52, s52, 4096
  v_accvgpr_read_b32 v70, a10
  v_accvgpr_read_b32 v71, a74
  s_waitcnt lgkmcnt(4)
  buffer_store_dwordx4 v[224:227], v4, s[80:83], s52 offen offset:0 sc1
  v_accvgpr_read_b32 v72, a138
  v_accvgpr_read_b32 v73, a11
  s_waitcnt lgkmcnt(3)
  buffer_store_dwordx4 v[228:231], v4, s[80:83], s52 offen offset:1024 sc1
  v_accvgpr_read_b32 v74, a75
  v_accvgpr_read_b32 v75, a139
  s_waitcnt lgkmcnt(2)
  buffer_store_dwordx4 v[232:235], v4, s[80:83], s52 offen offset:2048 sc1
  v_pk_mul_f32 v[64:65], v[64:65], v[138:139] op_sel:[0,0] op_sel_hi:[1,0]
  v_pk_mul_f32 v[66:67], v[66:67], v[138:139] op_sel:[0,0] op_sel_hi:[1,0]
  s_waitcnt lgkmcnt(1)
  buffer_store_dwordx4 v[236:239], v4, s[80:83], s52 offen offset:3072 sc1
  v_pk_mul_f32 v[68:69], v[68:69], v[138:139] op_sel:[0,0] op_sel_hi:[1,0]
  v_pk_mul_f32 v[70:71], v[70:71], v[138:139] op_sel:[0,0] op_sel_hi:[1,0]
  v_pk_mul_f32 v[72:73], v[72:73], v[138:139] op_sel:[0,0] op_sel_hi:[1,0]
  v_pk_mul_f32 v[74:75], v[74:75], v[138:139] op_sel:[0,0] op_sel_hi:[1,0]
  v_cvt_pk_bf16_f32 v64, v64, v65
  v_cvt_pk_bf16_f32 v65, v66, v67
  v_cvt_pk_bf16_f32 v66, v68, v69
  v_cvt_pk_bf16_f32 v67, v70, v71
  v_cvt_pk_bf16_f32 v68, v72, v73
  v_cvt_pk_bf16_f32 v69, v74, v75
  ds_write_b64 v148, v[64:65] offset:0
  ds_write_b64 v148, v[66:67] offset:8
  ds_write_b64 v148, v[68:69] offset:16
  v_accvgpr_read_b32 v80, a24
  v_accvgpr_read_b32 v81, a88
  v_accvgpr_read_b32 v82, a152
  v_accvgpr_read_b32 v83, a25
  v_accvgpr_read_b32 v84, a89
  v_accvgpr_read_b32 v85, a153
  v_accvgpr_read_b32 v86, a26
  v_accvgpr_read_b32 v87, a90
  v_accvgpr_read_b32 v88, a154
  v_accvgpr_read_b32 v89, a27
  v_accvgpr_read_b32 v90, a91
  v_accvgpr_read_b32 v91, a155
  v_pk_mul_f32 v[80:81], v[80:81], v[138:139] op_sel:[0,0] op_sel_hi:[1,0]
  v_pk_mul_f32 v[82:83], v[82:83], v[138:139] op_sel:[0,0] op_sel_hi:[1,0]
  v_pk_mul_f32 v[84:85], v[84:85], v[138:139] op_sel:[0,0] op_sel_hi:[1,0]
  v_pk_mul_f32 v[86:87], v[86:87], v[138:139] op_sel:[0,0] op_sel_hi:[1,0]
  v_pk_mul_f32 v[88:89], v[88:89], v[138:139] op_sel:[0,0] op_sel_hi:[1,0]
  v_pk_mul_f32 v[90:91], v[90:91], v[138:139] op_sel:[0,0] op_sel_hi:[1,0]
  v_cvt_pk_bf16_f32 v80, v80, v81
  v_cvt_pk_bf16_f32 v81, v82, v83
  v_cvt_pk_bf16_f32 v82, v84, v85
  v_cvt_pk_bf16_f32 v83, v86, v87
  v_cvt_pk_bf16_f32 v84, v88, v89
  v_cvt_pk_bf16_f32 v85, v90, v91
  ds_write_b64 v148, v[80:81] offset:96
  ds_write_b64 v148, v[82:83] offset:104
  ds_write_b64 v148, v[84:85] offset:112
  v_accvgpr_read_b32 v96, a40
  v_accvgpr_read_b32 v97, a104
  v_accvgpr_read_b32 v98, a168
  v_accvgpr_read_b32 v99, a41
  v_accvgpr_read_b32 v100, a105
  v_accvgpr_read_b32 v101, a169
  v_accvgpr_read_b32 v102, a42
  v_accvgpr_read_b32 v103, a106
  v_accvgpr_read_b32 v104, a170
  v_accvgpr_read_b32 v105, a43
  v_accvgpr_read_b32 v106, a107
  v_accvgpr_read_b32 v107, a171
  v_pk_mul_f32 v[96:97], v[96:97], v[138:139] op_sel:[0,0] op_sel_hi:[1,0]
  v_pk_mul_f32 v[98:99], v[98:99], v[138:139] op_sel:[0,0] op_sel_hi:[1,0]
  v_pk_mul_f32 v[100:101], v[100:101], v[138:139] op_sel:[0,0] op_sel_hi:[1,0]
  v_pk_mul_f32 v[102:103], v[102:103], v[138:139] op_sel:[0,0] op_sel_hi:[1,0]
  v_pk_mul_f32 v[104:105], v[104:105], v[138:139] op_sel:[0,0] op_sel_hi:[1,0]
  v_pk_mul_f32 v[106:107], v[106:107], v[138:139] op_sel:[0,0] op_sel_hi:[1,0]
  v_cvt_pk_bf16_f32 v96, v96, v97
  v_cvt_pk_bf16_f32 v97, v98, v99
  v_cvt_pk_bf16_f32 v98, v100, v101
  v_cvt_pk_bf16_f32 v99, v102, v103
  v_cvt_pk_bf16_f32 v100, v104, v105
  v_cvt_pk_bf16_f32 v101, v106, v107
  ds_write_b64 v148, v[96:97] offset:192
  ds_write_b64 v148, v[98:99] offset:200
  ds_write_b64 v148, v[100:101] offset:208
  v_accvgpr_read_b32 v64, a56
  v_accvgpr_read_b32 v65, a120
  v_accvgpr_read_b32 v66, a184
  v_accvgpr_read_b32 v67, a57
  v_accvgpr_read_b32 v68, a121
  v_accvgpr_read_b32 v69, a185
  v_accvgpr_read_b32 v70, a58
  v_accvgpr_read_b32 v71, a122
  v_accvgpr_read_b32 v72, a186
  v_accvgpr_read_b32 v73, a59
  v_accvgpr_read_b32 v74, a123
  v_accvgpr_read_b32 v75, a187
  v_pk_mul_f32 v[64:65], v[64:65], v[138:139] op_sel:[0,0] op_sel_hi:[1,0]
  v_pk_mul_f32 v[66:67], v[66:67], v[138:139] op_sel:[0,0] op_sel_hi:[1,0]
  v_pk_mul_f32 v[68:69], v[68:69], v[138:139] op_sel:[0,0] op_sel_hi:[1,0]
  v_pk_mul_f32 v[70:71], v[70:71], v[138:139] op_sel:[0,0] op_sel_hi:[1,0]
  v_pk_mul_f32 v[72:73], v[72:73], v[138:139] op_sel:[0,0] op_sel_hi:[1,0]
  v_pk_mul_f32 v[74:75], v[74:75], v[138:139] op_sel:[0,0] op_sel_hi:[1,0]
  v_cvt_pk_bf16_f32 v64, v64, v65
  v_cvt_pk_bf16_f32 v65, v66, v67
  v_cvt_pk_bf16_f32 v66, v68, v69
  v_cvt_pk_bf16_f32 v67, v70, v71
  v_cvt_pk_bf16_f32 v68, v72, v73
  v_cvt_pk_bf16_f32 v69, v74, v75
  ds_write_b64 v148, v[64:65] offset:288
  ds_write_b64 v148, v[66:67] offset:296
  ds_write_b64 v148, v[68:69] offset:304
  ds_read_b128 v[192:195], v149 offset:0
  ds_read_b128 v[196:199], v150 offset:0
  ds_read_b128 v[200:203], v151 offset:0
  ds_read_b128 v[204:207], v149 offset:3200
  ds_read_b128 v[208:211], v150 offset:3200
  ds_read_b128 v[212:215], v151 offset:3200
  v_accvgpr_read_b32 v80, a12
  v_accvgpr_read_b32 v81, a76
  s_add_u32 s52, s52, 4096
  v_accvgpr_read_b32 v82, a140
  v_accvgpr_read_b32 v83, a13
  s_waitcnt lgkmcnt(5)
  buffer_store_dwordx4 v[192:195], v4, s[80:83], s52 offen offset:0 sc1
  v_accvgpr_read_b32 v84, a77
  v_accvgpr_read_b32 v85, a141
  s_waitcnt lgkmcnt(4)
  buffer_store_dwordx4 v[196:199], v4, s[80:83], s52 offen offset:1024 sc1
  v_accvgpr_read_b32 v86, a14
  v_accvgpr_read_b32 v87, a78
  s_waitcnt lgkmcnt(3)
  buffer_store_dwordx4 v[200:203], v4, s[80:83], s52 offen offset:2048 sc1
  v_accvgpr_read_b32 v88, a142
  v_accvgpr_read_b32 v89, a15
  s_waitcnt lgkmcnt(2)
  buffer_store_dwordx4 v[204:207], v4, s[80:83], s52 offen offset:3072 sc1
  v_accvgpr_read_b32 v90, a79
  v_accvgpr_read_b32 v91, a143
  s_add_u32 s52, s52, 4096
  v_pk_mul_f32 v[80:81], v[80:81], v[138:139] op_sel:[0,1] op_sel_hi:[1,1]
  v_pk_mul_f32 v[82:83], v[82:83], v[138:139] op_sel:[0,1] op_sel_hi:[1,1]
  s_waitcnt lgkmcnt(1)
  buffer_store_dwordx4 v[208:211], v4, s[80:83], s52 offen offset:0 sc1
  v_pk_mul_f32 v[84:85], v[84:85], v[138:139] op_sel:[0,1] op_sel_hi:[1,1]
  v_pk_mul_f32 v[86:87], v[86:87], v[138:139] op_sel:[0,1] op_sel_hi:[1,1]
  s_waitcnt lgkmcnt(0)
  buffer_store_dwordx4 v[212:215], v4, s[80:83], s52 offen offset:1024 sc1
  v_pk_mul_f32 v[88:89], v[88:89], v[138:139] op_sel:[0,1] op_sel_hi:[1,1]
  v_pk_mul_f32 v[90:91], v[90:91], v[138:139] op_sel:[0,1] op_sel_hi:[1,1]
  v_cvt_pk_bf16_f32 v80, v80, v81
  v_cvt_pk_bf16_f32 v81, v82, v83
  v_cvt_pk_bf16_f32 v82, v84, v85
  v_cvt_pk_bf16_f32 v83, v86, v87
  v_cvt_pk_bf16_f32 v84, v88, v89
  v_cvt_pk_bf16_f32 v85, v90, v91
  ds_write_b64 v148, v[80:81] offset:6400
  ds_write_b64 v148, v[82:83] offset:6408
  ds_write_b64 v148, v[84:85] offset:6416
  v_accvgpr_read_b32 v96, a28
  v_accvgpr_read_b32 v97, a92
  v_accvgpr_read_b32 v98, a156
  v_accvgpr_read_b32 v99, a29
  v_accvgpr_read_b32 v100, a93
  v_accvgpr_read_b32 v101, a157
  v_accvgpr_read_b32 v102, a30
  v_accvgpr_read_b32 v103, a94
  v_accvgpr_read_b32 v104, a158
  v_accvgpr_read_b32 v105, a31
  v_accvgpr_read_b32 v106, a95
  v_accvgpr_read_b32 v107, a159
  v_pk_mul_f32 v[96:97], v[96:97], v[138:139] op_sel:[0,1] op_sel_hi:[1,1]
  v_pk_mul_f32 v[98:99], v[98:99], v[138:139] op_sel:[0,1] op_sel_hi:[1,1]
  v_pk_mul_f32 v[100:101], v[100:101], v[138:139] op_sel:[0,1] op_sel_hi:[1,1]
  v_pk_mul_f32 v[102:103], v[102:103], v[138:139] op_sel:[0,1] op_sel_hi:[1,1]
  v_pk_mul_f32 v[104:105], v[104:105], v[138:139] op_sel:[0,1] op_sel_hi:[1,1]
  v_pk_mul_f32 v[106:107], v[106:107], v[138:139] op_sel:[0,1] op_sel_hi:[1,1]
  v_cvt_pk_bf16_f32 v96, v96, v97
  v_cvt_pk_bf16_f32 v97, v98, v99
  v_cvt_pk_bf16_f32 v98, v100, v101
  v_cvt_pk_bf16_f32 v99, v102, v103
  v_cvt_pk_bf16_f32 v100, v104, v105
  v_cvt_pk_bf16_f32 v101, v106, v107
  ds_write_b64 v148, v[96:97] offset:6496
  ds_write_b64 v148, v[98:99] offset:6504
  ds_write_b64 v148, v[100:101] offset:6512
  v_accvgpr_read_b32 v64, a44
  v_accvgpr_read_b32 v65, a108
  v_accvgpr_read_b32 v66, a172
  v_accvgpr_read_b32 v67, a45
  v_accvgpr_read_b32 v68, a109
  v_accvgpr_read_b32 v69, a173
  v_accvgpr_read_b32 v70, a46
  v_accvgpr_read_b32 v71, a110
  v_accvgpr_read_b32 v72, a174
  v_accvgpr_read_b32 v73, a47
  v_accvgpr_read_b32 v74, a111
  v_accvgpr_read_b32 v75, a175
  v_pk_mul_f32 v[64:65], v[64:65], v[138:139] op_sel:[0,1] op_sel_hi:[1,1]
  v_pk_mul_f32 v[66:67], v[66:67], v[138:139] op_sel:[0,1] op_sel_hi:[1,1]
  v_pk_mul_f32 v[68:69], v[68:69], v[138:139] op_sel:[0,1] op_sel_hi:[1,1]
  v_pk_mul_f32 v[70:71], v[70:71], v[138:139] op_sel:[0,1] op_sel_hi:[1,1]
  v_pk_mul_f32 v[72:73], v[72:73], v[138:139] op_sel:[0,1] op_sel_hi:[1,1]
  v_pk_mul_f32 v[74:75], v[74:75], v[138:139] op_sel:[0,1] op_sel_hi:[1,1]
  v_cvt_pk_bf16_f32 v64, v64, v65
  v_cvt_pk_bf16_f32 v65, v66, v67
  v_cvt_pk_bf16_f32 v66, v68, v69
  v_cvt_pk_bf16_f32 v67, v70, v71
  v_cvt_pk_bf16_f32 v68, v72, v73
  v_cvt_pk_bf16_f32 v69, v74, v75
  ds_write_b64 v148, v[64:65] offset:6592
  ds_write_b64 v148, v[66:67] offset:6600
  ds_write_b64 v148, v[68:69] offset:6608
  v_accvgpr_read_b32 v80, a60
  v_accvgpr_read_b32 v81, a124
  v_accvgpr_read_b32 v82, a188
  v_accvgpr_read_b32 v83, a61
  v_accvgpr_read_b32 v84, a125
  v_accvgpr_read_b32 v85, a189
  v_accvgpr_read_b32 v86, a62
  v_accvgpr_read_b32 v87, a126
  v_accvgpr_read_b32 v88, a190
  v_accvgpr_read_b32 v89, a63
  v_accvgpr_read_b32 v90, a127
  v_accvgpr_read_b32 v91, a191
  v_pk_mul_f32 v[80:81], v[80:81], v[138:139] op_sel:[0,1] op_sel_hi:[1,1]
  v_pk_mul_f32 v[82:83], v[82:83], v[138:139] op_sel:[0,1] op_sel_hi:[1,1]
  v_pk_mul_f32 v[84:85], v[84:85], v[138:139] op_sel:[0,1] op_sel_hi:[1,1]
  v_pk_mul_f32 v[86:87], v[86:87], v[138:139] op_sel:[0,1] op_sel_hi:[1,1]
  v_pk_mul_f32 v[88:89], v[88:89], v[138:139] op_sel:[0,1] op_sel_hi:[1,1]
  v_pk_mul_f32 v[90:91], v[90:91], v[138:139] op_sel:[0,1] op_sel_hi:[1,1]
  v_cvt_pk_bf16_f32 v80, v80, v81
  v_cvt_pk_bf16_f32 v81, v82, v83
  v_cvt_pk_bf16_f32 v82, v84, v85
  v_cvt_pk_bf16_f32 v83, v86, v87
  v_cvt_pk_bf16_f32 v84, v88, v89
  v_cvt_pk_bf16_f32 v85, v90, v91
  ds_write_b64 v148, v[80:81] offset:6688
  ds_write_b64 v148, v[82:83] offset:6696
  ds_write_b64 v148, v[84:85] offset:6704
  ds_read_b128 v[216:219], v149 offset:6400
  ds_read_b128 v[220:223], v150 offset:6400
  ds_read_b128 v[224:227], v151 offset:6400
  ds_read_b128 v[228:231], v149 offset:9600
  ds_read_b128 v[232:235], v150 offset:9600
  ds_read_b128 v[236:239], v151 offset:9600
  s_waitcnt lgkmcnt(5)
  buffer_store_dwordx4 v[216:219], v4, s[80:83], s52 offen offset:2048 sc1
  s_waitcnt lgkmcnt(4)
  buffer_store_dwordx4 v[220:223], v4, s[80:83], s52 offen offset:3072 sc1
  s_add_u32 s52, s52, 4096
  s_waitcnt lgkmcnt(3)
  buffer_store_dwordx4 v[224:227], v4, s[80:83], s52 offen offset:0 sc1
  s_waitcnt lgkmcnt(2)
  buffer_store_dwordx4 v[228:231], v4, s[80:83], s52 offen offset:1024 sc1
  s_waitcnt lgkmcnt(1)
  buffer_store_dwordx4 v[232:235], v4, s[80:83], s52 offen offset:2048 sc1
  s_waitcnt lgkmcnt(0)
  buffer_store_dwordx4 v[236:239], v4, s[80:83], s52 offen offset:3072 sc1
  v_mov_b32 v140, 98304
  s_barrier
  ds_read_b128 v[136:139], v140
  s_waitcnt lgkmcnt(0)
  v_or3_b32 v140, v136, v137, v138
  v_or_b32 v140, v140, v139
  s_nop 0
  v_readfirstlane_b32 s50, v140
  s_cmp_lg_u32 s57, 0
  s_cbranch_scc1 L_end
  s_cmp_eq_u32 s50, 0
  s_cbranch_scc1 L_end
  s_waitcnt vmcnt(0) lgkmcnt(0)
  s_xor_b32 s79, s39, 1
  s_lshl_b32 s50, s79, 9
  buffer_load_dwordx2 v[2:3], v1, s[4:7], s50 offen sc1
  s_waitcnt vmcnt(0)
  v_cmp_eq_u64 vcc, s[88:89], v[2:3]
  s_nop 4
  s_cbranch_vccz L_slow24
L_ret24:
  s_barrier
  v_mov_b32 v112, 0xff800000
  v_mov_b32 v113, 0xff800000
  v_mov_b32 v114, 0xff800000
  v_mov_b32 v115, 0xff800000
  s_mov_b32 s40, 0
L_fb_loop:
  s_add_u32 s50, s40, 0
  buffer_load_dwordx4 v[64:67], v4, s[4:7], s50 offen offset:0 sc1
  s_add_u32 s50, s40, 0
  buffer_load_dwordx4 v[68:71], v4, s[4:7], s50 offen offset:1024 sc1
  s_add_u32 s50, s40, 0
  buffer_load_dwordx4 v[72:75], v4, s[4:7], s50 offen offset:2048 sc1
  s_add_u32 s50, s40, 0
  buffer_load_dwordx4 v[76:79], v4, s[4:7], s50 offen offset:3072 sc1
  s_add_u32 s50, s40, 4096
  buffer_load_dwordx4 v[80:83], v4, s[4:7], s50 offen offset:0 sc1
  s_add_u32 s50, s40, 4096
  buffer_load_dwordx4 v[84:87], v4, s[4:7], s50 offen offset:1024 sc1
  s_add_u32 s50, s40, 4096
  buffer_load_dwordx4 v[88:91], v4, s[4:7], s50 offen offset:2048 sc1
  s_add_u32 s50, s40, 4096
  buffer_load_dwordx4 v[92:95], v4, s[4:7], s50 offen offset:3072 sc1
  s_add_u32 s50, s40, 8192
  buffer_load_dwordx4 v[96:99], v4, s[4:7], s50 offen offset:0 sc1
  s_add_u32 s50, s40, 8192
  buffer_load_dwordx4 v[100:103], v4, s[4:7], s50 offen offset:1024 sc1
  s_add_u32 s50, s40, 8192
  buffer_load_dwordx4 v[104:107], v4, s[4:7], s50 offen offset:2048 sc1
  s_add_u32 s50, s40, 8192
  buffer_load_dwordx4 v[108:111], v4, s[4:7], s50 offen offset:3072 sc1
  s_waitcnt vmcnt(0)
  v_mfma_f32_16x16x32_bf16 v[136:139], v[64:67], v[16:19], 0
  v_mfma_f32_16x16x32_bf16 v[136:139], v[68:71], v[20:23], v[136:139]
  v_mfma_f32_16x16x32_bf16 v[136:139], v[72:75], v[24:27], v[136:139]
  v_mfma_f32_16x16x32_bf16 v[136:139], v[76:79], v[28:31], v[136:139]
  v_mfma_f32_16x16x32_bf16 v[136:139], v[80:83], v[32:35], v[136:139]
  v_mfma_f32_16x16x32_bf16 v[136:139], v[84:87], v[36:39], v[136:139]
  v_mfma_f32_16x16x32_bf16 v[140:143], v[88:91], v[16:19], 0
  v_mfma_f32_16x16x32_bf16 v[140:143], v[92:95], v[20:23], v[140:143]
  v_mfma_f32_16x16x32_bf16 v[140:143], v[96:99], v[24:27], v[140:143]
  v_mfma_f32_16x16x32_bf16 v[140:143], v[100:103], v[28:31], v[140:143]
  v_mfma_f32_16x16x32_bf16 v[140:143], v[104:107], v[32:35], v[140:143]
  v_mfma_f32_16x16x32_bf16 v[140:143], v[108:111], v[36:39], v[140:143]
  v_mfma_f32_16x16x32_bf16 v[144:147], v[64:67], v[40:43], 0
  v_mfma_f32_16x16x32_bf16 v[144:147], v[68:71], v[44:47], v[144:147]
  v_mfma_f32_16x16x32_bf16 v[144:147], v[72:75], v[48:51], v[144:147]
  v_mfma_f32_16x16x32_bf16 v[144:147], v[76:79], v[52:55], v[144:147]
  v_mfma_f32_16x16x32_bf16 v[144:147], v[80:83], v[56:59], v[144:147]
  v_mfma_f32_16x16x32_bf16 v[144:147], v[84:87], v[60:63], v[144:147]
  v_mfma_f32_16x16x32_bf16 v[148:151], v[88:91], v[40:43], 0
  v_mfma_f32_16x16x32_bf16 v[148:151], v[92:95], v[44:47], v[148:151]
  v_mfma_f32_16x16x32_bf16 v[148:151], v[96:99], v[48:51], v[148:151]
  v_mfma_f32_16x16x32_bf16 v[148:151], v[100:103], v[52:55], v[148:151]
  v_mfma_f32_16x16x32_bf16 v[148:151], v[104:107], v[56:59], v[148:151]
  v_mfma_f32_16x16x32_bf16 v[148:151], v[108:111], v[60:63], v[148:151]
  v_mfma_f32_16x16x32_bf16 v[152:155], v[64:67], a[208:211], 0
  v_mfma_f32_16x16x32_bf16 v[152:155], v[68:71], a[212:215], v[152:155]
  v_mfma_f32_16x16x32_bf16 v[152:155], v[72:75], a[216:219], v[152:155]
  v_mfma_f32_16x16x32_bf16 v[152:155], v[76:79], a[220:223], v[152:155]
  v_mfma_f32_16x16x32_bf16 v[152:155], v[80:83], a[224:227], v[152:155]
  v_mfma_f32_16x16x32_bf16 v[152:155], v[84:87], a[228:231], v[152:155]
  v_mfma_f32_16x16x32_bf16 v[156:159], v[88:91], a[208:211], 0
  v_mfma_f32_16x16x32_bf16 v[156:159], v[92:95], a[212:215], v[156:159]
  v_mfma_f32_16x16x32_bf16 v[156:159], v[96:99], a[216:219], v[156:159]
  v_mfma_f32_16x16x32_bf16 v[156:159], v[100:103], a[220:223], v[156:159]
  v_mfma_f32_16x16x32_bf16 v[156:159], v[104:107], a[224:227], v[156:159]
  v_mfma_f32_16x16x32_bf16 v[156:159], v[108:111], a[228:231], v[156:159]
  v_mfma_f32_16x16x32_bf16 v[160:163], v[64:67], a[232:235], 0
  v_mfma_f32_16x16x32_bf16 v[160:163], v[68:71], a[236:239], v[160:163]
  v_mfma_f32_16x16x32_bf16 v[160:163], v[72:75], a[240:243], v[160:163]
  v_mfma_f32_16x16x32_bf16 v[160:163], v[76:79], a[244:247], v[160:163]
  v_mfma_f32_16x16x32_bf16 v[160:163], v[80:83], a[248:251], v[160:163]
  v_mfma_f32_16x16x32_bf16 v[160:163], v[84:87], a[252:255], v[160:163]
  v_mfma_f32_16x16x32_bf16 v[164:167], v[88:91], a[232:235], 0
  v_mfma_f32_16x16x32_bf16 v[164:167], v[92:95], a[236:239], v[164:167]
  v_mfma_f32_16x16x32_bf16 v[164:167], v[96:99], a[240:243], v[164:167]
  v_mfma_f32_16x16x32_bf16 v[164:167], v[100:103], a[244:247], v[164:167]
  v_mfma_f32_16x16x32_bf16 v[164:167], v[104:107], a[248:251], v[164:167]
  v_mfma_f32_16x16x32_bf16 v[164:167], v[108:111], a[252:255], v[164:167]
  v_max3_f32 v112, v112, v136, v137
  v_max3_f32 v112, v112, v138, v139
  v_max3_f32 v112, v112, v140, v141
  v_max3_f32 v112, v112, v142, v143
  v_max3_f32 v113, v113, v144, v145
  v_max3_f32 v113, v113, v146, v147
  v_max3_f32 v113, v113, v148, v149
  v_max3_f32 v113, v113, v150, v151
  v_max3_f32 v114, v114, v152, v153
  v_max3_f32 v114, v114, v154, v155
  v_max3_f32 v114, v114, v156, v157
  v_max3_f32 v114, v114, v158, v159
  v_max3_f32 v115, v115, v160, v161
  v_max3_f32 v115, v115, v162, v163
  v_max3_f32 v115, v115, v164, v165
  v_max3_f32 v115, v115, v166, v167
  s_add_u32 s40, s40, 24576
  s_cmp_lt_u32 s40, 1572864
  s_cbranch_scc1 L_fb_loop
  v_mov_b32 v116, v112
  v_mov_b32 v117, v116
  v_mov_b32 v120, v113
  v_mov_b32 v121, v120
  v_mov_b32 v124, v114
  v_mov_b32 v125, v124
  v_mov_b32 v128, v115
  v_mov_b32 v129, v128
  v_permlane32_swap_b32 v116, v117
  v_permlane32_swap_b32 v120, v121
  v_permlane32_swap_b32 v124, v125
  v_permlane32_swap_b32 v128, v129
  v_max_f32 v116, v116, v117
  v_mov_b32 v117, v116
  v_max_f32 v120, v120, v121
  v_mov_b32 v121, v120
  v_max_f32 v124, v124, v125
  v_mov_b32 v125, v124
  v_max_f32 v128, v128, v129
  v_mov_b32 v129, v128
  v_permlane16_swap_b32 v116, v117
  v_permlane16_swap_b32 v120, v121
  v_permlane16_swap_b32 v124, v125
  v_permlane16_swap_b32 v128, v129
  v_max_f32 v116, v116, v117
  v_sub_f32 v168, 0x80000000, v116
  v_mov_b32 v169, v168
  v_mov_b32 v170, v168
  v_mov_b32 v171, v168
  v_max_f32 v120, v120, v121
  v_sub_f32 v172, 0x80000000, v120
  v_mov_b32 v173, v172
  v_mov_b32 v174, v172
  v_mov_b32 v175, v172
  v_max_f32 v124, v124, v125
  v_sub_f32 v176, 0x80000000, v124
  v_mov_b32 v177, v176
  v_mov_b32 v178, v176
  v_mov_b32 v179, v176
  v_max_f32 v128, v128, v129
  v_sub_f32 v180, 0x80000000, v128
  v_mov_b32 v181, v180
  v_mov_b32 v182, v180
  v_mov_b32 v183, v180
  s_mov_b32 s57, 1
  s_xor_b32 s79, s39, 0
  s_mul_i32 s40, s79, 24576
  s_add_u32 m0, s37, 0
  s_nop 0
  buffer_load_dwordx4 v8, s[4:7], s40 offen offset:0 sc1 lds
  buffer_load_dwordx4 v8, s[4:7], s40 offen offset:1024 sc1 lds
  buffer_load_dwordx4 v8, s[4:7], s40 offen offset:2048 sc1 lds
  s_add_u32 m0, s37, 49152
  s_nop 0
  buffer_load_dwordx4 v9, s[4:7], s40 offen offset:0 sc1 lds
  buffer_load_dwordx4 v9, s[4:7], s40 offen offset:1024 sc1 lds
  buffer_load_dwordx4 v9, s[4:7], s40 offen offset:2048 sc1 lds
  s_xor_b32 s79, s39, 1
  s_mul_i32 s40, s79, 24576
  s_add_u32 m0, s37, 12288
  s_nop 0
  buffer_load_dwordx4 v8, s[4:7], s40 offen offset:0 sc1 lds
  buffer_load_dwordx4 v8, s[4:7], s40 offen offset:1024 sc1 lds
  buffer_load_dwordx4 v8, s[4:7], s40 offen offset:2048 sc1 lds
  s_add_u32 m0, s37, 61440
  s_nop 0
  buffer_load_dwordx4 v9, s[4:7], s40 offen offset:0 sc1 lds
  buffer_load_dwordx4 v9, s[4:7], s40 offen offset:1024 sc1 lds
  buffer_load_dwordx4 v9, s[4:7], s40 offen offset:2048 sc1 lds
  s_xor_b32 s79, s39, 2
  s_mul_i32 s40, s79, 24576
  s_add_u32 m0, s37, 24576
  s_nop 0
  buffer_load_dwordx4 v8, s[4:7], s40 offen offset:0 sc1 lds
  buffer_load_dwordx4 v8, s[4:7], s40 offen offset:1024 sc1 lds
  buffer_load_dwordx4 v8, s[4:7], s40 offen offset:2048 sc1 lds
  s_add_u32 m0, s37, 73728
  s_nop 0
  buffer_load_dwordx4 v9, s[4:7], s40 offen offset:0 sc1 lds
  buffer_load_dwordx4 v9, s[4:7], s40 offen offset:1024 sc1 lds
  buffer_load_dwordx4 v9, s[4:7], s40 offen offset:2048 sc1 lds
  v_accvgpr_write_b32 a0, 0
  v_accvgpr_write_b32 a1, 0
  v_accvgpr_write_b32 a2, 0
  v_accvgpr_write_b32 a3, 0
  v_accvgpr_write_b32 a4, 0
  v_accvgpr_write_b32 a5, 0
  v_accvgpr_write_b32 a6, 0
  v_accvgpr_write_b32 a7, 0
  v_accvgpr_write_b32 a8, 0
  v_accvgpr_write_b32 a9, 0
  v_accvgpr_write_b32 a10, 0
  v_accvgpr_write_b32 a11, 0
  v_accvgpr_write_b32 a12, 0
  v_accvgpr_write_b32 a13, 0
  v_accvgpr_write_b32 a14, 0
  v_accvgpr_write_b32 a15, 0
  v_accvgpr_write_b32 a16, 0
  v_accvgpr_write_b32 a17, 0
  v_accvgpr_write_b32 a18, 0
  v_accvgpr_write_b32 a19, 0
  v_accvgpr_write_b32 a20, 0
  v_accvgpr_write_b32 a21, 0
  v_accvgpr_write_b32 a22, 0
  v_accvgpr_write_b32 a23, 0
  v_accvgpr_write_b32 a24, 0
  v_accvgpr_write_b32 a25, 0
  v_accvgpr_write_b32 a26, 0
  v_accvgpr_write_b32 a27, 0
  v_accvgpr_write_b32 a28, 0
  v_accvgpr_write_b32 a29, 0
  v_accvgpr_write_b32 a30, 0
  v_accvgpr_write_b32 a31, 0
  v_accvgpr_write_b32 a32, 0
  v_accvgpr_write_b32 a33, 0
  v_accvgpr_write_b32 a34, 0
  v_accvgpr_write_b32 a35, 0
  v_accvgpr_write_b32 a36, 0
  v_accvgpr_write_b32 a37, 0
  v_accvgpr_write_b32 a38, 0
  v_accvgpr_write_b32 a39, 0
  v_accvgpr_write_b32 a40, 0
  v_accvgpr_write_b32 a41, 0
  v_accvgpr_write_b32 a42, 0
  v_accvgpr_write_b32 a43, 0
  v_accvgpr_write_b32 a44, 0
  v_accvgpr_write_b32 a45, 0
  v_accvgpr_write_b32 a46, 0
  v_accvgpr_write_b32 a47, 0
  v_accvgpr_write_b32 a48, 0
  v_accvgpr_write_b32 a49, 0
  v_accvgpr_write_b32 a50, 0
  v_accvgpr_write_b32 a51, 0
  v_accvgpr_write_b32 a52, 0
  v_accvgpr_write_b32 a53, 0
  v_accvgpr_write_b32 a54, 0
  v_accvgpr_write_b32 a55, 0
  v_accvgpr_write_b32 a56, 0
  v_accvgpr_write_b32 a57, 0
  v_accvgpr_write_b32 a58, 0
  v_accvgpr_write_b32 a59, 0
  v_accvgpr_write_b32 a60, 0
  v_accvgpr_write_b32 a61, 0
  v_accvgpr_write_b32 a62, 0
  v_accvgpr_write_b32 a63, 0
  v_accvgpr_write_b32 a64, 0
  v_accvgpr_write_b32 a65, 0
  v_accvgpr_write_b32 a66, 0
  v_accvgpr_write_b32 a67, 0
  v_accvgpr_write_b32 a68, 0
  v_accvgpr_write_b32 a69, 0
  v_accvgpr_write_b32 a70, 0
  v_accvgpr_write_b32 a71, 0
  v_accvgpr_write_b32 a72, 0
  v_accvgpr_write_b32 a73, 0
  v_accvgpr_write_b32 a74, 0
  v_accvgpr_write_b32 a75, 0
  v_accvgpr_write_b32 a76, 0
  v_accvgpr_write_b32 a77, 0
  v_accvgpr_write_b32 a78, 0
  v_accvgpr_write_b32 a79, 0
  v_accvgpr_write_b32 a80, 0
  v_accvgpr_write_b32 a81, 0
  v_accvgpr_write_b32 a82, 0
  v_accvgpr_write_b32 a83, 0
  v_accvgpr_write_b32 a84, 0
  v_accvgpr_write_b32 a85, 0
  v_accvgpr_write_b32 a86, 0
  v_accvgpr_write_b32 a87, 0
  v_accvgpr_write_b32 a88, 0
  v_accvgpr_write_b32 a89, 0
  v_accvgpr_write_b32 a90, 0
  v_accvgpr_write_b32 a91, 0
  v_accvgpr_write_b32 a92, 0
  v_accvgpr_write_b32 a93, 0
  v_accvgpr_write_b32 a94, 0
  v_accvgpr_write_b32 a95, 0
  v_accvgpr_write_b32 a96, 0
  v_accvgpr_write_b32 a97, 0
  v_accvgpr_write_b32 a98, 0
  v_accvgpr_write_b32 a99, 0
  v_accvgpr_write_b32 a100, 0
  v_accvgpr_write_b32 a101, 0
  v_accvgpr_write_b32 a102, 0
  v_accvgpr_write_b32 a103, 0
  v_accvgpr_write_b32 a104, 0
  v_accvgpr_write_b32 a105, 0
  v_accvgpr_write_b32 a106, 0
  v_accvgpr_write_b32 a107, 0
  v_accvgpr_write_b32 a108, 0
  v_accvgpr_write_b32 a109, 0
  v_accvgpr_write_b32 a110, 0
  v_accvgpr_write_b32 a111, 0
  v_accvgpr_write_b32 a112, 0
  v_accvgpr_write_b32 a113, 0
  v_accvgpr_write_b32 a114, 0
  v_accvgpr_write_b32 a115, 0
  v_accvgpr_write_b32 a116, 0
  v_accvgpr_write_b32 a117, 0
  v_accvgpr_write_b32 a118, 0
  v_accvgpr_write_b32 a119, 0
  v_accvgpr_write_b32 a120, 0
  v_accvgpr_write_b32 a121, 0
  v_accvgpr_write_b32 a122, 0
  v_accvgpr_write_b32 a123, 0
  v_accvgpr_write_b32 a124, 0
  v_accvgpr_write_b32 a125, 0
  v_accvgpr_write_b32 a126, 0
  v_accvgpr_write_b32 a127, 0
  v_accvgpr_write_b32 a128, 0
  v_accvgpr_write_b32 a129, 0
  v_accvgpr_write_b32 a130, 0
  v_accvgpr_write_b32 a131, 0
  v_accvgpr_write_b32 a132, 0
  v_accvgpr_write_b32 a133, 0
  v_accvgpr_write_b32 a134, 0
  v_accvgpr_write_b32 a135, 0
  v_accvgpr_write_b32 a136, 0
  v_accvgpr_write_b32 a137, 0
  v_accvgpr_write_b32 a138, 0
  v_accvgpr_write_b32 a139, 0
  v_accvgpr_write_b32 a140, 0
  v_accvgpr_write_b32 a141, 0
  v_accvgpr_write_b32 a142, 0
  v_accvgpr_write_b32 a143, 0
  v_accvgpr_write_b32 a144, 0
  v_accvgpr_write_b32 a145, 0
  v_accvgpr_write_b32 a146, 0
  v_accvgpr_write_b32 a147, 0
  v_accvgpr_write_b32 a148, 0
  v_accvgpr_write_b32 a149, 0
  v_accvgpr_write_b32 a150, 0
  v_accvgpr_write_b32 a151, 0
  v_accvgpr_write_b32 a152, 0
  v_accvgpr_write_b32 a153, 0
  v_accvgpr_write_b32 a154, 0
  v_accvgpr_write_b32 a155, 0
  v_accvgpr_write_b32 a156, 0
  v_accvgpr_write_b32 a157, 0
  v_accvgpr_write_b32 a158, 0
  v_accvgpr_write_b32 a159, 0
  v_accvgpr_write_b32 a160, 0
  v_accvgpr_write_b32 a161, 0
  v_accvgpr_write_b32 a162, 0
  v_accvgpr_write_b32 a163, 0
  v_accvgpr_write_b32 a164, 0
  v_accvgpr_write_b32 a165, 0
  v_accvgpr_write_b32 a166, 0
  v_accvgpr_write_b32 a167, 0
  v_accvgpr_write_b32 a168, 0
  v_accvgpr_write_b32 a169, 0
  v_accvgpr_write_b32 a170, 0
  v_accvgpr_write_b32 a171, 0
  v_accvgpr_write_b32 a172, 0
  v_accvgpr_write_b32 a173, 0
  v_accvgpr_write_b32 a174, 0
  v_accvgpr_write_b32 a175, 0
  v_accvgpr_write_b32 a176, 0
  v_accvgpr_write_b32 a177, 0
  v_accvgpr_write_b32 a178, 0
  v_accvgpr_write_b32 a179, 0
  v_accvgpr_write_b32 a180, 0
  v_accvgpr_write_b32 a181, 0
  v_accvgpr_write_b32 a182, 0
  v_accvgpr_write_b32 a183, 0
  v_accvgpr_write_b32 a184, 0
  v_accvgpr_write_b32 a185, 0
  v_accvgpr_write_b32 a186, 0
  v_accvgpr_write_b32 a187, 0
  v_accvgpr_write_b32 a188, 0
  v_accvgpr_write_b32 a189, 0
  v_accvgpr_write_b32 a190, 0
  v_accvgpr_write_b32 a191, 0
  v_accvgpr_write_b32 a192, 0
  v_accvgpr_write_b32 a193, 0
  v_accvgpr_write_b32 a194, 0
  v_accvgpr_write_b32 a195, 0
  v_accvgpr_write_b32 a196, 0
  v_accvgpr_write_b32 a197, 0
  v_accvgpr_write_b32 a198, 0
  v_accvgpr_write_b32 a199, 0
  v_accvgpr_write_b32 a200, 0
  v_accvgpr_write_b32 a201, 0
  v_accvgpr_write_b32 a202, 0
  v_accvgpr_write_b32 a203, 0
  v_accvgpr_write_b32 a204, 0
  v_accvgpr_write_b32 a205, 0
  v_accvgpr_write_b32 a206, 0
  v_accvgpr_write_b32 a207, 0
  s_xor_b32 s50, s76, 1536
  buffer_load_dwordx2 v[2:3], v1, s[4:7], s50 offen sc1
  s_xor_b32 s50, s76, 2048
  buffer_load_dwordx2 v[6:7], v1, s[4:7], s50 offen sc1
  s_xor_b32 s50, s76, 1536
  s_mul_i32 s40, s50, 48
  s_xor_b32 s50, s76, 2048
  s_mul_i32 s48, s50, 48
  s_mov_b32 s3, 2048
  s_waitcnt vmcnt(0)
  s_barrier
  ds_read_b128 v[64:67], v4 offset:0
  ds_read_b128 v[68:71], v4 offset:1024
  ds_read_b128 v[72:75], v4 offset:2048
  ds_read_b128 v[76:79], v4 offset:3072
  ds_read_b128 v[80:83], v4 offset:4096
  ds_read_b128 v[84:87], v4 offset:5120
  ds_read_b128 v[88:91], v4 offset:6144
  ds_read_b128 v[92:95], v4 offset:7168
  ds_read_b128 v[96:99], v4 offset:8192
  ds_read_b128 v[100:103], v4 offset:9216
  ds_read_b128 v[104:107], v4 offset:10240
  ds_read_b128 v[108:111], v4 offset:11264
  s_waitcnt lgkmcnt(0)
  s_mov_b32 s41, 16
  s_nop 7
  s_branch L_loopC
L_slow0:
  s_mov_b32 s100, 0
  s_branch L_wait
L_slow1:
  s_mov_b32 s100, 1
  s_branch L_wait
L_slow2:
  s_mov_b32 s100, 2
  s_branch L_waitl
L_slow3:
  s_mov_b32 s100, 3
  s_branch L_waitl
L_slow4:
  s_mov_b32 s100, 4
  s_branch L_waitl
L_slow5:
  s_mov_b32 s100, 5
  s_branch L_waitl
L_slow6:
  s_mov_b32 s100, 6
  s_branch L_waitl
L_slow7:
  s_mov_b32 s100, 7
  s_branch L_waitl
L_slow8:
  s_mov_b32 s100, 8
  s_branch L_waitl
L_slow9:
  s_mov_b32 s100, 9
  s_branch L_waitl
L_slow10:
  s_mov_b32 s100, 10
  s_branch L_waitl
L_slow11:
  s_mov_b32 s100, 11
  s_branch L_waitl
L_slow12:
  s_mov_b32 s100, 12
  s_branch L_waitl
L_slow13:
  s_mov_b32 s100, 13
  s_branch L_waitl
L_slow14:
  s_mov_b32 s100, 14
  s_branch L_waitl
L_slow15:
  s_mov_b32 s100, 15
  s_branch L_waitl
L_slow16:
  s_mov_b32 s100, 16
  s_branch L_waitl
L_slow17:
  s_mov_b32 s100, 17
  s_branch L_waitl
L_slow18:
  s_mov_b32 s100, 18
  s_branch L_waitl
L_slow19:
  s_mov_b32 s100, 19
  s_branch L_waitl
L_slow20:
  s_mov_b32 s100, 20
  s_branch L_waitl
L_slow21:
  s_mov_b32 s100, 21
  s_branch L_waitl
L_slow22:
  s_mov_b32 s100, 22
  s_branch L_waitl
L_slow23:
  s_mov_b32 s100, 23
  s_branch L_waitl
L_slow24:
  s_mov_b32 s100, 24
  s_branch L_wait
L_waitl:
  s_sub_u32 s79, s3, 1024
  s_xor_b32 s79, s79, s76
  s_bfe_u32 s79, s79, 0x60009
L_wait:
  s_waitcnt vmcnt(0) lgkmcnt(0)
  s_mov_b32 s101, 40
L_spin:
  s_lshl_b32 s50, s79, 9
  buffer_load_dwordx2 v[64:65], v1, s[4:7], s50 offen sc1
  s_waitcnt vmcnt(0)
  v_cmp_eq_u64 vcc, s[88:89], v[64:65]
  s_nop 4
  s_cbranch_vccnz L_wret
  s_sleep 4
  s_sub_u32 s101, s101, 1
  s_cmp_lg_u32 s101, 0
  s_cbranch_scc1 L_spin
  v_writelane_b32 v140, s60, 0
  v_writelane_b32 v140, s61, 1
  v_writelane_b32 v140, s62, 2
  v_writelane_b32 v140, s63, 3
  v_writelane_b32 v140, s64, 4
  v_writelane_b32 v140, s65, 5
  v_writelane_b32 v140, s66, 6
  v_writelane_b32 v140, s67, 7
  v_writelane_b32 v140, s68, 8
  v_writelane_b32 v140, s69, 9
  v_writelane_b32 v140, s70, 10
  v_writelane_b32 v140, s71, 11
  v_writelane_b32 v140, s72, 12
  v_writelane_b32 v140, s73, 13
  v_writelane_b32 v140, s74, 14
  v_writelane_b32 v140, s75, 15
  s_mul_i32 s52, s79, 24576
  s_add_u32 s53, s52, 12288
  s_mul_i32 s54, s79, 384
  s_lshl_b32 s55, s79, 6
  v_mov_b32 v156, 0
  v_mov_b32 v157, 0
  buffer_load_dwordx4 v[64:67], v184, s[12:15], s52 offen offset:0 sc0 sc1 nt
  buffer_load_dwordx4 v[68:71], v184, s[12:15], s52 offen offset:16 sc0 sc1 nt
  buffer_load_dwordx4 v[72:75], v185, s[24:27], s54 offen offset:0
  buffer_load_dwordx4 v[76:79], v185, s[20:23], s54 offen offset:0
  buffer_load_dwordx4 v[80:83], v184, s[12:15], s52 offen offset:128 sc0 sc1 nt
  buffer_load_dwordx4 v[84:87], v184, s[12:15], s52 offen offset:144 sc0 sc1 nt
  buffer_load_dwordx4 v[88:91], v185, s[24:27], s54 offen offset:64
  buffer_load_dwordx4 v[92:95], v185, s[20:23], s54 offen offset:64
  buffer_load_dwordx4 v[96:99], v184, s[12:15], s52 offen offset:256 sc0 sc1 nt
  buffer_load_dwordx4 v[100:103], v184, s[12:15], s52 offen offset:272 sc0 sc1 nt
  buffer_load_dwordx4 v[104:107], v185, s[24:27], s54 offen offset:128
  buffer_load_dwordx4 v[108:111], v185, s[20:23], s54 offen offset:128
  s_waitcnt vmcnt(11)
  v_cvt_f32_i32 v64, v64
  v_cvt_f32_i32 v65, v65
  s_waitcnt vmcnt(9)
  v_lshlrev_b32 v148, 16, v72
  v_and_b32 v149, s44, v72
  v_cvt_pk_bf16_f32 v64, 0, v64
  v_cvt_pk_bf16_f32 v65, 0, v65
  s_waitcnt vmcnt(8)
  v_lshlrev_b32 v150, 16, v76
  v_and_b32 v151, s44, v76
  v_pk_add_f32 v[64:65], v[64:65], v[148:149] neg_lo:[0,1] neg_hi:[0,1]
  v_pk_mul_f32 v[150:151], v[150:151], s[42:43]
  v_cvt_pk_bf16_f32 v64, 0, v64
  v_cvt_pk_bf16_f32 v65, 0, v65
  v_pk_mul_f32 v[64:65], v[64:65], v[150:151]
  v_cvt_pk_bf16_f32 v72, v64, v65
  v_cvt_f32_i32 v66, v66
  v_cvt_f32_i32 v67, v67
  v_lshlrev_b32 v148, 16, v73
  v_and_b32 v149, s44, v73
  v_cvt_pk_bf16_f32 v66, 0, v66
  v_cvt_pk_bf16_f32 v67, 0, v67
  v_lshlrev_b32 v150, 16, v77
  v_and_b32 v151, s44, v77
  v_pk_add_f32 v[66:67], v[66:67], v[148:149] neg_lo:[0,1] neg_hi:[0,1]
  v_pk_mul_f32 v[150:151], v[150:151], s[42:43]
  v_cvt_pk_bf16_f32 v66, 0, v66
  v_cvt_pk_bf16_f32 v67, 0, v67
  v_pk_mul_f32 v[66:67], v[66:67], v[150:151]
  v_cvt_pk_bf16_f32 v73, v66, v67
  v_cvt_f32_i32 v68, v68
  v_cvt_f32_i32 v69, v69
  v_lshlrev_b32 v148, 16, v74
  v_and_b32 v149, s44, v74
  v_cvt_pk_bf16_f32 v68, 0, v68
  v_cvt_pk_bf16_f32 v69, 0, v69
  v_lshlrev_b32 v150, 16, v78
  v_and_b32 v151, s44, v78
  v_pk_add_f32 v[68:69], v[68:69], v[148:149] neg_lo:[0,1] neg_hi:[0,1]
  v_pk_mul_f32 v[150:151], v[150:151], s[42:43]
  v_cvt_pk_bf16_f32 v68, 0, v68
  v_cvt_pk_bf16_f32 v69, 0, v69
  v_pk_mul_f32 v[68:69], v[68:69], v[150:151]
  v_cvt_pk_bf16_f32 v74, v68, v69
  v_cvt_f32_i32 v70, v70
  v_cvt_f32_i32 v71, v71
  v_lshlrev_b32 v148, 16, v75
  v_and_b32 v149, s44, v75
  v_cvt_pk_bf16_f32 v70, 0, v70
  v_cvt_pk_bf16_f32 v71, 0, v71
  v_lshlrev_b32 v150, 16, v79
  v_and_b32 v151, s44, v79
  v_pk_add_f32 v[70:71], v[70:71], v[148:149] neg_lo:[0,1] neg_hi:[0,1]
  v_pk_mul_f32 v[150:151], v[150:151], s[42:43]
  v_cvt_pk_bf16_f32 v70, 0, v70
  v_cvt_pk_bf16_f32 v71, 0, v71
  v_pk_mul_f32 v[70:71], v[70:71], v[150:151]
  v_cvt_pk_bf16_f32 v75, v70, v71
  buffer_store_dwordx4 v[72:75], v8, s[4:7], s52 offen offset:0 sc1
  s_waitcnt vmcnt(8)
  v_cvt_f32_i32 v80, v80
  v_cvt_f32_i32 v81, v81
  s_waitcnt vmcnt(6)
  v_lshlrev_b32 v148, 16, v88
  v_and_b32 v149, s44, v88
  v_cvt_pk_bf16_f32 v80, 0, v80
  v_cvt_pk_bf16_f32 v81, 0, v81
  s_waitcnt vmcnt(5)
  v_lshlrev_b32 v150, 16, v92
  v_and_b32 v151, s44, v92
  v_pk_add_f32 v[80:81], v[80:81], v[148:149] neg_lo:[0,1] neg_hi:[0,1]
  v_pk_mul_f32 v[150:151], v[150:151], s[42:43]
  v_cvt_pk_bf16_f32 v80, 0, v80
  v_cvt_pk_bf16_f32 v81, 0, v81
  v_pk_mul_f32 v[80:81], v[80:81], v[150:151]
  v_cvt_pk_bf16_f32 v88, v80, v81
  v_cvt_f32_i32 v82, v82
  v_cvt_f32_i32 v83, v83
  v_lshlrev_b32 v148, 16, v89
  v_and_b32 v149, s44, v89
  v_cvt_pk_bf16_f32 v82, 0, v82
  v_cvt_pk_bf16_f32 v83, 0, v83
  v_lshlrev_b32 v150, 16, v93
  v_and_b32 v151, s44, v93
  v_pk_add_f32 v[82:83], v[82:83], v[148:149] neg_lo:[0,1] neg_hi:[0,1]
  v_pk_mul_f32 v[150:151], v[150:151], s[42:43]
  v_cvt_pk_bf16_f32 v82, 0, v82
  v_cvt_pk_bf16_f32 v83, 0, v83
  v_pk_mul_f32 v[82:83], v[82:83], v[150:151]
  v_cvt_pk_bf16_f32 v89, v82, v83
  v_cvt_f32_i32 v84, v84
  v_cvt_f32_i32 v85, v85
  v_lshlrev_b32 v148, 16, v90
  v_and_b32 v149, s44, v90
  v_cvt_pk_bf16_f32 v84, 0, v84
  v_cvt_pk_bf16_f32 v85, 0, v85
  v_lshlrev_b32 v150, 16, v94
  v_and_b32 v151, s44, v94
  v_pk_add_f32 v[84:85], v[84:85], v[148:149] neg_lo:[0,1] neg_hi:[0,1]
  v_pk_mul_f32 v[150:151], v[150:151], s[42:43]
  v_cvt_pk_bf16_f32 v84, 0, v84
  v_cvt_pk_bf16_f32 v85, 0, v85
  v_pk_mul_f32 v[84:85], v[84:85], v[150:151]
  v_cvt_pk_bf16_f32 v90, v84, v85
  v_cvt_f32_i32 v86, v86
  v_cvt_f32_i32 v87, v87
  v_lshlrev_b32 v148, 16, v91
  v_and_b32 v149, s44, v91
  v_cvt_pk_bf16_f32 v86, 0, v86
  v_cvt_pk_bf16_f32 v87, 0, v87
  v_lshlrev_b32 v150, 16, v95
  v_and_b32 v151, s44, v95
  v_pk_add_f32 v[86:87], v[86:87], v[148:149] neg_lo:[0,1] neg_hi:[0,1]
  v_pk_mul_f32 v[150:151], v[150:151], s[42:43]
  v_cvt_pk_bf16_f32 v86, 0, v86
  v_cvt_pk_bf16_f32 v87, 0, v87
  v_pk_mul_f32 v[86:87], v[86:87], v[150:151]
  v_cvt_pk_bf16_f32 v91, v86, v87
  buffer_store_dwordx4 v[88:91], v8, s[4:7], s52 offen offset:1024 sc1
  s_waitcnt vmcnt(5)
  v_cvt_f32_i32 v96, v96
  v_cvt_f32_i32 v97, v97
  s_waitcnt vmcnt(3)
  v_lshlrev_b32 v148, 16, v104
  v_and_b32 v149, s44, v104
  v_cvt_pk_bf16_f32 v96, 0, v96
  v_cvt_pk_bf16_f32 v97, 0, v97
  s_waitcnt vmcnt(2)
  v_lshlrev_b32 v150, 16, v108
  v_and_b32 v151, s44, v108
  v_pk_add_f32 v[96:97], v[96:97], v[148:149] neg_lo:[0,1] neg_hi:[0,1]
  v_pk_mul_f32 v[150:151], v[150:151], s[42:43]
  v_cvt_pk_bf16_f32 v96, 0, v96
  v_cvt_pk_bf16_f32 v97, 0, v97
  v_pk_mul_f32 v[96:97], v[96:97], v[150:151]
  v_cvt_pk_bf16_f32 v104, v96, v97
  v_cvt_f32_i32 v98, v98
  v_cvt_f32_i32 v99, v99
  v_lshlrev_b32 v148, 16, v105
  v_and_b32 v149, s44, v105
  v_cvt_pk_bf16_f32 v98, 0, v98
  v_cvt_pk_bf16_f32 v99, 0, v99
  v_lshlrev_b32 v150, 16, v109
  v_and_b32 v151, s44, v109
  v_pk_add_f32 v[98:99], v[98:99], v[148:149] neg_lo:[0,1] neg_hi:[0,1]
  v_pk_mul_f32 v[150:151], v[150:151], s[42:43]
  v_cvt_pk_bf16_f32 v98, 0, v98
  v_cvt_pk_bf16_f32 v99, 0, v99
  v_pk_mul_f32 v[98:99], v[98:99], v[150:151]
  v_cvt_pk_bf16_f32 v105, v98, v99
  v_cvt_f32_i32 v100, v100
  v_cvt_f32_i32 v101, v101
  v_lshlrev_b32 v148, 16, v106
  v_and_b32 v149, s44, v106
  v_cvt_pk_bf16_f32 v100, 0, v100
  v_cvt_pk_bf16_f32 v101, 0, v101
  v_lshlrev_b32 v150, 16, v110
  v_and_b32 v151, s44, v110
  v_pk_add_f32 v[100:101], v[100:101], v[148:149] neg_lo:[0,1] neg_hi:[0,1]
  v_pk_mul_f32 v[150:151], v[150:151], s[42:43]
  v_cvt_pk_bf16_f32 v100, 0, v100
  v_cvt_pk_bf16_f32 v101, 0, v101
  v_pk_mul_f32 v[100:101], v[100:101], v[150:151]
  v_cvt_pk_bf16_f32 v106, v100, v101
  v_cvt_f32_i32 v102, v102
  v_cvt_f32_i32 v103, v103
  v_lshlrev_b32 v148, 16, v107
  v_and_b32 v149, s44, v107
  v_cvt_pk_bf16_f32 v102, 0, v102
  v_cvt_pk_bf16_f32 v103, 0, v103
  v_lshlrev_b32 v150, 16, v111
  v_and_b32 v151, s44, v111
  v_pk_add_f32 v[102:103], v[102:103], v[148:149] neg_lo:[0,1] neg_hi:[0,1]
  v_pk_mul_f32 v[150:151], v[150:151], s[42:43]
  v_cvt_pk_bf16_f32 v102, 0, v102
  v_cvt_pk_bf16_f32 v103, 0, v103
  v_pk_mul_f32 v[102:103], v[102:103], v[150:151]
  v_cvt_pk_bf16_f32 v107, v102, v103
  buffer_store_dwordx4 v[104:107], v8, s[4:7], s52 offen offset:2048 sc1
  s_nop 1
  buffer_load_short_d16_hi v156, v187, s[32:35], s55 offen
  buffer_load_short_d16_hi v157, v187, s[28:31], s55 offen
  buffer_load_dwordx3 v[64:66], v186, s[16:19], s52 offen offset:0 sc0 sc1 nt
  buffer_load_dwordx3 v[68:70], v186, s[16:19], s52 offen offset:768 sc0 sc1 nt
  buffer_load_dwordx3 v[72:74], v186, s[16:19], s52 offen offset:1536 sc0 sc1 nt
  buffer_load_dwordx3 v[76:78], v186, s[16:19], s52 offen offset:2304 sc0 sc1 nt
  buffer_load_dwordx3 v[80:82], v186, s[16:19], s53 offen offset:0 sc0 sc1 nt
  buffer_load_dwordx3 v[84:86], v186, s[16:19], s53 offen offset:768 sc0 sc1 nt
  buffer_load_dwordx3 v[88:90], v186, s[16:19], s53 offen offset:1536 sc0 sc1 nt
  buffer_load_dwordx3 v[92:94], v186, s[16:19], s53 offen offset:2304 sc0 sc1 nt
  s_waitcnt vmcnt(9)
  v_readlane_b32 s60, v156, 0
  v_readlane_b32 s61, v156, 1
  v_readlane_b32 s62, v156, 2
  v_readlane_b32 s63, v156, 3
  v_readlane_b32 s64, v156, 4
  v_readlane_b32 s65, v156, 5
  v_readlane_b32 s66, v156, 6
  v_readlane_b32 s67, v156, 7
  s_waitcnt vmcnt(8)
  v_readlane_b32 s68, v157, 0
  v_readlane_b32 s69, v157, 1
  v_readlane_b32 s70, v157, 2
  v_readlane_b32 s71, v157, 3
  v_readlane_b32 s72, v157, 4
  v_readlane_b32 s73, v157, 5
  v_readlane_b32 s74, v157, 6
  v_readlane_b32 s75, v157, 7
  s_waitcnt vmcnt(6)
  v_cvt_f32_i32 v71, v70
  v_cvt_f32_i32 v70, v66
  v_cvt_f32_i32 v66, v65
  v_cvt_f32_i32 v67, v69
  v_cvt_f32_i32 v65, v68
  v_cvt_f32_i32 v64, v64
  v_cvt_pk_bf16_f32 v70, 0, v70
  v_cvt_pk_bf16_f32 v71, 0, v71
  v_cvt_pk_bf16_f32 v66, 0, v66
  v_cvt_pk_bf16_f32 v67, 0, v67
  v_cvt_pk_bf16_f32 v64, 0, v64
  v_cvt_pk_bf16_f32 v65, 0, v65
  v_pk_add_f32 v[70:71], v[70:71], s[60:61] neg_lo:[0,1] neg_hi:[0,1]
  v_pk_add_f32 v[66:67], v[66:67], s[60:61] neg_lo:[0,1] neg_hi:[0,1]
  v_pk_add_f32 v[64:65], v[64:65], s[60:61] neg_lo:[0,1] neg_hi:[0,1]
  v_cvt_pk_bf16_f32 v70, 0, v70
  v_cvt_pk_bf16_f32 v71, 0, v71
  v_cvt_pk_bf16_f32 v66, 0, v66
  v_cvt_pk_bf16_f32 v67, 0, v67
  v_cvt_pk_bf16_f32 v64, 0, v64
  v_cvt_pk_bf16_f32 v65, 0, v65
  v_pk_mul_f32 v[70:71], v[70:71], s[68:69]
  v_pk_mul_f32 v[66:67], v[66:67], s[68:69]
  v_pk_mul_f32 v[64:65], v[64:65], s[68:69]
  v_cvt_pk_bf16_f32 v148, v70, v71
  v_cvt_pk_bf16_f32 v68, v66, v67
  v_cvt_pk_bf16_f32 v64, v64, v65
  s_waitcnt vmcnt(4)
  v_cvt_f32_i32 v79, v78
  v_cvt_f32_i32 v78, v74
  v_cvt_f32_i32 v74, v73
  v_cvt_f32_i32 v75, v77
  v_cvt_f32_i32 v73, v76
  v_cvt_f32_i32 v72, v72
  v_cvt_pk_bf16_f32 v78, 0, v78
  v_cvt_pk_bf16_f32 v79, 0, v79
  v_cvt_pk_bf16_f32 v74, 0, v74
  v_cvt_pk_bf16_f32 v75, 0, v75
  v_cvt_pk_bf16_f32 v72, 0, v72
  v_cvt_pk_bf16_f32 v73, 0, v73
  v_pk_add_f32 v[78:79], v[78:79], s[62:63] neg_lo:[0,1] neg_hi:[0,1]
  v_pk_add_f32 v[74:75], v[74:75], s[62:63] neg_lo:[0,1] neg_hi:[0,1]
  v_pk_add_f32 v[72:73], v[72:73], s[62:63] neg_lo:[0,1] neg_hi:[0,1]
  v_cvt_pk_bf16_f32 v78, 0, v78
  v_cvt_pk_bf16_f32 v79, 0, v79
  v_cvt_pk_bf16_f32 v74, 0, v74
  v_cvt_pk_bf16_f32 v75, 0, v75
  v_cvt_pk_bf16_f32 v72, 0, v72
  v_cvt_pk_bf16_f32 v73, 0, v73
  v_pk_mul_f32 v[78:79], v[78:79], s[70:71]
  v_pk_mul_f32 v[74:75], v[74:75], s[70:71]
  v_pk_mul_f32 v[72:73], v[72:73], s[70:71]
  v_cvt_pk_bf16_f32 v149, v78, v79
  v_cvt_pk_bf16_f32 v69, v74, v75
  v_cvt_pk_bf16_f32 v65, v72, v73
  s_waitcnt vmcnt(2)
  v_cvt_f32_i32 v87, v86
  v_cvt_f32_i32 v86, v82
  v_cvt_f32_i32 v82, v81
  v_cvt_f32_i32 v83, v85
  v_cvt_f32_i32 v81, v84
  v_cvt_f32_i32 v80, v80
  v_cvt_pk_bf16_f32 v86, 0, v86
  v_cvt_pk_bf16_f32 v87, 0, v87
  v_cvt_pk_bf16_f32 v82, 0, v82
  v_cvt_pk_bf16_f32 v83, 0, v83
  v_cvt_pk_bf16_f32 v80, 0, v80
  v_cvt_pk_bf16_f32 v81, 0, v81
  v_pk_add_f32 v[86:87], v[86:87], s[64:65] neg_lo:[0,1] neg_hi:[0,1]
  v_pk_add_f32 v[82:83], v[82:83], s[64:65] neg_lo:[0,1] neg_hi:[0,1]
  v_pk_add_f32 v[80:81], v[80:81], s[64:65] neg_lo:[0,1] neg_hi:[0,1]
  v_cvt_pk_bf16_f32 v86, 0, v86
  v_cvt_pk_bf16_f32 v87, 0, v87
  v_cvt_pk_bf16_f32 v82, 0, v82
  v_cvt_pk_bf16_f32 v83, 0, v83
  v_cvt_pk_bf16_f32 v80, 0, v80
  v_cvt_pk_bf16_f32 v81, 0, v81
  v_pk_mul_f32 v[86:87], v[86:87], s[72:73]
  v_pk_mul_f32 v[82:83], v[82:83], s[72:73]
  v_pk_mul_f32 v[80:81], v[80:81], s[72:73]
  v_cvt_pk_bf16_f32 v150, v86, v87
  v_cvt_pk_bf16_f32 v70, v82, v83
  v_cvt_pk_bf16_f32 v66, v80, v81
  s_waitcnt vmcnt(0)
  v_cvt_f32_i32 v95, v94
  v_cvt_f32_i32 v94, v90
  v_cvt_f32_i32 v90, v89
  v_cvt_f32_i32 v91, v93
  v_cvt_f32_i32 v89, v92
  v_cvt_f32_i32 v88, v88
  v_cvt_pk_bf16_f32 v94, 0, v94
  v_cvt_pk_bf16_f32 v95, 0, v95
  v_cvt_pk_bf16_f32 v90, 0, v90
  v_cvt_pk_bf16_f32 v91, 0, v91
  v_cvt_pk_bf16_f32 v88, 0, v88
  v_cvt_pk_bf16_f32 v89, 0, v89
  v_pk_add_f32 v[94:95], v[94:95], s[66:67] neg_lo:[0,1] neg_hi:[0,1]
  v_pk_add_f32 v[90:91], v[90:91], s[66:67] neg_lo:[0,1] neg_hi:[0,1]
  v_pk_add_f32 v[88:89], v[88:89], s[66:67] neg_lo:[0,1] neg_hi:[0,1]
  v_cvt_pk_bf16_f32 v94, 0, v94
  v_cvt_pk_bf16_f32 v95, 0, v95
  v_cvt_pk_bf16_f32 v90, 0, v90
  v_cvt_pk_bf16_f32 v91, 0, v91
  v_cvt_pk_bf16_f32 v88, 0, v88
  v_cvt_pk_bf16_f32 v89, 0, v89
  v_pk_mul_f32 v[94:95], v[94:95], s[74:75]
  v_pk_mul_f32 v[90:91], v[90:91], s[74:75]
  v_pk_mul_f32 v[88:89], v[88:89], s[74:75]
  v_cvt_pk_bf16_f32 v151, v94, v95
  v_cvt_pk_bf16_f32 v71, v90, v91
  v_cvt_pk_bf16_f32 v67, v88, v89
  buffer_store_dwordx4 v[64:67], v9, s[4:7], s52 offen offset:0 sc1
  buffer_store_dwordx4 v[68:71], v9, s[4:7], s52 offen offset:1024 sc1
  buffer_store_dwordx4 v[148:151], v9, s[4:7], s52 offen offset:2048 sc1
  v_readlane_b32 s60, v140, 0
  v_readlane_b32 s61, v140, 1
  v_readlane_b32 s62, v140, 2
  v_readlane_b32 s63, v140, 3
  v_readlane_b32 s64, v140, 4
  v_readlane_b32 s65, v140, 5
  v_readlane_b32 s66, v140, 6
  v_readlane_b32 s67, v140, 7
  v_readlane_b32 s68, v140, 8
  v_readlane_b32 s69, v140, 9
  v_readlane_b32 s70, v140, 10
  v_readlane_b32 s71, v140, 11
  v_readlane_b32 s72, v140, 12
  v_readlane_b32 s73, v140, 13
  v_readlane_b32 s74, v140, 14
  v_readlane_b32 s75, v140, 15
  s_waitcnt vmcnt(0)
L_wret:
  s_nop 7
  s_cmp_eq_u32 s100, 0
  s_cbranch_scc1 L_ret0
  s_cmp_eq_u32 s100, 1
  s_cbranch_scc1 L_ret1
  s_cmp_eq_u32 s100, 2
  s_cbranch_scc1 L_ret2
  s_cmp_eq_u32 s100, 3
  s_cbranch_scc1 L_ret3
  s_cmp_eq_u32 s100, 4
  s_cbranch_scc1 L_ret4
  s_cmp_eq_u32 s100, 5
  s_cbranch_scc1 L_ret5
  s_cmp_eq_u32 s100, 6
  s_cbranch_scc1 L_ret6
  s_cmp_eq_u32 s100, 7
  s_cbranch_scc1 L_ret7
  s_cmp_eq_u32 s100, 8
  s_cbranch_scc1 L_ret8
  s_cmp_eq_u32 s100, 9
  s_cbranch_scc1 L_ret9
  s_cmp_eq_u32 s100, 10
  s_cbranch_scc1 L_ret10
  s_cmp_eq_u32 s100, 11
  s_cbranch_scc1 L_ret11
  s_cmp_eq_u32 s100, 12
  s_cbranch_scc1 L_ret12
  s_cmp_eq_u32 s100, 13
  s_cbranch_scc1 L_ret13
  s_cmp_eq_u32 s100, 14
  s_cbranch_scc1 L_ret14
  s_cmp_eq_u32 s100, 15
  s_cbranch_scc1 L_ret15
  s_cmp_eq_u32 s100, 16
  s_cbranch_scc1 L_ret16
  s_cmp_eq_u32 s100, 17
  s_cbranch_scc1 L_ret17
  s_cmp_eq_u32 s100, 18
  s_cbranch_scc1 L_ret18
  s_cmp_eq_u32 s100, 19
  s_cbranch_scc1 L_ret19
  s_cmp_eq_u32 s100, 20
  s_cbranch_scc1 L_ret20
  s_cmp_eq_u32 s100, 21
  s_cbranch_scc1 L_ret21
  s_cmp_eq_u32 s100, 22
  s_cbranch_scc1 L_ret22
  s_cmp_eq_u32 s100, 23
  s_cbranch_scc1 L_ret23
  s_branch L_ret24
L_end:
  s_endpgm
L_codeend:
.section .rodata,"a"
.p2align 6
.amdhsa_kernel standalone__kv_cache_quant_int4_int2_kv_with_per_channel_or_per_token_scales__prompt_kernel
  .amdhsa_next_free_vgpr 512
  .amdhsa_next_free_sgpr 102
  .amdhsa_accum_offset 256
  .amdhsa_group_segment_fixed_size 0
  .amdhsa_kernarg_size 80
  .amdhsa_user_sgpr_count 2
  .amdhsa_user_sgpr_kernarg_segment_ptr 1
  .amdhsa_system_sgpr_workgroup_id_x 1
  .amdhsa_float_denorm_mode_32 3
.end_amdhsa_kernel
```
